```python
import torch

def _softmax(x, axis=-1):
    return torch.softmax(x, dim=axis)

def _gelu(x):
    return torch.nn.functional.gelu(x, approximate='tanh')

def _silu(x):
    return torch.nn.functional.silu(x)

def _sigmoid(x):
    return torch.sigmoid(x)

def _layernorm(x, axis=-1, eps=1e-05):
    m = x.mean(dim=axis, keepdim=True)
    v = x.var(dim=axis, keepdim=True, unbiased=False)
    return (x - m) / torch.sqrt(v + eps)

def _scatter_add(tgt, idx, src, axis=0):
    return tgt.clone().index_add_(axis, idx, src)

def _segment_sum(src, seg, n):
    out = torch.zeros((n,) + src.shape[1:], dtype=src.dtype)
    return out.index_add_(0, seg, src)

def _pad(x, pw):
    flat = tuple((v for pair in reversed(pw) for v in pair))
    return torch.nn.functional.pad(x, flat)
kernel_name = 'adaLN_cond__sliding_block_cached__dense_activation_squared_relu__prompt'

def setup_inputs():

    _w = lambda a: (lambda t: t.to(torch.bfloat16) if t.is_floating_point() else t)(torch.as_tensor(a))

    def _A_setup():
        B, Sq, D = (1, 2048, 640)
        Hq, Hkv, Sk, Dh = (32, 32, 2048, 128)
        assert Hq % Hkv == 0, (Hq, Hkv)
        return {'x': _w((lambda *s: torch.randn(*s, dtype=torch.bfloat16) * 0.05)(B, Sq, D)), 'k_cache': _w((lambda *s: torch.randn(*s, dtype=torch.bfloat16) * 3.2)(B, Hkv, Sk, Dh)), 'v_cache': _w((lambda *s: torch.randn(*s, dtype=torch.bfloat16) * 0.4)(B, Hkv, Sk, Dh)), 'wq': _w((lambda *s: torch.randn(*s, dtype=torch.bfloat16) * 3.2)(D, Hq * Dh) * D ** (-0.5)), 'wo': _w((lambda *s: torch.randn(*s, dtype=torch.bfloat16) * 0.4)(Hq * Dh, D) * (Hq * Dh) ** (-0.5))}
    _A_in = _A_setup()

    def _B_setup():
        B, S, D, F = (1, 2048, 640, 1728)
        return {'x': _w((lambda *s: torch.randn(*s, dtype=torch.bfloat16) * 0.05)(B, S, D)), 'w1': _w((lambda *s: torch.randn(*s, dtype=torch.bfloat16) * 0.05)(D, F)), 'b1': _w((lambda *s: torch.randn(*s, dtype=torch.bfloat16) * 0.8)(F)), 'w2': _w((lambda *s: torch.randn(*s, dtype=torch.bfloat16) * 0.05)(F, D)), 'b2': _w((lambda *s: torch.randn(*s, dtype=torch.bfloat16) * 6.4)(D))}
    _B_in = _B_setup()
    return {'A_x': _A_in['x'], 'A_k_cache': _A_in['k_cache'], 'A_v_cache': _A_in['v_cache'], 'A_wq': _A_in['wq'], 'A_wo': _A_in['wo'], 'B_x': _B_in['x'], 'B_w1': _B_in['w1'], 'B_b1': _B_in['b1'], 'B_w2': _B_in['w2'], 'B_b2': _B_in['b2'], 'c': _w((lambda *s: torch.randn(*s, dtype=torch.bfloat16) * 0.1)(1, 640) * 8.0), 'w_mod': _w((lambda *s: torch.randn(*s, dtype=torch.bfloat16) * 0.1)(640, 6 * 640) * 640 ** (-0.5) * 8.0)}

def reference(A_x, A_k_cache, A_v_cache, A_wq, A_wo, B_x, B_w1, B_b1, B_w2, B_b2, c, w_mod):

    def _A_ref(x, k_cache, v_cache, wq, wo):
        B, Sq, D = x.shape
        Hq, Dh = (32, 128)
        Hkv, Sk = (k_cache.shape[1], k_cache.shape[2])
        W = min(4096, max(256, Sk // 4))
        rep = Hq // Hkv
        q = (lambda x, *d: x.permute(*d))((x @ wq).reshape(B, Sq, Hq, Dh), 0, 2, 1, 3)
        k = (lambda x, n, axis: torch.repeat_interleave(x, n, dim=axis))(k_cache[:, :, Sk - W:, :], rep, axis=1)
        v = (lambda x, n, axis: torch.repeat_interleave(x, n, dim=axis))(v_cache[:, :, Sk - W:, :], rep, axis=1)
        scores = torch.einsum('bhqd,bhkd->bhqk', q, k) * Dh ** (-0.5)
        p = _softmax(scores, axis=-1)
        o = torch.einsum('bhqk,bhkd->bhqd', p, v)
        return (lambda x, *d: x.permute(*d))(o, 0, 2, 1, 3).reshape(B, Sq, Hq * Dh) @ wo

    def _B_ref(x, w1, b1, w2, b2):
        h = torch.einsum('bsd,df->bsf', x, w1) + b1
        zero = torch.zeros_like(h)
        r = torch.where(h > zero, h, zero)
        h = r * r
        out = torch.einsum('bsf,fd->bsd', h, w2) + b2
        return out
    x = A_x
    mod = (_silu(c) @ w_mod).reshape(c.shape[0], 6, 1, -1)
    sa, ca, ga, sb, cb, gb = (mod[:, 0].clone(), mod[:, 1].clone(), mod[:, 2].clone(), mod[:, 3].clone(), mod[:, 4].clone(), mod[:, 5].clone())
    h = _layernorm(x, axis=-1) * (1 + ca) + sa
    x = x + ga * _A_ref(h, A_k_cache, A_v_cache, A_wq, A_wo)
    h = _layernorm(x, axis=-1) * (1 + cb) + sb
    x = x + gb * _B_ref(h, B_w1, B_b1, B_w2, B_b2)
    return x
```

```asm
; @launch kernel=attn_kernel grid=(256,1,1) block=(256,1,1) lds=131648
; @launch kernel=oproj_kernel grid=(256,1,1) block=(768,1,1) lds=150528
; @launch kernel=mlp1_kernel grid=(224,1,1) block=(512,1,1) lds=102400
; @launch kernel=mlp2_kernel grid=(256,1,1) block=(768,1,1) lds=141312
.amdgcn_target "amdgcn-amd-amdhsa--gfx950"
.text
.globl attn_kernel
.p2align 8
.type attn_kernel,@function
attn_kernel:
    s_cmp_ge_u32 s2, 256
    s_cbranch_scc1 attn_kernel_end_1
    s_load_dwordx2 s[74:75], s[0:1], 24
    s_load_dwordx2 s[56:57], s[0:1], 104
    s_and_b32 s16, s2, 7
    s_lshr_b32 s17, s2, 3
    s_lshr_b32 s18, s17, 1
    s_lshl_b32 s18, s18, 4
    s_lshl_b32 s19, s16, 1
    s_add_u32 s18, s18, s19
    s_and_b32 s19, s17, 1
    s_add_u32 s18, s18, s19
    s_lshl_b32 s16, s16, 4
    s_and_b32 s17, s17, 15
    s_add_u32 s16, s16, s17
    s_cmp_ge_u32 s18, 120
    s_cselect_b32 s17, 2, 0
    s_cmp_ge_u32 s2, 128
    s_cselect_b32 s17, 1, s17
    s_mov_b32 s54, 0
    s_mov_b32 s3, s17
attn_kernel_prod_12:
    s_load_dwordx2 s[12:13], s[0:1], 112
    s_load_dwordx2 s[4:5], s[0:1], 80
    s_load_dwordx2 s[8:9], s[0:1], 88
    s_load_dwordx2 s[24:25], s[0:1], 0
    v_lshrrev_b32 v1, 6, v0
    v_and_b32 v2, 63, v0
    v_mov_b32 v255, v0
    v_readfirstlane_b32 s28, v1
    s_and_b32 s37, s2, 7
    s_lshr_b32 s38, s2, 3
    s_and_b32 s35, s37, 1
    s_lshl_b32 s35, s35, 2
    s_and_b32 s33, s38, 3
    s_add_u32 s35, s35, s33
    s_lshr_b32 s34, s37, 1
    s_lshl_b32 s34, s34, 3
    s_lshr_b32 s38, s38, 2
    s_add_u32 s34, s34, s38
    s_mul_i32 s39, s28, 4480
    v_lshrrev_b32 v3, 4, v2
    v_and_b32 v4, 15, v2
    v_lshlrev_b32 v5, 4, v1
    v_lshl_add_u32 v5, v3, 2, v5
    v_lshlrev_b32 v5, 13, v5
    v_lshl_add_u32 v232, v4, 4, v5
    v_add_u32 v233, 7104, v232
    v_add_u32 v234, 14208, v232
    v_add_u32 v235, 21312, v232
    s_mov_b32 s40, 524288
    s_cmp_eq_u32 s17, 1
    s_cbranch_scc1 attn_kernel_ln_13
    s_cmp_eq_u32 s17, 2
    s_cbranch_scc1 attn_kernel_none_14
    v_lshrrev_b32 v1, 2, v0
    v_and_b32 v2, 3, v0
    v_lshlrev_b32 v3, 1, v1
    v_mul_u32_u24 v4, 7680, v1
    v_lshl_add_u32 v4, v2, 4, v4
    s_lshl_b32 s19, s18, 6
    s_waitcnt lgkmcnt(0)
    s_mov_b32 s6, 1280
    s_mov_b32 s7, 0x00020000
    s_mov_b32 s10, 4915200
    s_mov_b32 s11, 0x00020000
    s_mov_b32 s14, 37888
    s_mov_b32 s15, 0x00020000
    buffer_load_ushort v8, v3, s[4:7], 0 offen offset:0
    buffer_load_ushort v9, v3, s[4:7], 0 offen offset:128
    buffer_load_ushort v10, v3, s[4:7], 0 offen offset:256
    buffer_load_ushort v11, v3, s[4:7], 0 offen offset:384
    buffer_load_ushort v12, v3, s[4:7], 0 offen offset:512
    buffer_load_ushort v13, v3, s[4:7], 0 offen offset:640
    buffer_load_ushort v14, v3, s[4:7], 0 offen offset:768
    buffer_load_ushort v15, v3, s[4:7], 0 offen offset:896
    buffer_load_ushort v16, v3, s[4:7], 0 offen offset:1024
    buffer_load_ushort v17, v3, s[4:7], 0 offen offset:1152
    buffer_load_dwordx4 v[20:23], v4, s[8:11], s19 offen
    s_add_u32 s19, s19, 491520
    buffer_load_dwordx4 v[24:27], v4, s[8:11], s19 offen
    s_add_u32 s19, s19, 491520
    buffer_load_dwordx4 v[28:31], v4, s[8:11], s19 offen
    s_add_u32 s19, s19, 491520
    buffer_load_dwordx4 v[32:35], v4, s[8:11], s19 offen
    s_add_u32 s19, s19, 491520
    buffer_load_dwordx4 v[36:39], v4, s[8:11], s19 offen
    s_add_u32 s19, s19, 491520
    buffer_load_dwordx4 v[40:43], v4, s[8:11], s19 offen
    s_add_u32 s19, s19, 491520
    buffer_load_dwordx4 v[44:47], v4, s[8:11], s19 offen
    s_add_u32 s19, s19, 491520
    buffer_load_dwordx4 v[48:51], v4, s[8:11], s19 offen
    s_add_u32 s19, s19, 491520
    buffer_load_dwordx4 v[52:55], v4, s[8:11], s19 offen
    s_add_u32 s19, s19, 491520
    buffer_load_dwordx4 v[56:59], v4, s[8:11], s19 offen
    s_lshl_b32 s37, s34, 8
    s_add_u32 s44, s74, s37
    s_addc_u32 s45, s75, 0
    s_sub_u32 s46, 5242880, s37
    s_mov_b32 s47, 0x00020000
    s_add_u32 s48, s74, s37
    s_addc_u32 s49, s75, 0
    s_sub_u32 s50, 5242880, s37
    s_mov_b32 s51, 0x00020000
    s_mov_b32 s31, 0
    s_add_u32 m0, s39, 0
    s_nop 0
    buffer_load_dwordx4 v232, s[44:47], s31 offen offset:0 lds
    buffer_load_dwordx4 v233, s[44:47], s31 offen offset:1088 lds
    buffer_load_dwordx4 v234, s[48:51], s31 offen offset:2176 lds
    buffer_load_dwordx4 v235, s[48:51], s31 offen offset:3264 lds
    s_waitcnt vmcnt(14)
    v_lshlrev_b32 v8, 16, v8
    v_mul_f32 v84, 0xbfb8aa3b, v8
    v_exp_f32 v84, v84
    s_nop 0
    v_add_f32 v84, 1.0, v84
    v_rcp_f32 v84, v84
    s_nop 0
    v_mul_f32 v84, v84, v8
    v_cvt_pk_bf16_f32 v84, v84, v84
    v_lshlrev_b32 v8, 16, v84
    v_lshlrev_b32 v9, 16, v9
    v_mul_f32 v85, 0xbfb8aa3b, v9
    v_exp_f32 v85, v85
    s_nop 0
    v_add_f32 v85, 1.0, v85
    v_rcp_f32 v85, v85
    s_nop 0
    v_mul_f32 v85, v85, v9
    v_cvt_pk_bf16_f32 v85, v85, v85
    v_lshlrev_b32 v9, 16, v85
    v_lshlrev_b32 v10, 16, v10
    v_mul_f32 v86, 0xbfb8aa3b, v10
    v_exp_f32 v86, v86
    s_nop 0
    v_add_f32 v86, 1.0, v86
    v_rcp_f32 v86, v86
    s_nop 0
    v_mul_f32 v86, v86, v10
    v_cvt_pk_bf16_f32 v86, v86, v86
    v_lshlrev_b32 v10, 16, v86
    v_lshlrev_b32 v11, 16, v11
    v_mul_f32 v87, 0xbfb8aa3b, v11
    v_exp_f32 v87, v87
    s_nop 0
    v_add_f32 v87, 1.0, v87
    v_rcp_f32 v87, v87
    s_nop 0
    v_mul_f32 v87, v87, v11
    v_cvt_pk_bf16_f32 v87, v87, v87
    v_lshlrev_b32 v11, 16, v87
    v_lshlrev_b32 v12, 16, v12
    v_mul_f32 v84, 0xbfb8aa3b, v12
    v_exp_f32 v84, v84
    s_nop 0
    v_add_f32 v84, 1.0, v84
    v_rcp_f32 v84, v84
    s_nop 0
    v_mul_f32 v84, v84, v12
    v_cvt_pk_bf16_f32 v84, v84, v84
    v_lshlrev_b32 v12, 16, v84
    v_lshlrev_b32 v13, 16, v13
    v_mul_f32 v85, 0xbfb8aa3b, v13
    v_exp_f32 v85, v85
    s_nop 0
    v_add_f32 v85, 1.0, v85
    v_rcp_f32 v85, v85
    s_nop 0
    v_mul_f32 v85, v85, v13
    v_cvt_pk_bf16_f32 v85, v85, v85
    v_lshlrev_b32 v13, 16, v85
    v_lshlrev_b32 v14, 16, v14
    v_mul_f32 v86, 0xbfb8aa3b, v14
    v_exp_f32 v86, v86
    s_nop 0
    v_add_f32 v86, 1.0, v86
    v_rcp_f32 v86, v86
    s_nop 0
    v_mul_f32 v86, v86, v14
    v_cvt_pk_bf16_f32 v86, v86, v86
    v_lshlrev_b32 v14, 16, v86
    v_lshlrev_b32 v15, 16, v15
    v_mul_f32 v87, 0xbfb8aa3b, v15
    v_exp_f32 v87, v87
    s_nop 0
    v_add_f32 v87, 1.0, v87
    v_rcp_f32 v87, v87
    s_nop 0
    v_mul_f32 v87, v87, v15
    v_cvt_pk_bf16_f32 v87, v87, v87
    v_lshlrev_b32 v15, 16, v87
    v_lshlrev_b32 v16, 16, v16
    v_mul_f32 v84, 0xbfb8aa3b, v16
    v_exp_f32 v84, v84
    s_nop 0
    v_add_f32 v84, 1.0, v84
    v_rcp_f32 v84, v84
    s_nop 0
    v_mul_f32 v84, v84, v16
    v_cvt_pk_bf16_f32 v84, v84, v84
    v_lshlrev_b32 v16, 16, v84
    v_lshlrev_b32 v17, 16, v17
    v_mul_f32 v85, 0xbfb8aa3b, v17
    v_exp_f32 v85, v85
    s_nop 0
    v_add_f32 v85, 1.0, v85
    v_rcp_f32 v85, v85
    s_nop 0
    v_mul_f32 v85, v85, v17
    v_cvt_pk_bf16_f32 v85, v85, v85
    v_lshlrev_b32 v17, 16, v85
    v_mov_b32 v64, 0
    v_mov_b32 v65, 0
    v_mov_b32 v66, 0
    v_mov_b32 v67, 0
    v_mov_b32 v68, 0
    v_mov_b32 v69, 0
    v_mov_b32 v70, 0
    v_mov_b32 v71, 0
    v_lshrrev_b32 v5, 4, v0
    v_lshlrev_b32 v5, 7, v5
    v_lshl_add_u32 v5, v2, 5, v5
    v_add_u32 v5, 129600, v5
    v_and_b32 v6, 15, v0
    v_cmp_gt_u32 vcc, 4, v6
    s_waitcnt vmcnt(13)
    v_lshlrev_b32 v84, 16, v20
    v_and_b32 v85, 0xffff0000, v20
    v_fmac_f32 v64, v84, v8
    v_fmac_f32 v65, v85, v8
    v_lshlrev_b32 v86, 16, v21
    v_and_b32 v87, 0xffff0000, v21
    v_fmac_f32 v66, v86, v8
    v_fmac_f32 v67, v87, v8
    v_lshlrev_b32 v84, 16, v22
    v_and_b32 v85, 0xffff0000, v22
    v_fmac_f32 v68, v84, v8
    v_fmac_f32 v69, v85, v8
    v_lshlrev_b32 v86, 16, v23
    v_and_b32 v87, 0xffff0000, v23
    v_fmac_f32 v70, v86, v8
    v_fmac_f32 v71, v87, v8
    s_waitcnt vmcnt(12)
    v_lshlrev_b32 v84, 16, v24
    v_and_b32 v85, 0xffff0000, v24
    v_fmac_f32 v64, v84, v9
    v_fmac_f32 v65, v85, v9
    v_lshlrev_b32 v86, 16, v25
    v_and_b32 v87, 0xffff0000, v25
    v_fmac_f32 v66, v86, v9
    v_fmac_f32 v67, v87, v9
    v_lshlrev_b32 v84, 16, v26
    v_and_b32 v85, 0xffff0000, v26
    v_fmac_f32 v68, v84, v9
    v_fmac_f32 v69, v85, v9
    v_lshlrev_b32 v86, 16, v27
    v_and_b32 v87, 0xffff0000, v27
    v_fmac_f32 v70, v86, v9
    v_fmac_f32 v71, v87, v9
    s_waitcnt vmcnt(11)
    v_lshlrev_b32 v84, 16, v28
    v_and_b32 v85, 0xffff0000, v28
    v_fmac_f32 v64, v84, v10
    v_fmac_f32 v65, v85, v10
    v_lshlrev_b32 v86, 16, v29
    v_and_b32 v87, 0xffff0000, v29
    v_fmac_f32 v66, v86, v10
    v_fmac_f32 v67, v87, v10
    v_lshlrev_b32 v84, 16, v30
    v_and_b32 v85, 0xffff0000, v30
    v_fmac_f32 v68, v84, v10
    v_fmac_f32 v69, v85, v10
    v_lshlrev_b32 v86, 16, v31
    v_and_b32 v87, 0xffff0000, v31
    v_fmac_f32 v70, v86, v10
    v_fmac_f32 v71, v87, v10
    s_waitcnt vmcnt(10)
    v_lshlrev_b32 v84, 16, v32
    v_and_b32 v85, 0xffff0000, v32
    v_fmac_f32 v64, v84, v11
    v_fmac_f32 v65, v85, v11
    v_lshlrev_b32 v86, 16, v33
    v_and_b32 v87, 0xffff0000, v33
    v_fmac_f32 v66, v86, v11
    v_fmac_f32 v67, v87, v11
    v_lshlrev_b32 v84, 16, v34
    v_and_b32 v85, 0xffff0000, v34
    v_fmac_f32 v68, v84, v11
    v_fmac_f32 v69, v85, v11
    v_lshlrev_b32 v86, 16, v35
    v_and_b32 v87, 0xffff0000, v35
    v_fmac_f32 v70, v86, v11
    v_fmac_f32 v71, v87, v11
    s_waitcnt vmcnt(9)
    v_lshlrev_b32 v84, 16, v36
    v_and_b32 v85, 0xffff0000, v36
    v_fmac_f32 v64, v84, v12
    v_fmac_f32 v65, v85, v12
    v_lshlrev_b32 v86, 16, v37
    v_and_b32 v87, 0xffff0000, v37
    v_fmac_f32 v66, v86, v12
    v_fmac_f32 v67, v87, v12
    v_lshlrev_b32 v84, 16, v38
    v_and_b32 v85, 0xffff0000, v38
    v_fmac_f32 v68, v84, v12
    v_fmac_f32 v69, v85, v12
    v_lshlrev_b32 v86, 16, v39
    v_and_b32 v87, 0xffff0000, v39
    v_fmac_f32 v70, v86, v12
    v_fmac_f32 v71, v87, v12
    s_waitcnt vmcnt(8)
    v_lshlrev_b32 v84, 16, v40
    v_and_b32 v85, 0xffff0000, v40
    v_fmac_f32 v64, v84, v13
    v_fmac_f32 v65, v85, v13
    v_lshlrev_b32 v86, 16, v41
    v_and_b32 v87, 0xffff0000, v41
    v_fmac_f32 v66, v86, v13
    v_fmac_f32 v67, v87, v13
    v_lshlrev_b32 v84, 16, v42
    v_and_b32 v85, 0xffff0000, v42
    v_fmac_f32 v68, v84, v13
    v_fmac_f32 v69, v85, v13
    v_lshlrev_b32 v86, 16, v43
    v_and_b32 v87, 0xffff0000, v43
    v_fmac_f32 v70, v86, v13
    v_fmac_f32 v71, v87, v13
    s_waitcnt vmcnt(7)
    v_lshlrev_b32 v84, 16, v44
    v_and_b32 v85, 0xffff0000, v44
    v_fmac_f32 v64, v84, v14
    v_fmac_f32 v65, v85, v14
    v_lshlrev_b32 v86, 16, v45
    v_and_b32 v87, 0xffff0000, v45
    v_fmac_f32 v66, v86, v14
    v_fmac_f32 v67, v87, v14
    v_lshlrev_b32 v84, 16, v46
    v_and_b32 v85, 0xffff0000, v46
    v_fmac_f32 v68, v84, v14
    v_fmac_f32 v69, v85, v14
    v_lshlrev_b32 v86, 16, v47
    v_and_b32 v87, 0xffff0000, v47
    v_fmac_f32 v70, v86, v14
    v_fmac_f32 v71, v87, v14
    s_waitcnt vmcnt(6)
    v_lshlrev_b32 v84, 16, v48
    v_and_b32 v85, 0xffff0000, v48
    v_fmac_f32 v64, v84, v15
    v_fmac_f32 v65, v85, v15
    v_lshlrev_b32 v86, 16, v49
    v_and_b32 v87, 0xffff0000, v49
    v_fmac_f32 v66, v86, v15
    v_fmac_f32 v67, v87, v15
    v_lshlrev_b32 v84, 16, v50
    v_and_b32 v85, 0xffff0000, v50
    v_fmac_f32 v68, v84, v15
    v_fmac_f32 v69, v85, v15
    v_lshlrev_b32 v86, 16, v51
    v_and_b32 v87, 0xffff0000, v51
    v_fmac_f32 v70, v86, v15
    v_fmac_f32 v71, v87, v15
    s_waitcnt vmcnt(5)
    v_lshlrev_b32 v84, 16, v52
    v_and_b32 v85, 0xffff0000, v52
    v_fmac_f32 v64, v84, v16
    v_fmac_f32 v65, v85, v16
    v_lshlrev_b32 v86, 16, v53
    v_and_b32 v87, 0xffff0000, v53
    v_fmac_f32 v66, v86, v16
    v_fmac_f32 v67, v87, v16
    v_lshlrev_b32 v84, 16, v54
    v_and_b32 v85, 0xffff0000, v54
    v_fmac_f32 v68, v84, v16
    v_fmac_f32 v69, v85, v16
    v_lshlrev_b32 v86, 16, v55
    v_and_b32 v87, 0xffff0000, v55
    v_fmac_f32 v70, v86, v16
    v_fmac_f32 v71, v87, v16
    s_waitcnt vmcnt(4)
    v_lshlrev_b32 v84, 16, v56
    v_and_b32 v85, 0xffff0000, v56
    v_fmac_f32 v64, v84, v17
    v_fmac_f32 v65, v85, v17
    v_lshlrev_b32 v86, 16, v57
    v_and_b32 v87, 0xffff0000, v57
    v_fmac_f32 v66, v86, v17
    v_fmac_f32 v67, v87, v17
    v_lshlrev_b32 v84, 16, v58
    v_and_b32 v85, 0xffff0000, v58
    v_fmac_f32 v68, v84, v17
    v_fmac_f32 v69, v85, v17
    v_lshlrev_b32 v86, 16, v59
    v_and_b32 v87, 0xffff0000, v59
    v_fmac_f32 v70, v86, v17
    v_fmac_f32 v71, v87, v17
    v_add_f32_dpp v72, v64, v64 row_ror:4 row_mask:0xf bank_mask:0xf
    v_add_f32_dpp v73, v65, v65 row_ror:4 row_mask:0xf bank_mask:0xf
    v_add_f32_dpp v74, v66, v66 row_ror:4 row_mask:0xf bank_mask:0xf
    v_add_f32_dpp v75, v67, v67 row_ror:4 row_mask:0xf bank_mask:0xf
    v_add_f32_dpp v76, v68, v68 row_ror:4 row_mask:0xf bank_mask:0xf
    v_add_f32_dpp v77, v69, v69 row_ror:4 row_mask:0xf bank_mask:0xf
    v_add_f32_dpp v78, v70, v70 row_ror:4 row_mask:0xf bank_mask:0xf
    v_add_f32_dpp v79, v71, v71 row_ror:4 row_mask:0xf bank_mask:0xf
    v_add_f32_dpp v64, v72, v72 row_ror:8 row_mask:0xf bank_mask:0xf
    v_add_f32_dpp v65, v73, v73 row_ror:8 row_mask:0xf bank_mask:0xf
    v_add_f32_dpp v66, v74, v74 row_ror:8 row_mask:0xf bank_mask:0xf
    v_add_f32_dpp v67, v75, v75 row_ror:8 row_mask:0xf bank_mask:0xf
    v_add_f32_dpp v68, v76, v76 row_ror:8 row_mask:0xf bank_mask:0xf
    v_add_f32_dpp v69, v77, v77 row_ror:8 row_mask:0xf bank_mask:0xf
    v_add_f32_dpp v70, v78, v78 row_ror:8 row_mask:0xf bank_mask:0xf
    v_add_f32_dpp v71, v79, v79 row_ror:8 row_mask:0xf bank_mask:0xf
    s_and_saveexec_b64 s[20:21], vcc
    ds_write_b128 v5, v[64:67]
    ds_write_b128 v5, v[68:71] offset:16
    s_mov_b64 exec, s[20:21]
    v_lshlrev_b32 v5, 2, v0
    v_add_u32 v6, 129600, v5
    v_cmp_gt_u32 vcc, 32, v0
    s_waitcnt lgkmcnt(0)
    s_barrier
    s_and_saveexec_b64 s[20:21], vcc
    s_cbranch_execz attn_kernel_done_15
    ds_read_b32 v20, v6 offset:0
    ds_read_b32 v21, v6 offset:128
    ds_read_b32 v22, v6 offset:256
    ds_read_b32 v23, v6 offset:384
    ds_read_b32 v24, v6 offset:512
    ds_read_b32 v25, v6 offset:640
    ds_read_b32 v26, v6 offset:768
    ds_read_b32 v27, v6 offset:896
    ds_read_b32 v28, v6 offset:1024
    ds_read_b32 v29, v6 offset:1152
    ds_read_b32 v30, v6 offset:1280
    ds_read_b32 v31, v6 offset:1408
    ds_read_b32 v32, v6 offset:1536
    ds_read_b32 v33, v6 offset:1664
    ds_read_b32 v34, v6 offset:1792
    ds_read_b32 v35, v6 offset:1920
    s_sub_u32 s22, s18, 20
    s_cmp_lt_u32 s22, 20
    s_cselect_b32 s23, 1.0, 0
    s_sub_u32 s22, s18, 80
    s_cmp_lt_u32 s22, 20
    s_cselect_b32 s23, 1.0, s23
    s_lshl_b32 s19, s18, 7
    s_cmp_lt_u32 s18, 20
    s_cselect_b32 s22, 0x3e0293ee, 1.0
    v_lshlrev_b32 v7, 1, v0
    s_waitcnt lgkmcnt(0)
    v_add_f32 v20, v20, v28
    v_add_f32 v21, v21, v29
    v_add_f32 v22, v22, v30
    v_add_f32 v23, v23, v31
    v_add_f32 v24, v24, v32
    v_add_f32 v25, v25, v33
    v_add_f32 v26, v26, v34
    v_add_f32 v27, v27, v35
    v_add_f32 v20, v20, v24
    v_add_f32 v21, v21, v25
    v_add_f32 v22, v22, v26
    v_add_f32 v23, v23, v27
    v_add_f32 v20, v20, v22
    v_add_f32 v21, v21, v23
    v_add_f32 v20, v20, v21
    v_cvt_pk_bf16_f32 v20, v20, v20
    v_lshlrev_b32 v20, 16, v20
    v_add_f32 v20, s23, v20
    v_cvt_pk_bf16_f32 v20, v20, v20
    v_lshlrev_b32 v20, 16, v20
    v_mul_f32 v21, s22, v20
    v_cvt_f16_f32 v21, v21
    s_add_u32 s22, s19, 32768
    buffer_store_short v21, v7, s[12:15], s22 offen sc1
    buffer_store_dword v20, v5, s[12:15], s19 offen
    s_branch attn_kernel_done_15
attn_kernel_ln_13:
    v_and_b32 v1, 15, v0
    v_bfe_u32 v2, v0, 4, 2
    v_lshrrev_b32 v3, 6, v0
    v_mul_u32_u24 v4, 1280, v1
    v_mul_u32_u24 v5, 320, v3
    v_add_u32 v4, v4, v5
    v_lshl_add_u32 v4, v2, 4, v4
    s_mul_i32 s19, s16, 20480
    s_waitcnt lgkmcnt(0)
    s_mov_b32 s26, 2621440
    s_mov_b32 s27, 0x00020000
    s_add_u32 s12, s12, 65536
    s_addc_u32 s13, s13, 0
    s_mov_b32 s14, 2621440
    s_mov_b32 s15, 0x00020000
    buffer_load_dwordx4 v[8:11], v4, s[24:27], s19 offen offset:0
    buffer_load_dwordx4 v[12:15], v4, s[24:27], s19 offen offset:64
    buffer_load_dwordx4 v[16:19], v4, s[24:27], s19 offen offset:128
    buffer_load_dwordx4 v[20:23], v4, s[24:27], s19 offen offset:192
    buffer_load_dwordx4 v[24:27], v4, s[24:27], s19 offen offset:256
    s_lshl_b32 s37, s34, 8
    s_add_u32 s44, s74, s37
    s_addc_u32 s45, s75, 0
    s_sub_u32 s46, 5242880, s37
    s_mov_b32 s47, 0x00020000
    s_add_u32 s48, s74, s37
    s_addc_u32 s49, s75, 0
    s_sub_u32 s50, 5242880, s37
    s_mov_b32 s51, 0x00020000
    s_mov_b32 s31, 0
    s_add_u32 m0, s39, 0
    s_nop 0
    buffer_load_dwordx4 v232, s[44:47], s31 offen offset:0 lds
    buffer_load_dwordx4 v233, s[44:47], s31 offen offset:1088 lds
    buffer_load_dwordx4 v234, s[48:51], s31 offen offset:2176 lds
    buffer_load_dwordx4 v235, s[48:51], s31 offen offset:3264 lds
    v_mul_u32_u24 v5, 10240, v3
    v_lshl_add_u32 v5, v2, 9, v5
    v_lshl_add_u32 v5, v1, 4, v5
    s_and_b32 s20, s16, 1
    s_lshl_b32 s20, s20, 8
    s_lshr_b32 s19, s16, 1
    s_mul_i32 s19, s19, 40960
    s_add_u32 s19, s19, s20
    v_lshlrev_b32 v6, 3, v1
    v_add_u32 v6, 129600, v6
    v_lshl_add_u32 v7, v3, 7, v6
    v_mov_b32 v72, 0
    v_mov_b32 v73, 0
    v_mov_b32 v74, 0
    v_mov_b32 v75, 0
    s_waitcnt vmcnt(8)
    v_lshlrev_b32 v32, 16, v8
    v_and_b32 v33, 0xffff0000, v8
    v_pk_add_f32 v[72:73], v[72:73], v[32:33]
    v_pk_fma_f32 v[74:75], v[32:33], v[32:33], v[74:75]
    v_lshlrev_b32 v34, 16, v9
    v_and_b32 v35, 0xffff0000, v9
    v_pk_add_f32 v[72:73], v[72:73], v[34:35]
    v_pk_fma_f32 v[74:75], v[34:35], v[34:35], v[74:75]
    v_lshlrev_b32 v36, 16, v10
    v_and_b32 v37, 0xffff0000, v10
    v_pk_add_f32 v[72:73], v[72:73], v[36:37]
    v_pk_fma_f32 v[74:75], v[36:37], v[36:37], v[74:75]
    v_lshlrev_b32 v38, 16, v11
    v_and_b32 v39, 0xffff0000, v11
    v_pk_add_f32 v[72:73], v[72:73], v[38:39]
    v_pk_fma_f32 v[74:75], v[38:39], v[38:39], v[74:75]
    s_waitcnt vmcnt(7)
    v_lshlrev_b32 v40, 16, v12
    v_and_b32 v41, 0xffff0000, v12
    v_pk_add_f32 v[72:73], v[72:73], v[40:41]
    v_pk_fma_f32 v[74:75], v[40:41], v[40:41], v[74:75]
    v_lshlrev_b32 v42, 16, v13
    v_and_b32 v43, 0xffff0000, v13
    v_pk_add_f32 v[72:73], v[72:73], v[42:43]
    v_pk_fma_f32 v[74:75], v[42:43], v[42:43], v[74:75]
    v_lshlrev_b32 v44, 16, v14
    v_and_b32 v45, 0xffff0000, v14
    v_pk_add_f32 v[72:73], v[72:73], v[44:45]
    v_pk_fma_f32 v[74:75], v[44:45], v[44:45], v[74:75]
    v_lshlrev_b32 v46, 16, v15
    v_and_b32 v47, 0xffff0000, v15
    v_pk_add_f32 v[72:73], v[72:73], v[46:47]
    v_pk_fma_f32 v[74:75], v[46:47], v[46:47], v[74:75]
    s_waitcnt vmcnt(6)
    v_lshlrev_b32 v48, 16, v16
    v_and_b32 v49, 0xffff0000, v16
    v_pk_add_f32 v[72:73], v[72:73], v[48:49]
    v_pk_fma_f32 v[74:75], v[48:49], v[48:49], v[74:75]
    v_lshlrev_b32 v50, 16, v17
    v_and_b32 v51, 0xffff0000, v17
    v_pk_add_f32 v[72:73], v[72:73], v[50:51]
    v_pk_fma_f32 v[74:75], v[50:51], v[50:51], v[74:75]
    v_lshlrev_b32 v52, 16, v18
    v_and_b32 v53, 0xffff0000, v18
    v_pk_add_f32 v[72:73], v[72:73], v[52:53]
    v_pk_fma_f32 v[74:75], v[52:53], v[52:53], v[74:75]
    v_lshlrev_b32 v54, 16, v19
    v_and_b32 v55, 0xffff0000, v19
    v_pk_add_f32 v[72:73], v[72:73], v[54:55]
    v_pk_fma_f32 v[74:75], v[54:55], v[54:55], v[74:75]
    s_waitcnt vmcnt(5)
    v_lshlrev_b32 v56, 16, v20
    v_and_b32 v57, 0xffff0000, v20
    v_pk_add_f32 v[72:73], v[72:73], v[56:57]
    v_pk_fma_f32 v[74:75], v[56:57], v[56:57], v[74:75]
    v_lshlrev_b32 v58, 16, v21
    v_and_b32 v59, 0xffff0000, v21
    v_pk_add_f32 v[72:73], v[72:73], v[58:59]
    v_pk_fma_f32 v[74:75], v[58:59], v[58:59], v[74:75]
    v_lshlrev_b32 v60, 16, v22
    v_and_b32 v61, 0xffff0000, v22
    v_pk_add_f32 v[72:73], v[72:73], v[60:61]
    v_pk_fma_f32 v[74:75], v[60:61], v[60:61], v[74:75]
    v_lshlrev_b32 v62, 16, v23
    v_and_b32 v63, 0xffff0000, v23
    v_pk_add_f32 v[72:73], v[72:73], v[62:63]
    v_pk_fma_f32 v[74:75], v[62:63], v[62:63], v[74:75]
    s_waitcnt vmcnt(4)
    v_lshlrev_b32 v64, 16, v24
    v_and_b32 v65, 0xffff0000, v24
    v_pk_add_f32 v[72:73], v[72:73], v[64:65]
    v_pk_fma_f32 v[74:75], v[64:65], v[64:65], v[74:75]
    v_lshlrev_b32 v66, 16, v25
    v_and_b32 v67, 0xffff0000, v25
    v_pk_add_f32 v[72:73], v[72:73], v[66:67]
    v_pk_fma_f32 v[74:75], v[66:67], v[66:67], v[74:75]
    v_lshlrev_b32 v68, 16, v26
    v_and_b32 v69, 0xffff0000, v26
    v_pk_add_f32 v[72:73], v[72:73], v[68:69]
    v_pk_fma_f32 v[74:75], v[68:69], v[68:69], v[74:75]
    v_lshlrev_b32 v70, 16, v27
    v_and_b32 v71, 0xffff0000, v27
    v_pk_add_f32 v[72:73], v[72:73], v[70:71]
    v_pk_fma_f32 v[74:75], v[70:71], v[70:71], v[74:75]
    v_add_f32 v72, v72, v73
    v_add_f32 v73, v74, v75
    v_mov_b32 v74, v72
    v_mov_b32 v75, v73
    s_nop 0
    v_permlane32_swap_b32 v72, v74
    v_permlane32_swap_b32 v73, v75
    v_add_f32 v72, v72, v74
    v_add_f32 v73, v73, v75
    v_mov_b32 v74, v72
    v_mov_b32 v75, v73
    s_nop 0
    v_permlane16_swap_b32 v72, v74
    v_permlane16_swap_b32 v73, v75
    v_add_f32 v72, v72, v74
    v_add_f32 v73, v73, v75
    ds_write_b64 v7, v[72:73]
    s_waitcnt lgkmcnt(0)
    s_barrier
    ds_read_b64 v[76:77], v6 offset:0
    ds_read_b64 v[78:79], v6 offset:128
    ds_read_b64 v[80:81], v6 offset:256
    ds_read_b64 v[82:83], v6 offset:384
    s_waitcnt lgkmcnt(0)
    v_pk_add_f32 v[76:77], v[76:77], v[78:79]
    v_pk_add_f32 v[80:81], v[80:81], v[82:83]
    v_pk_add_f32 v[76:77], v[76:77], v[80:81]
    v_mul_f32 v76, 0x3acccccd, v76
    v_mul_f32 v77, 0x3acccccd, v77
    v_fma_f32 v77, -v76, v76, v77
    v_max_f32 v77, 0, v77
    v_add_f32 v77, 0x3727c5ac, v77
    v_rsq_f32 v78, v77
    s_nop 0
    v_mul_f32 v78, 0x3e0293ee, v78
    v_mul_f32 v80, -v76, v78
    v_pk_fma_f32 v[32:33], v[32:33], v[78:79], v[80:81] op_sel_hi:[1,0,0]
    v_cvt_pk_f16_f32 v8, v32, v33
    v_pk_fma_f32 v[34:35], v[34:35], v[78:79], v[80:81] op_sel_hi:[1,0,0]
    v_cvt_pk_f16_f32 v9, v34, v35
    v_pk_fma_f32 v[36:37], v[36:37], v[78:79], v[80:81] op_sel_hi:[1,0,0]
    v_cvt_pk_f16_f32 v10, v36, v37
    v_pk_fma_f32 v[38:39], v[38:39], v[78:79], v[80:81] op_sel_hi:[1,0,0]
    v_cvt_pk_f16_f32 v11, v38, v39
    buffer_store_dwordx4 v[8:11], v5, s[12:15], s19 offen sc1
    s_add_u32 s19, s19, 2048
    v_pk_fma_f32 v[40:41], v[40:41], v[78:79], v[80:81] op_sel_hi:[1,0,0]
    v_cvt_pk_f16_f32 v12, v40, v41
    v_pk_fma_f32 v[42:43], v[42:43], v[78:79], v[80:81] op_sel_hi:[1,0,0]
    v_cvt_pk_f16_f32 v13, v42, v43
    v_pk_fma_f32 v[44:45], v[44:45], v[78:79], v[80:81] op_sel_hi:[1,0,0]
    v_cvt_pk_f16_f32 v14, v44, v45
    v_pk_fma_f32 v[46:47], v[46:47], v[78:79], v[80:81] op_sel_hi:[1,0,0]
    v_cvt_pk_f16_f32 v15, v46, v47
    buffer_store_dwordx4 v[12:15], v5, s[12:15], s19 offen sc1
    s_add_u32 s19, s19, 2048
    v_pk_fma_f32 v[48:49], v[48:49], v[78:79], v[80:81] op_sel_hi:[1,0,0]
    v_cvt_pk_f16_f32 v16, v48, v49
    v_pk_fma_f32 v[50:51], v[50:51], v[78:79], v[80:81] op_sel_hi:[1,0,0]
    v_cvt_pk_f16_f32 v17, v50, v51
    v_pk_fma_f32 v[52:53], v[52:53], v[78:79], v[80:81] op_sel_hi:[1,0,0]
    v_cvt_pk_f16_f32 v18, v52, v53
    v_pk_fma_f32 v[54:55], v[54:55], v[78:79], v[80:81] op_sel_hi:[1,0,0]
    v_cvt_pk_f16_f32 v19, v54, v55
    buffer_store_dwordx4 v[16:19], v5, s[12:15], s19 offen sc1
    s_add_u32 s19, s19, 2048
    v_pk_fma_f32 v[56:57], v[56:57], v[78:79], v[80:81] op_sel_hi:[1,0,0]
    v_cvt_pk_f16_f32 v20, v56, v57
    v_pk_fma_f32 v[58:59], v[58:59], v[78:79], v[80:81] op_sel_hi:[1,0,0]
    v_cvt_pk_f16_f32 v21, v58, v59
    v_pk_fma_f32 v[60:61], v[60:61], v[78:79], v[80:81] op_sel_hi:[1,0,0]
    v_cvt_pk_f16_f32 v22, v60, v61
    v_pk_fma_f32 v[62:63], v[62:63], v[78:79], v[80:81] op_sel_hi:[1,0,0]
    v_cvt_pk_f16_f32 v23, v62, v63
    buffer_store_dwordx4 v[20:23], v5, s[12:15], s19 offen sc1
    s_add_u32 s19, s19, 2048
    v_pk_fma_f32 v[64:65], v[64:65], v[78:79], v[80:81] op_sel_hi:[1,0,0]
    v_cvt_pk_f16_f32 v24, v64, v65
    v_pk_fma_f32 v[66:67], v[66:67], v[78:79], v[80:81] op_sel_hi:[1,0,0]
    v_cvt_pk_f16_f32 v25, v66, v67
    v_pk_fma_f32 v[68:69], v[68:69], v[78:79], v[80:81] op_sel_hi:[1,0,0]
    v_cvt_pk_f16_f32 v26, v68, v69
    v_pk_fma_f32 v[70:71], v[70:71], v[78:79], v[80:81] op_sel_hi:[1,0,0]
    v_cvt_pk_f16_f32 v27, v70, v71
    buffer_store_dwordx4 v[24:27], v5, s[12:15], s19 offen sc1
    s_branch attn_kernel_done_15
attn_kernel_none_14:
    s_waitcnt lgkmcnt(0)
    s_lshl_b32 s37, s34, 8
    s_add_u32 s44, s74, s37
    s_addc_u32 s45, s75, 0
    s_sub_u32 s46, 5242880, s37
    s_mov_b32 s47, 0x00020000
    s_add_u32 s48, s74, s37
    s_addc_u32 s49, s75, 0
    s_sub_u32 s50, 5242880, s37
    s_mov_b32 s51, 0x00020000
    s_mov_b32 s31, 0
    s_add_u32 m0, s39, 0
    s_nop 0
    buffer_load_dwordx4 v232, s[44:47], s31 offen offset:0 lds
    buffer_load_dwordx4 v233, s[44:47], s31 offen offset:1088 lds
    buffer_load_dwordx4 v234, s[48:51], s31 offen offset:2176 lds
    buffer_load_dwordx4 v235, s[48:51], s31 offen offset:3264 lds
attn_kernel_done_15:
    s_mov_b64 exec, -1
    s_mov_b32 s58, 256
    s_mov_b32 s59, 0x00020000
    s_lshr_b32 s19, s16, 4
    s_lshl_b32 s19, s19, 3
    s_add_u32 s19, s19, s16
    s_add_u32 s19, s19, 64
    s_cmp_eq_u32 s17, 1
    s_cselect_b32 s19, s19, s18
    s_cselect_b32 s20, 0, s18
    s_cmp_eq_u32 s28, 0
    s_cselect_b32 s20, s20, 40
    v_mov_b32 v6, 1
    v_mov_b32 v7, 0
    s_waitcnt vmcnt(0) lgkmcnt(0)
    s_barrier
    s_cmp_eq_u32 s54, 1
    s_cbranch_scc1 attn_kernel_next_21
    s_cmp_ge_u32 s20, 40
    s_cbranch_scc1 attn_kernel_post_16
    s_mov_b64 exec, 1
    buffer_store_byte v6, v7, s[56:59], s19 offen sc1
    s_mov_b64 exec, -1
attn_kernel_post_16:
    s_load_dwordx2 s[8:9], s[0:1], 8
    s_load_dwordx2 s[12:13], s[0:1], 16
    s_load_dwordx2 s[24:25], s[0:1], 112
    s_load_dwordx2 s[84:85], s[0:1], 32
    s_load_dwordx2 s[88:89], s[0:1], 64
    s_mov_b32 s31, 524288
    s_add_u32 m0, s39, 17920
    s_nop 0
    buffer_load_dwordx4 v232, s[44:47], s31 offen offset:0 lds
    buffer_load_dwordx4 v233, s[44:47], s31 offen offset:1088 lds
    buffer_load_dwordx4 v234, s[48:51], s31 offen offset:2176 lds
    buffer_load_dwordx4 v235, s[48:51], s31 offen offset:3264 lds
    s_mov_b32 s31, 1048576
    s_add_u32 m0, s39, 35840
    s_nop 0
    buffer_load_dwordx4 v232, s[44:47], s31 offen offset:0 lds
    buffer_load_dwordx4 v233, s[44:47], s31 offen offset:1088 lds
    buffer_load_dwordx4 v234, s[48:51], s31 offen offset:2176 lds
    buffer_load_dwordx4 v235, s[48:51], s31 offen offset:3264 lds
    s_mov_b32 s31, 1572864
    s_add_u32 m0, s39, 53760
    s_nop 0
    buffer_load_dwordx4 v232, s[44:47], s31 offen offset:0 lds
    buffer_load_dwordx4 v233, s[44:47], s31 offen offset:1088 lds
    buffer_load_dwordx4 v234, s[48:51], s31 offen offset:2176 lds
    buffer_load_dwordx4 v235, s[48:51], s31 offen offset:3264 lds
    s_mov_b32 s31, 2097152
    s_add_u32 m0, s39, 71680
    s_nop 0
    buffer_load_dwordx4 v232, s[44:47], s31 offen offset:0 lds
    buffer_load_dwordx4 v233, s[44:47], s31 offen offset:1088 lds
    buffer_load_dwordx4 v234, s[48:51], s31 offen offset:2176 lds
    buffer_load_dwordx4 v235, s[48:51], s31 offen offset:3264 lds
    s_mov_b32 s31, 2621440
    s_add_u32 m0, s39, 89600
    s_nop 0
    buffer_load_dwordx4 v232, s[44:47], s31 offen offset:0 lds
    buffer_load_dwordx4 v233, s[44:47], s31 offen offset:1088 lds
    buffer_load_dwordx4 v234, s[48:51], s31 offen offset:2176 lds
    buffer_load_dwordx4 v235, s[48:51], s31 offen offset:3264 lds
    s_mov_b32 s29, 107520
    s_mov_b32 s32, 0
    s_mov_b32 s36, 0
    v_lshrrev_b32 v1, 6, v0
    v_and_b32 v2, 63, v0
    v_lshrrev_b32 v3, 4, v2
    v_and_b32 v4, 15, v2
    v_mov_b32 v255, v0
    v_mul_u32_u24 v5, 81920, v1
    v_lshl_add_u32 v240, v2, 4, v5
    v_add_u32 v241, 40960, v240
    s_waitcnt lgkmcnt(0)
    s_lshl_b32 s38, s34, 19
    s_add_u32 s38, s38, 389120
    s_add_u32 s8, s8, s38
    s_addc_u32 s9, s9, 0
    s_mov_b32 s10, 135168
    s_mov_b32 s11, 0x00020000
    s_add_u32 s12, s12, s38
    s_addc_u32 s13, s13, 0
    s_mov_b32 s14, 135168
    s_mov_b32 s15, 0x00020000
    s_mul_i32 s37, s35, 327680
    s_add_u32 s37, s37, 65536
    s_add_u32 s16, s24, s37
    s_addc_u32 s17, s25, 0
    s_mov_b32 s18, 327680
    s_mov_b32 s19, 0x00020000
    s_mov_b32 s92, s24
    s_mov_b32 s93, s25
    s_add_u32 s24, s24, 32768
    s_addc_u32 s25, s25, 0
    s_mov_b32 s26, 5120
    s_mov_b32 s27, 0x00020000
    s_lshl_b32 s37, s35, 21
    s_add_u32 s37, s37, 4194304
    s_add_u32 s20, s92, s37
    s_addc_u32 s21, s93, 0
    s_mov_b32 s22, 2097152
    s_mov_b32 s23, 0x00020000
    v_lshl_add_u32 v5, v1, 3, v3
    v_lshlrev_b32 v5, 8, v5
    v_xor_b32 v6, v4, v3
    v_lshl_add_u32 v5, v6, 4, v5
    v_add_u32 v236, 4096, v5
    v_add_u32 v237, 4032, v5
    v_lshrrev_b32 v5, 1, v1
    v_lshlrev_b32 v5, 4, v5
    v_lshl_add_u32 v5, v3, 2, v5
    v_and_b32 v6, 1, v1
    v_lshl_add_u32 v5, v6, 1, v5
    v_lshlrev_b32 v5, 8, v5
    v_lshl_add_u32 v5, v4, 4, v5
    v_add_u32 v238, 1920, v5
    v_add_u32 v239, 1088, v5
    v_bfe_u32 v5, v2, 2, 2
    v_and_b32 v6, 3, v2
    v_lshrrev_b32 v7, 5, v2
    v_and_b32 v8, 1, v3
    v_mul_u32_u24 v9, 1088, v5
    v_lshl_add_u32 v9, v7, 9, v9
    v_lshl_add_u32 v9, v8, 5, v9
    v_and_b32 v10, 1, v6
    v_lshl_add_u32 v9, v10, 4, v9
    v_lshrrev_b32 v10, 1, v6
    v_lshl_add_u32 v242, v10, 3, v9
    v_lshrrev_b32 v9, 1, v5
    v_mul_u32_u24 v9, 4480, v9
    v_and_b32 v10, 1, v5
    v_mul_u32_u24 v10, 1088, v10
    v_add3_u32 v9, v9, v10, 0
    v_add_u32 v9, 2176, v9
    v_lshl_add_u32 v9, v7, 8, v9
    v_lshl_add_u32 v9, v8, 5, v9
    v_lshl_add_u32 v245, v6, 3, v9
    v_bfe_u32 v9, v2, 3, 2
    v_mul_u32_u24 v9, 4480, v9
    v_bfe_u32 v10, v2, 2, 1
    v_mul_u32_u24 v10, 1088, v10
    v_add_u32 v9, v9, v10
    v_lshl_add_u32 v9, v6, 8, v9
    v_xor_b32 v10, v7, v6
    v_lshl_add_u32 v243, v10, 4, v9
    v_xor_b32 v10, 2, v10
    v_lshl_add_u32 v244, v10, 4, v9
    v_lshlrev_b32 v250, 5, v7
    v_add_u32 v250, 125440, v250
    v_lshlrev_b32 v9, 19, v1
    v_lshl_add_u32 v9, v8, 10, v9
    v_lshl_add_u32 v9, v7, 8, v9
    v_lshl_add_u32 v251, v4, 4, v9
    s_and_b32 s37, s2, 1
    s_lshl_b32 s37, s37, 2
    s_bfe_u32 s38, s2, 0x20003
    s_add_u32 s86, s37, s38
    s_bfe_u32 s37, s2, 0x20001
    s_lshr_b32 s38, s2, 5
    s_lshl_b32 s99, s38, 2
    s_add_u32 s99, s99, s37
    s_min_u32 s99, s99, 14
    s_lshl_b32 s37, s37, 3
    s_add_u32 s87, s37, s38
    s_mul_i32 s100, s86, 160
    s_mul_i32 s38, s99, 163840
    s_add_u32 s38, s38, s100
    s_add_u32 s88, s88, s38
    s_addc_u32 s89, s89, 0
    s_sub_u32 s90, 2211840, s38
    s_max_i32 s90, s90, 0
    s_mov_b32 s91, 0x00020000
    s_mul_i32 s37, s86, 276480
    s_mul_i32 s38, s99, 20480
    s_sub_u32 s98, 276480, s38
    s_max_i32 s98, s98, 0
    s_mov_b32 s99, 0x00020000
    s_add_u32 s37, s37, s38
    s_add_u32 s37, s37, 52428800
    s_add_u32 s96, s92, s37
    s_addc_u32 s97, s93, 0
    s_lshl_b32 s37, s86, 5
    s_add_u32 s37, s37, s87
    s_mul_i32 s37, s37, 20480
    s_add_u32 s37, s37, 44040192
    s_add_u32 s92, s92, s37
    s_addc_u32 s93, s93, 0
    s_mov_b32 s94, 20480
    s_mov_b32 s95, 0x00020000
    s_mul_i32 s38, s87, 163840
    s_add_u32 s38, s38, s100
    s_add_u32 s84, s84, s38
    s_addc_u32 s85, s85, 0
    s_sub_u32 s86, 5242880, s38
    s_mov_b32 s87, 0x00020000
    s_mov_b32 s100, 4096
    v_and_b32 v252, 63, v255
    v_lshrrev_b32 v253, 6, v255
    v_mul_u32_u24 v253, 320, v253
    v_add_u32 v252, v252, v253
    v_lshlrev_b32 v255, 4, v252
    v_mov_b32 v246, v242
    s_mov_b32 s30, 0
    s_mov_b32 s33, 4
    v_lshlrev_b32 v11, 2, v2
    s_mul_i32 s37, s35, 6
    s_add_u32 s37, s37, 16
    v_subrev_u32 v12, s37, v2
    v_cmp_gt_u32 vcc, 4, v12
    s_nop 1
    v_cndmask_b32 v12, 0, 1, vcc
    v_cmp_gt_u32 vcc, 10, v2
    s_nop 1
    v_cndmask_b32 v12, v12, 1, vcc
    s_mov_b32 s38, 0x01010101
    v_mul_lo_u32 v12, v12, s38
    v_lshrrev_b32 v13, 3, v0
    v_lshlrev_b32 v13, 7, v13
    v_bfe_u32 v14, v0, 1, 2
    v_lshl_add_u32 v13, v14, 4, v13
    v_and_b32 v14, 1, v0
    v_xor_b32 v14, 1, v14
    v_mul_u32_u24 v14, 2560, v14
    v_add_u32 v13, v13, v14
    s_lshl_b32 s37, s28, 2
    s_add_u32 s37, s37, 129552
    v_mov_b32 v15, s37
    v_mov_b32 v16, 129552
    s_lshl_b32 s37, s28, 10
    s_add_u32 m0, s37, 125440
    s_mov_b32 s43, 4000
    v_mov_b32 v17, 0
    s_cmp_eq_u32 s54, 2
    s_cbranch_scc1 attn_kernel_go_18
    s_cmp_lg_u32 s28, 0
    s_cbranch_scc1 attn_kernel_sync_19
    v_cmp_ne_u32 vcc, 0, v12
    s_nop 0
    s_mov_b64 exec, vcc
    s_cmp_eq_u32 s3, 0
    s_cbranch_scc1 attn_kernel_poll_17
    s_sleep 48
attn_kernel_poll_17:
    buffer_load_dword v14, v11, s[56:59], 0 offen sc0 sc1
    s_sub_u32 s43, s43, 1
    s_waitcnt vmcnt(0)
    v_cmp_ne_u32 vcc, v14, v12
    s_nop 0
    s_and_b64 exec, vcc, vcc
    s_cbranch_scc0 attn_kernel_no1_23
    s_sleep 16
    s_cmp_gt_i32 s43, 0
    s_cbranch_scc1 attn_kernel_poll_17
    s_mov_b64 exec, -1
    v_mov_b32 v17, 1
attn_kernel_no1_23:
    s_mov_b64 exec, -1
    ds_write_b32 v16, v17
    s_waitcnt lgkmcnt(0)
attn_kernel_sync_19:
    s_barrier
    ds_read_b32 v20, v16
    s_waitcnt lgkmcnt(0)
    v_readfirstlane_b32 s37, v20
    s_nop 0
    s_cmp_lg_u32 s37, 0
    s_cbranch_scc1 attn_kernel_redo_20
attn_kernel_go_18:
    buffer_load_dwordx4 v13, s[24:27], 0 offen lds
    buffer_load_dwordx4 v[128:131], v240, s[16:19], s32 offen offset:0
    buffer_load_dwordx4 v[132:135], v241, s[16:19], s32 offen offset:0
    buffer_load_dwordx4 v[136:139], v240, s[16:19], s32 offen offset:1024
    buffer_load_dwordx4 v[140:143], v241, s[16:19], s32 offen offset:1024
    buffer_load_dwordx4 v[144:147], v240, s[16:19], s32 offen offset:2048
    buffer_load_dwordx4 v[148:151], v241, s[16:19], s32 offen offset:2048
    buffer_load_dwordx4 v[152:155], v240, s[16:19], s32 offen offset:3072
    buffer_load_dwordx4 v[156:159], v241, s[16:19], s32 offen offset:3072
    ds_read_b64_tr_b16 a[128:129], v246 offset:0
    ds_read_b64_tr_b16 a[130:131], v246 offset:256
    ds_read_b64_tr_b16 a[132:133], v246 offset:64
    ds_read_b64_tr_b16 a[134:135], v246 offset:320
    ds_read_b64_tr_b16 a[136:137], v246 offset:128
    ds_read_b64_tr_b16 a[138:139], v246 offset:384
    ds_read_b64_tr_b16 a[140:141], v246 offset:192
    ds_read_b64_tr_b16 a[142:143], v246 offset:448
    s_waitcnt vmcnt(8)
    s_barrier
    ds_read_b128 v[208:211], v250 offset:0
    ds_read_b128 v[212:215], v250 offset:16
    ds_read_b128 v[216:219], v250 offset:64
    ds_read_b128 v[220:223], v250 offset:80
    s_waitcnt vmcnt(7) lgkmcnt(2)
    v_fma_mix_f32 v224, v128, v208, v212 op_sel:[0,0,0] op_sel_hi:[1,1,1]
    v_fma_mix_f32 v225, v128, v208, v212 op_sel:[1,1,1] op_sel_hi:[1,1,1]
    v_fma_mix_f32 v226, v129, v209, v213 op_sel:[0,0,0] op_sel_hi:[1,1,1]
    v_fma_mix_f32 v227, v129, v209, v213 op_sel:[1,1,1] op_sel_hi:[1,1,1]
    v_cvt_pk_bf16_f32 v192, v224, v225
    v_fma_mix_f32 v228, v130, v210, v214 op_sel:[0,0,0] op_sel_hi:[1,1,1]
    v_fma_mix_f32 v229, v130, v210, v214 op_sel:[1,1,1] op_sel_hi:[1,1,1]
    v_cvt_pk_bf16_f32 v193, v226, v227
    v_fma_mix_f32 v230, v131, v211, v215 op_sel:[0,0,0] op_sel_hi:[1,1,1]
    v_fma_mix_f32 v231, v131, v211, v215 op_sel:[1,1,1] op_sel_hi:[1,1,1]
    v_cvt_pk_bf16_f32 v194, v228, v229
    s_waitcnt vmcnt(6)
    v_fma_mix_f32 v224, v132, v208, v212 op_sel:[0,0,0] op_sel_hi:[1,1,1]
    v_fma_mix_f32 v225, v132, v208, v212 op_sel:[1,1,1] op_sel_hi:[1,1,1]
    v_cvt_pk_bf16_f32 v195, v230, v231
    v_fma_mix_f32 v226, v133, v209, v213 op_sel:[0,0,0] op_sel_hi:[1,1,1]
    v_fma_mix_f32 v227, v133, v209, v213 op_sel:[1,1,1] op_sel_hi:[1,1,1]
    v_cvt_pk_bf16_f32 v196, v224, v225
    v_fma_mix_f32 v228, v134, v210, v214 op_sel:[0,0,0] op_sel_hi:[1,1,1]
    v_fma_mix_f32 v229, v134, v210, v214 op_sel:[1,1,1] op_sel_hi:[1,1,1]
    v_cvt_pk_bf16_f32 v197, v226, v227
    v_fma_mix_f32 v230, v135, v211, v215 op_sel:[0,0,0] op_sel_hi:[1,1,1]
    v_fma_mix_f32 v231, v135, v211, v215 op_sel:[1,1,1] op_sel_hi:[1,1,1]
    v_cvt_pk_bf16_f32 v198, v228, v229
    v_cvt_pk_bf16_f32 v199, v230, v231
    s_waitcnt vmcnt(4) lgkmcnt(0)
    v_mfma_f32_32x32x16_bf16 v[0:15], a[128:131], v[192:195], 0
    ds_read_b128 v[208:211], v250 offset:128
    ds_read_b128 v[212:215], v250 offset:144
    v_fma_mix_f32 v224, v136, v216, v220 op_sel:[0,0,0] op_sel_hi:[1,1,1]
    v_fma_mix_f32 v225, v136, v216, v220 op_sel:[1,1,1] op_sel_hi:[1,1,1]
    v_fma_mix_f32 v226, v137, v217, v221 op_sel:[0,0,0] op_sel_hi:[1,1,1]
    v_mfma_f32_32x32x16_bf16 v[64:79], a[128:131], v[196:199], 0
    ds_read_b64_tr_b16 a[144:145], v246 offset:4480
    ds_read_b64_tr_b16 a[146:147], v246 offset:4736
    v_fma_mix_f32 v227, v137, v217, v221 op_sel:[1,1,1] op_sel_hi:[1,1,1]
    v_cvt_pk_bf16_f32 v200, v224, v225
    v_fma_mix_f32 v228, v138, v218, v222 op_sel:[0,0,0] op_sel_hi:[1,1,1]
    v_mfma_f32_32x32x16_bf16 v[16:31], a[132:135], v[192:195], 0
    ds_read_b64_tr_b16 a[148:149], v246 offset:4544
    ds_read_b64_tr_b16 a[150:151], v246 offset:4800
    v_fma_mix_f32 v229, v138, v218, v222 op_sel:[1,1,1] op_sel_hi:[1,1,1]
    v_cvt_pk_bf16_f32 v201, v226, v227
    v_fma_mix_f32 v230, v139, v219, v223 op_sel:[0,0,0] op_sel_hi:[1,1,1]
    v_mfma_f32_32x32x16_bf16 v[80:95], a[132:135], v[196:199], 0
    ds_read_b64_tr_b16 a[152:153], v246 offset:4608
    ds_read_b64_tr_b16 a[154:155], v246 offset:4864
    s_add_u32 s32, s32, 4096
    buffer_load_dwordx4 v[160:163], v240, s[16:19], s32 offen offset:0
    v_fma_mix_f32 v231, v139, v219, v223 op_sel:[1,1,1] op_sel_hi:[1,1,1]
    v_mfma_f32_32x32x16_bf16 v[32:47], a[136:139], v[192:195], 0
    ds_read_b64_tr_b16 a[156:157], v246 offset:4672
    ds_read_b64_tr_b16 a[158:159], v246 offset:4928
    buffer_load_dwordx4 v[164:167], v241, s[16:19], s32 offen offset:0
    v_cvt_pk_bf16_f32 v202, v228, v229
    v_mfma_f32_32x32x16_bf16 v[96:111], a[136:139], v[196:199], 0
    buffer_load_dwordx4 v[168:171], v240, s[16:19], s32 offen offset:1024
    v_fma_mix_f32 v224, v140, v216, v220 op_sel:[0,0,0] op_sel_hi:[1,1,1]
    v_fma_mix_f32 v225, v140, v216, v220 op_sel:[1,1,1] op_sel_hi:[1,1,1]
    v_cvt_pk_bf16_f32 v203, v230, v231
    v_fma_mix_f32 v226, v141, v217, v221 op_sel:[0,0,0] op_sel_hi:[1,1,1]
    v_mfma_f32_32x32x16_bf16 v[48:63], a[140:143], v[192:195], 0
    buffer_load_dwordx4 v[172:175], v241, s[16:19], s32 offen offset:1024
    v_fma_mix_f32 v227, v141, v217, v221 op_sel:[1,1,1] op_sel_hi:[1,1,1]
    v_cvt_pk_bf16_f32 v204, v224, v225
    v_fma_mix_f32 v228, v142, v218, v222 op_sel:[0,0,0] op_sel_hi:[1,1,1]
    v_fma_mix_f32 v229, v142, v218, v222 op_sel:[1,1,1] op_sel_hi:[1,1,1]
    v_mfma_f32_32x32x16_bf16 v[112:127], a[140:143], v[196:199], 0
    v_cvt_pk_bf16_f32 v205, v226, v227
    v_fma_mix_f32 v230, v143, v219, v223 op_sel:[0,0,0] op_sel_hi:[1,1,1]
    v_fma_mix_f32 v231, v143, v219, v223 op_sel:[1,1,1] op_sel_hi:[1,1,1]
    v_cvt_pk_bf16_f32 v206, v228, v229
    v_cvt_pk_bf16_f32 v207, v230, v231
    s_waitcnt vmcnt(6) lgkmcnt(0)
    v_mfma_f32_32x32x16_bf16 v[0:15], a[144:147], v[200:203], v[0:15]
    ds_read_b128 v[216:219], v250 offset:192
    ds_read_b128 v[220:223], v250 offset:208
    v_fma_mix_f32 v224, v144, v208, v212 op_sel:[0,0,0] op_sel_hi:[1,1,1]
    v_fma_mix_f32 v225, v144, v208, v212 op_sel:[1,1,1] op_sel_hi:[1,1,1]
    v_fma_mix_f32 v226, v145, v209, v213 op_sel:[0,0,0] op_sel_hi:[1,1,1]
    v_mfma_f32_32x32x16_bf16 v[64:79], a[144:147], v[204:207], v[64:79]
    ds_read_b64_tr_b16 a[128:129], v246 offset:8960
    ds_read_b64_tr_b16 a[130:131], v246 offset:9216
    v_fma_mix_f32 v227, v145, v209, v213 op_sel:[1,1,1] op_sel_hi:[1,1,1]
    v_cvt_pk_bf16_f32 v192, v224, v225
    v_fma_mix_f32 v228, v146, v210, v214 op_sel:[0,0,0] op_sel_hi:[1,1,1]
    v_mfma_f32_32x32x16_bf16 v[16:31], a[148:151], v[200:203], v[16:31]
    ds_read_b64_tr_b16 a[132:133], v246 offset:9024
    ds_read_b64_tr_b16 a[134:135], v246 offset:9280
    v_fma_mix_f32 v229, v146, v210, v214 op_sel:[1,1,1] op_sel_hi:[1,1,1]
    v_cvt_pk_bf16_f32 v193, v226, v227
    v_mfma_f32_32x32x16_bf16 v[80:95], a[148:151], v[204:207], v[80:95]
    ds_read_b64_tr_b16 a[136:137], v246 offset:9088
    ds_read_b64_tr_b16 a[138:139], v246 offset:9344
    buffer_load_dwordx4 v[176:179], v240, s[16:19], s32 offen offset:2048
    v_fma_mix_f32 v230, v147, v211, v215 op_sel:[0,0,0] op_sel_hi:[1,1,1]
    v_fma_mix_f32 v231, v147, v211, v215 op_sel:[1,1,1] op_sel_hi:[1,1,1]
    v_mfma_f32_32x32x16_bf16 v[32:47], a[152:155], v[200:203], v[32:47]
    ds_read_b64_tr_b16 a[140:141], v246 offset:9152
    ds_read_b64_tr_b16 a[142:143], v246 offset:9408
    buffer_load_dwordx4 v[180:183], v241, s[16:19], s32 offen offset:2048
    v_cvt_pk_bf16_f32 v194, v228, v229
    v_fma_mix_f32 v224, v148, v208, v212 op_sel:[0,0,0] op_sel_hi:[1,1,1]
    v_mfma_f32_32x32x16_bf16 v[96:111], a[152:155], v[204:207], v[96:111]
    buffer_load_dwordx4 v[184:187], v240, s[16:19], s32 offen offset:3072
    v_fma_mix_f32 v225, v148, v208, v212 op_sel:[1,1,1] op_sel_hi:[1,1,1]
    v_cvt_pk_bf16_f32 v195, v230, v231
    v_fma_mix_f32 v226, v149, v209, v213 op_sel:[0,0,0] op_sel_hi:[1,1,1]
    v_fma_mix_f32 v227, v149, v209, v213 op_sel:[1,1,1] op_sel_hi:[1,1,1]
    v_mfma_f32_32x32x16_bf16 v[48:63], a[156:159], v[200:203], v[48:63]
    buffer_load_dwordx4 v[188:191], v241, s[16:19], s32 offen offset:3072
    v_cvt_pk_bf16_f32 v196, v224, v225
    v_fma_mix_f32 v228, v150, v210, v214 op_sel:[0,0,0] op_sel_hi:[1,1,1]
    v_fma_mix_f32 v229, v150, v210, v214 op_sel:[1,1,1] op_sel_hi:[1,1,1]
    v_mfma_f32_32x32x16_bf16 v[112:127], a[156:159], v[204:207], v[112:127]
    v_cvt_pk_bf16_f32 v197, v226, v227
    v_fma_mix_f32 v230, v151, v211, v215 op_sel:[0,0,0] op_sel_hi:[1,1,1]
    v_fma_mix_f32 v231, v151, v211, v215 op_sel:[1,1,1] op_sel_hi:[1,1,1]
    v_cvt_pk_bf16_f32 v198, v228, v229
    v_cvt_pk_bf16_f32 v199, v230, v231
    s_waitcnt vmcnt(8) lgkmcnt(0)
    v_mfma_f32_32x32x16_bf16 v[0:15], a[128:131], v[192:195], v[0:15]
    ds_read_b128 v[208:211], v250 offset:256
    ds_read_b128 v[212:215], v250 offset:272
    v_fma_mix_f32 v224, v152, v216, v220 op_sel:[0,0,0] op_sel_hi:[1,1,1]
    v_fma_mix_f32 v225, v152, v216, v220 op_sel:[1,1,1] op_sel_hi:[1,1,1]
    v_fma_mix_f32 v226, v153, v217, v221 op_sel:[0,0,0] op_sel_hi:[1,1,1]
    v_mfma_f32_32x32x16_bf16 v[64:79], a[128:131], v[196:199], v[64:79]
    ds_read_b64_tr_b16 a[144:145], v246 offset:13440
    ds_read_b64_tr_b16 a[146:147], v246 offset:13696
    v_fma_mix_f32 v227, v153, v217, v221 op_sel:[1,1,1] op_sel_hi:[1,1,1]
    v_cvt_pk_bf16_f32 v200, v224, v225
    v_fma_mix_f32 v228, v154, v218, v222 op_sel:[0,0,0] op_sel_hi:[1,1,1]
    v_fma_mix_f32 v229, v154, v218, v222 op_sel:[1,1,1] op_sel_hi:[1,1,1]
    v_mfma_f32_32x32x16_bf16 v[16:31], a[132:135], v[192:195], v[16:31]
    s_add_u32 s30, s30, 17920
    s_cmp_ge_u32 s30, 125440
    s_cselect_b32 s38, 125440, 0
    s_sub_u32 s30, s30, s38
    ds_read_b64_tr_b16 a[148:149], v246 offset:13504
    ds_read_b64_tr_b16 a[150:151], v246 offset:13760
    v_mfma_f32_32x32x16_bf16 v[80:95], a[132:135], v[196:199], v[80:95]
    ds_read_b64_tr_b16 a[152:153], v246 offset:13568
    ds_read_b64_tr_b16 a[154:155], v246 offset:13824
    s_add_u32 s32, s32, 4096
    buffer_load_dwordx4 v[128:131], v240, s[16:19], s32 offen offset:0
    v_cvt_pk_bf16_f32 v201, v226, v227
    v_mfma_f32_32x32x16_bf16 v[32:47], a[136:139], v[192:195], v[32:47]
    ds_read_b64_tr_b16 a[156:157], v246 offset:13632
    ds_read_b64_tr_b16 a[158:159], v246 offset:13888
    buffer_load_dwordx4 v[132:135], v241, s[16:19], s32 offen offset:0
    v_fma_mix_f32 v230, v155, v219, v223 op_sel:[0,0,0] op_sel_hi:[1,1,1]
    v_fma_mix_f32 v231, v155, v219, v223 op_sel:[1,1,1] op_sel_hi:[1,1,1]
    v_mfma_f32_32x32x16_bf16 v[96:111], a[136:139], v[196:199], v[96:111]
    buffer_load_dwordx4 v[136:139], v240, s[16:19], s32 offen offset:1024
    v_cvt_pk_bf16_f32 v202, v228, v229
    v_fma_mix_f32 v224, v156, v216, v220 op_sel:[0,0,0] op_sel_hi:[1,1,1]
    v_fma_mix_f32 v225, v156, v216, v220 op_sel:[1,1,1] op_sel_hi:[1,1,1]
    v_cvt_pk_bf16_f32 v203, v230, v231
    v_mfma_f32_32x32x16_bf16 v[48:63], a[140:143], v[192:195], v[48:63]
    buffer_load_dwordx4 v[140:143], v241, s[16:19], s32 offen offset:1024
    v_fma_mix_f32 v226, v157, v217, v221 op_sel:[0,0,0] op_sel_hi:[1,1,1]
    v_fma_mix_f32 v227, v157, v217, v221 op_sel:[1,1,1] op_sel_hi:[1,1,1]
    v_cvt_pk_bf16_f32 v204, v224, v225
    v_fma_mix_f32 v228, v158, v218, v222 op_sel:[0,0,0] op_sel_hi:[1,1,1]
    v_fma_mix_f32 v229, v158, v218, v222 op_sel:[1,1,1] op_sel_hi:[1,1,1]
    v_mfma_f32_32x32x16_bf16 v[112:127], a[140:143], v[196:199], v[112:127]
    v_cvt_pk_bf16_f32 v205, v226, v227
    v_fma_mix_f32 v230, v159, v219, v223 op_sel:[0,0,0] op_sel_hi:[1,1,1]
    v_fma_mix_f32 v231, v159, v219, v223 op_sel:[1,1,1] op_sel_hi:[1,1,1]
    v_cvt_pk_bf16_f32 v206, v228, v229
    v_cvt_pk_bf16_f32 v207, v230, v231
    s_waitcnt vmcnt(10) lgkmcnt(0)
    v_mfma_f32_32x32x16_bf16 v[0:15], a[144:147], v[200:203], v[0:15]
    ds_read_b128 v[216:219], v250 offset:320
    ds_read_b128 v[220:223], v250 offset:336
    s_barrier
    v_add_u32 v246, s30, v242
    v_mfma_f32_32x32x16_bf16 v[64:79], a[144:147], v[204:207], v[64:79]
    ds_read_b64_tr_b16 a[128:129], v246 offset:0
    ds_read_b64_tr_b16 a[130:131], v246 offset:256
    v_fma_mix_f32 v224, v160, v208, v212 op_sel:[0,0,0] op_sel_hi:[1,1,1]
    v_fma_mix_f32 v225, v160, v208, v212 op_sel:[1,1,1] op_sel_hi:[1,1,1]
    v_fma_mix_f32 v226, v161, v209, v213 op_sel:[0,0,0] op_sel_hi:[1,1,1]
    v_mfma_f32_32x32x16_bf16 v[16:31], a[148:151], v[200:203], v[16:31]
    ds_read_b64_tr_b16 a[132:133], v246 offset:64
    ds_read_b64_tr_b16 a[134:135], v246 offset:320
    v_fma_mix_f32 v227, v161, v209, v213 op_sel:[1,1,1] op_sel_hi:[1,1,1]
    v_cvt_pk_bf16_f32 v192, v224, v225
    v_fma_mix_f32 v228, v162, v210, v214 op_sel:[0,0,0] op_sel_hi:[1,1,1]
    v_mfma_f32_32x32x16_bf16 v[80:95], a[148:151], v[204:207], v[80:95]
    ds_read_b64_tr_b16 a[136:137], v246 offset:128
    ds_read_b64_tr_b16 a[138:139], v246 offset:384
    buffer_load_dwordx4 v[144:147], v240, s[16:19], s32 offen offset:2048
    v_fma_mix_f32 v229, v162, v210, v214 op_sel:[1,1,1] op_sel_hi:[1,1,1]
    v_cvt_pk_bf16_f32 v193, v226, v227
    v_fma_mix_f32 v230, v163, v211, v215 op_sel:[0,0,0] op_sel_hi:[1,1,1]
    v_mfma_f32_32x32x16_bf16 v[32:47], a[152:155], v[200:203], v[32:47]
    ds_read_b64_tr_b16 a[140:141], v246 offset:192
    ds_read_b64_tr_b16 a[142:143], v246 offset:448
    buffer_load_dwordx4 v[148:151], v241, s[16:19], s32 offen offset:2048
    v_fma_mix_f32 v231, v163, v211, v215 op_sel:[1,1,1] op_sel_hi:[1,1,1]
    v_cvt_pk_bf16_f32 v194, v228, v229
    v_mfma_f32_32x32x16_bf16 v[96:111], a[152:155], v[204:207], v[96:111]
    buffer_load_dwordx4 v[152:155], v240, s[16:19], s32 offen offset:3072
    v_fma_mix_f32 v224, v164, v208, v212 op_sel:[0,0,0] op_sel_hi:[1,1,1]
    v_fma_mix_f32 v225, v164, v208, v212 op_sel:[1,1,1] op_sel_hi:[1,1,1]
    v_cvt_pk_bf16_f32 v195, v230, v231
    v_fma_mix_f32 v226, v165, v209, v213 op_sel:[0,0,0] op_sel_hi:[1,1,1]
    v_mfma_f32_32x32x16_bf16 v[48:63], a[156:159], v[200:203], v[48:63]
    buffer_load_dwordx4 v[156:159], v241, s[16:19], s32 offen offset:3072
    v_fma_mix_f32 v227, v165, v209, v213 op_sel:[1,1,1] op_sel_hi:[1,1,1]
    v_cvt_pk_bf16_f32 v196, v224, v225
    v_fma_mix_f32 v228, v166, v210, v214 op_sel:[0,0,0] op_sel_hi:[1,1,1]
    v_fma_mix_f32 v229, v166, v210, v214 op_sel:[1,1,1] op_sel_hi:[1,1,1]
    v_mfma_f32_32x32x16_bf16 v[112:127], a[156:159], v[204:207], v[112:127]
    v_cvt_pk_bf16_f32 v197, v226, v227
    v_fma_mix_f32 v230, v167, v211, v215 op_sel:[0,0,0] op_sel_hi:[1,1,1]
    v_fma_mix_f32 v231, v167, v211, v215 op_sel:[1,1,1] op_sel_hi:[1,1,1]
    v_cvt_pk_bf16_f32 v198, v228, v229
    v_cvt_pk_bf16_f32 v199, v230, v231
    s_waitcnt vmcnt(12) lgkmcnt(0)
    v_mfma_f32_32x32x16_bf16 v[0:15], a[128:131], v[192:195], v[0:15]
    ds_read_b128 v[208:211], v250 offset:384
    ds_read_b128 v[212:215], v250 offset:400
    v_fma_mix_f32 v224, v168, v216, v220 op_sel:[0,0,0] op_sel_hi:[1,1,1]
    v_fma_mix_f32 v225, v168, v216, v220 op_sel:[1,1,1] op_sel_hi:[1,1,1]
    v_fma_mix_f32 v226, v169, v217, v221 op_sel:[0,0,0] op_sel_hi:[1,1,1]
    v_mfma_f32_32x32x16_bf16 v[64:79], a[128:131], v[196:199], v[64:79]
    ds_read_b64_tr_b16 a[144:145], v246 offset:4480
    ds_read_b64_tr_b16 a[146:147], v246 offset:4736
    v_fma_mix_f32 v227, v169, v217, v221 op_sel:[1,1,1] op_sel_hi:[1,1,1]
    v_cvt_pk_bf16_f32 v200, v224, v225
    v_mfma_f32_32x32x16_bf16 v[16:31], a[132:135], v[192:195], v[16:31]
    ds_read_b64_tr_b16 a[148:149], v246 offset:4544
    ds_read_b64_tr_b16 a[150:151], v246 offset:4800
    v_fma_mix_f32 v228, v170, v218, v222 op_sel:[0,0,0] op_sel_hi:[1,1,1]
    v_fma_mix_f32 v229, v170, v218, v222 op_sel:[1,1,1] op_sel_hi:[1,1,1]
    v_cvt_pk_bf16_f32 v201, v226, v227
    v_mfma_f32_32x32x16_bf16 v[80:95], a[132:135], v[196:199], v[80:95]
    ds_read_b64_tr_b16 a[152:153], v246 offset:4608
    ds_read_b64_tr_b16 a[154:155], v246 offset:4864
    s_add_u32 s32, s32, 4096
    buffer_load_dwordx4 v[160:163], v240, s[16:19], s32 offen offset:0
    v_fma_mix_f32 v230, v171, v219, v223 op_sel:[0,0,0] op_sel_hi:[1,1,1]
    v_mfma_f32_32x32x16_bf16 v[32:47], a[136:139], v[192:195], v[32:47]
    ds_read_b64_tr_b16 a[156:157], v246 offset:4672
    ds_read_b64_tr_b16 a[158:159], v246 offset:4928
    buffer_load_dwordx4 v[164:167], v241, s[16:19], s32 offen offset:0
    v_fma_mix_f32 v231, v171, v219, v223 op_sel:[1,1,1] op_sel_hi:[1,1,1]
    v_mfma_f32_32x32x16_bf16 v[96:111], a[136:139], v[196:199], v[96:111]
    v_cvt_pk_bf16_f32 v202, v228, v229
    v_fma_mix_f32 v224, v172, v216, v220 op_sel:[0,0,0] op_sel_hi:[1,1,1]
    v_fma_mix_f32 v225, v172, v216, v220 op_sel:[1,1,1] op_sel_hi:[1,1,1]
    v_cvt_pk_bf16_f32 v203, v230, v231
    v_fma_mix_f32 v226, v173, v217, v221 op_sel:[0,0,0] op_sel_hi:[1,1,1]
    v_mfma_f32_32x32x16_bf16 v[48:63], a[140:143], v[192:195], v[48:63]
    v_fma_mix_f32 v227, v173, v217, v221 op_sel:[1,1,1] op_sel_hi:[1,1,1]
    v_cvt_pk_bf16_f32 v204, v224, v225
    v_fma_mix_f32 v228, v174, v218, v222 op_sel:[0,0,0] op_sel_hi:[1,1,1]
    v_fma_mix_f32 v229, v174, v218, v222 op_sel:[1,1,1] op_sel_hi:[1,1,1]
    v_mfma_f32_32x32x16_bf16 v[112:127], a[140:143], v[196:199], v[112:127]
    v_cvt_pk_bf16_f32 v205, v226, v227
    v_fma_mix_f32 v230, v175, v219, v223 op_sel:[0,0,0] op_sel_hi:[1,1,1]
    v_fma_mix_f32 v231, v175, v219, v223 op_sel:[1,1,1] op_sel_hi:[1,1,1]
    v_cvt_pk_bf16_f32 v206, v228, v229
    v_cvt_pk_bf16_f32 v207, v230, v231
    s_waitcnt vmcnt(12) lgkmcnt(0)
    v_mfma_f32_32x32x16_bf16 v[0:15], a[144:147], v[200:203], v[0:15]
    ds_read_b128 v[216:219], v250 offset:448
    ds_read_b128 v[220:223], v250 offset:464
    v_fma_mix_f32 v224, v176, v208, v212 op_sel:[0,0,0] op_sel_hi:[1,1,1]
    v_fma_mix_f32 v225, v176, v208, v212 op_sel:[1,1,1] op_sel_hi:[1,1,1]
    v_fma_mix_f32 v226, v177, v209, v213 op_sel:[0,0,0] op_sel_hi:[1,1,1]
    v_mfma_f32_32x32x16_bf16 v[64:79], a[144:147], v[204:207], v[64:79]
    ds_read_b64_tr_b16 a[128:129], v246 offset:8960
    ds_read_b64_tr_b16 a[130:131], v246 offset:9216
    v_fma_mix_f32 v227, v177, v209, v213 op_sel:[1,1,1] op_sel_hi:[1,1,1]
    v_cvt_pk_bf16_f32 v192, v224, v225
    v_mfma_f32_32x32x16_bf16 v[16:31], a[148:151], v[200:203], v[16:31]
    ds_read_b64_tr_b16 a[132:133], v246 offset:9024
    ds_read_b64_tr_b16 a[134:135], v246 offset:9280
    v_fma_mix_f32 v228, v178, v210, v214 op_sel:[0,0,0] op_sel_hi:[1,1,1]
    v_fma_mix_f32 v229, v178, v210, v214 op_sel:[1,1,1] op_sel_hi:[1,1,1]
    v_cvt_pk_bf16_f32 v193, v226, v227
    v_mfma_f32_32x32x16_bf16 v[80:95], a[148:151], v[204:207], v[80:95]
    ds_read_b64_tr_b16 a[136:137], v246 offset:9088
    ds_read_b64_tr_b16 a[138:139], v246 offset:9344
    buffer_load_dwordx4 v[168:171], v240, s[16:19], s32 offen offset:1024
    v_fma_mix_f32 v230, v179, v211, v215 op_sel:[0,0,0] op_sel_hi:[1,1,1]
    v_mfma_f32_32x32x16_bf16 v[32:47], a[152:155], v[200:203], v[32:47]
    ds_read_b64_tr_b16 a[140:141], v246 offset:9152
    ds_read_b64_tr_b16 a[142:143], v246 offset:9408
    buffer_load_dwordx4 v[172:175], v241, s[16:19], s32 offen offset:1024
    v_fma_mix_f32 v231, v179, v211, v215 op_sel:[1,1,1] op_sel_hi:[1,1,1]
    v_cvt_pk_bf16_f32 v194, v228, v229
    v_mfma_f32_32x32x16_bf16 v[96:111], a[152:155], v[204:207], v[96:111]
    v_fma_mix_f32 v224, v180, v208, v212 op_sel:[0,0,0] op_sel_hi:[1,1,1]
    v_fma_mix_f32 v225, v180, v208, v212 op_sel:[1,1,1] op_sel_hi:[1,1,1]
    v_cvt_pk_bf16_f32 v195, v230, v231
    v_fma_mix_f32 v226, v181, v209, v213 op_sel:[0,0,0] op_sel_hi:[1,1,1]
    v_mfma_f32_32x32x16_bf16 v[48:63], a[156:159], v[200:203], v[48:63]
    v_fma_mix_f32 v227, v181, v209, v213 op_sel:[1,1,1] op_sel_hi:[1,1,1]
    v_cvt_pk_bf16_f32 v196, v224, v225
    v_fma_mix_f32 v228, v182, v210, v214 op_sel:[0,0,0] op_sel_hi:[1,1,1]
    v_fma_mix_f32 v229, v182, v210, v214 op_sel:[1,1,1] op_sel_hi:[1,1,1]
    v_cvt_pk_bf16_f32 v197, v226, v227
    v_mfma_f32_32x32x16_bf16 v[112:127], a[156:159], v[204:207], v[112:127]
    v_fma_mix_f32 v230, v183, v211, v215 op_sel:[0,0,0] op_sel_hi:[1,1,1]
    v_fma_mix_f32 v231, v183, v211, v215 op_sel:[1,1,1] op_sel_hi:[1,1,1]
    v_cvt_pk_bf16_f32 v198, v228, v229
    v_cvt_pk_bf16_f32 v199, v230, v231
    s_waitcnt vmcnt(12) lgkmcnt(0)
    v_mfma_f32_32x32x16_bf16 v[0:15], a[128:131], v[192:195], v[0:15]
    v_add_u32 v250, 512, v250
    ds_read_b128 v[208:211], v250 offset:0
    ds_read_b128 v[212:215], v250 offset:16
    v_fma_mix_f32 v224, v184, v216, v220 op_sel:[0,0,0] op_sel_hi:[1,1,1]
    v_fma_mix_f32 v225, v184, v216, v220 op_sel:[1,1,1] op_sel_hi:[1,1,1]
    v_mfma_f32_32x32x16_bf16 v[64:79], a[128:131], v[196:199], v[64:79]
    ds_read_b64_tr_b16 a[144:145], v246 offset:13440
    ds_read_b64_tr_b16 a[146:147], v246 offset:13696
    v_fma_mix_f32 v226, v185, v217, v221 op_sel:[0,0,0] op_sel_hi:[1,1,1]
    v_fma_mix_f32 v227, v185, v217, v221 op_sel:[1,1,1] op_sel_hi:[1,1,1]
    v_cvt_pk_bf16_f32 v200, v224, v225
    v_mfma_f32_32x32x16_bf16 v[16:31], a[132:135], v[192:195], v[16:31]
    s_add_u32 s30, s30, 17920
    s_cmp_ge_u32 s30, 125440
    s_cselect_b32 s38, 125440, 0
    s_sub_u32 s30, s30, s38
    ds_read_b64_tr_b16 a[148:149], v246 offset:13504
    ds_read_b64_tr_b16 a[150:151], v246 offset:13760
    v_mfma_f32_32x32x16_bf16 v[80:95], a[132:135], v[196:199], v[80:95]
    ds_read_b64_tr_b16 a[152:153], v246 offset:13568
    ds_read_b64_tr_b16 a[154:155], v246 offset:13824
    buffer_load_dwordx4 v[176:179], v240, s[16:19], s32 offen offset:2048
    v_fma_mix_f32 v228, v186, v218, v222 op_sel:[0,0,0] op_sel_hi:[1,1,1]
    v_fma_mix_f32 v229, v186, v218, v222 op_sel:[1,1,1] op_sel_hi:[1,1,1]
    v_mfma_f32_32x32x16_bf16 v[32:47], a[136:139], v[192:195], v[32:47]
    ds_read_b64_tr_b16 a[156:157], v246 offset:13632
    ds_read_b64_tr_b16 a[158:159], v246 offset:13888
    buffer_load_dwordx4 v[180:183], v241, s[16:19], s32 offen offset:2048
    v_cvt_pk_bf16_f32 v201, v226, v227
    v_fma_mix_f32 v230, v187, v219, v223 op_sel:[0,0,0] op_sel_hi:[1,1,1]
    v_mfma_f32_32x32x16_bf16 v[96:111], a[136:139], v[196:199], v[96:111]
    v_fma_mix_f32 v231, v187, v219, v223 op_sel:[1,1,1] op_sel_hi:[1,1,1]
    v_cvt_pk_bf16_f32 v202, v228, v229
    v_fma_mix_f32 v224, v188, v216, v220 op_sel:[0,0,0] op_sel_hi:[1,1,1]
    v_fma_mix_f32 v225, v188, v216, v220 op_sel:[1,1,1] op_sel_hi:[1,1,1]
    v_cvt_pk_bf16_f32 v203, v230, v231
    v_mfma_f32_32x32x16_bf16 v[48:63], a[140:143], v[192:195], v[48:63]
    v_fma_mix_f32 v226, v189, v217, v221 op_sel:[0,0,0] op_sel_hi:[1,1,1]
    v_fma_mix_f32 v227, v189, v217, v221 op_sel:[1,1,1] op_sel_hi:[1,1,1]
    v_cvt_pk_bf16_f32 v204, v224, v225
    v_fma_mix_f32 v228, v190, v218, v222 op_sel:[0,0,0] op_sel_hi:[1,1,1]
    v_fma_mix_f32 v229, v190, v218, v222 op_sel:[1,1,1] op_sel_hi:[1,1,1]
    v_mfma_f32_32x32x16_bf16 v[112:127], a[140:143], v[196:199], v[112:127]
    v_cvt_pk_bf16_f32 v205, v226, v227
    v_fma_mix_f32 v230, v191, v219, v223 op_sel:[0,0,0] op_sel_hi:[1,1,1]
    v_fma_mix_f32 v231, v191, v219, v223 op_sel:[1,1,1] op_sel_hi:[1,1,1]
    v_cvt_pk_bf16_f32 v206, v228, v229
    v_cvt_pk_bf16_f32 v207, v230, v231
    s_waitcnt vmcnt(12) lgkmcnt(0)
    v_mfma_f32_32x32x16_bf16 v[0:15], a[144:147], v[200:203], v[0:15]
    ds_read_b128 v[216:219], v250 offset:64
    ds_read_b128 v[220:223], v250 offset:80
    s_barrier
    v_add_u32 v246, s30, v242
    v_mfma_f32_32x32x16_bf16 v[64:79], a[144:147], v[204:207], v[64:79]
    ds_read_b64_tr_b16 a[128:129], v246 offset:0
    ds_read_b64_tr_b16 a[130:131], v246 offset:256
    v_fma_mix_f32 v224, v128, v208, v212 op_sel:[0,0,0] op_sel_hi:[1,1,1]
    v_fma_mix_f32 v225, v128, v208, v212 op_sel:[1,1,1] op_sel_hi:[1,1,1]
    v_fma_mix_f32 v226, v129, v209, v213 op_sel:[0,0,0] op_sel_hi:[1,1,1]
    v_mfma_f32_32x32x16_bf16 v[16:31], a[148:151], v[200:203], v[16:31]
    ds_read_b64_tr_b16 a[132:133], v246 offset:64
    ds_read_b64_tr_b16 a[134:135], v246 offset:320
    v_fma_mix_f32 v227, v129, v209, v213 op_sel:[1,1,1] op_sel_hi:[1,1,1]
    v_cvt_pk_bf16_f32 v192, v224, v225
    v_fma_mix_f32 v228, v130, v210, v214 op_sel:[0,0,0] op_sel_hi:[1,1,1]
    v_mfma_f32_32x32x16_bf16 v[80:95], a[148:151], v[204:207], v[80:95]
    ds_read_b64_tr_b16 a[136:137], v246 offset:128
    ds_read_b64_tr_b16 a[138:139], v246 offset:384
    buffer_load_dwordx4 v[184:187], v240, s[16:19], s32 offen offset:3072
    v_fma_mix_f32 v229, v130, v210, v214 op_sel:[1,1,1] op_sel_hi:[1,1,1]
    v_cvt_pk_bf16_f32 v193, v226, v227
    v_mfma_f32_32x32x16_bf16 v[32:47], a[152:155], v[200:203], v[32:47]
    ds_read_b64_tr_b16 a[140:141], v246 offset:192
    ds_read_b64_tr_b16 a[142:143], v246 offset:448
    buffer_load_dwordx4 v[188:191], v241, s[16:19], s32 offen offset:3072
    v_fma_mix_f32 v230, v131, v211, v215 op_sel:[0,0,0] op_sel_hi:[1,1,1]
    v_mfma_f32_32x32x16_bf16 v[96:111], a[152:155], v[204:207], v[96:111]
    v_fma_mix_f32 v231, v131, v211, v215 op_sel:[1,1,1] op_sel_hi:[1,1,1]
    v_cvt_pk_bf16_f32 v194, v228, v229
    v_fma_mix_f32 v224, v132, v208, v212 op_sel:[0,0,0] op_sel_hi:[1,1,1]
    v_fma_mix_f32 v225, v132, v208, v212 op_sel:[1,1,1] op_sel_hi:[1,1,1]
    v_cvt_pk_bf16_f32 v195, v230, v231
    v_mfma_f32_32x32x16_bf16 v[48:63], a[156:159], v[200:203], v[48:63]
    v_fma_mix_f32 v226, v133, v209, v213 op_sel:[0,0,0] op_sel_hi:[1,1,1]
    v_fma_mix_f32 v227, v133, v209, v213 op_sel:[1,1,1] op_sel_hi:[1,1,1]
    v_cvt_pk_bf16_f32 v196, v224, v225
    v_fma_mix_f32 v228, v134, v210, v214 op_sel:[0,0,0] op_sel_hi:[1,1,1]
    v_fma_mix_f32 v229, v134, v210, v214 op_sel:[1,1,1] op_sel_hi:[1,1,1]
    v_mfma_f32_32x32x16_bf16 v[112:127], a[156:159], v[204:207], v[112:127]
    v_cvt_pk_bf16_f32 v197, v226, v227
    v_fma_mix_f32 v230, v135, v211, v215 op_sel:[0,0,0] op_sel_hi:[1,1,1]
    v_fma_mix_f32 v231, v135, v211, v215 op_sel:[1,1,1] op_sel_hi:[1,1,1]
    v_cvt_pk_bf16_f32 v198, v228, v229
    v_cvt_pk_bf16_f32 v199, v230, v231
attn_kernel_p1_2:
    s_waitcnt vmcnt(12) lgkmcnt(0)
    v_mfma_f32_32x32x16_bf16 v[0:15], a[128:131], v[192:195], v[0:15]
    ds_read_b128 v[208:211], v250 offset:128
    ds_read_b128 v[212:215], v250 offset:144
    v_fma_mix_f32 v224, v136, v216, v220 op_sel:[0,0,0] op_sel_hi:[1,1,1]
    v_fma_mix_f32 v225, v136, v216, v220 op_sel:[1,1,1] op_sel_hi:[1,1,1]
    v_fma_mix_f32 v226, v137, v217, v221 op_sel:[0,0,0] op_sel_hi:[1,1,1]
    v_mfma_f32_32x32x16_bf16 v[64:79], a[128:131], v[196:199], v[64:79]
    ds_read_b64_tr_b16 a[144:145], v246 offset:4480
    ds_read_b64_tr_b16 a[146:147], v246 offset:4736
    s_add_u32 s32, s32, 4096
    v_fma_mix_f32 v227, v137, v217, v221 op_sel:[1,1,1] op_sel_hi:[1,1,1]
    v_cvt_pk_bf16_f32 v200, v224, v225
    v_mfma_f32_32x32x16_bf16 v[16:31], a[132:135], v[192:195], v[16:31]
    ds_read_b64_tr_b16 a[148:149], v246 offset:4544
    ds_read_b64_tr_b16 a[150:151], v246 offset:4800
    s_add_u32 s31, s31, s40
    v_fma_mix_f32 v228, v138, v218, v222 op_sel:[0,0,0] op_sel_hi:[1,1,1]
    v_fma_mix_f32 v229, v138, v218, v222 op_sel:[1,1,1] op_sel_hi:[1,1,1]
    v_mfma_f32_32x32x16_bf16 v[80:95], a[132:135], v[196:199], v[80:95]
    ds_read_b64_tr_b16 a[152:153], v246 offset:4608
    ds_read_b64_tr_b16 a[154:155], v246 offset:4864
    v_cvt_pk_bf16_f32 v201, v226, v227
    v_fma_mix_f32 v230, v139, v219, v223 op_sel:[0,0,0] op_sel_hi:[1,1,1]
    v_fma_mix_f32 v231, v139, v219, v223 op_sel:[1,1,1] op_sel_hi:[1,1,1]
    v_mfma_f32_32x32x16_bf16 v[32:47], a[136:139], v[192:195], v[32:47]
    ds_read_b64_tr_b16 a[156:157], v246 offset:4672
    ds_read_b64_tr_b16 a[158:159], v246 offset:4928
    v_cvt_pk_bf16_f32 v202, v228, v229
    v_fma_mix_f32 v224, v140, v216, v220 op_sel:[0,0,0] op_sel_hi:[1,1,1]
    v_fma_mix_f32 v225, v140, v216, v220 op_sel:[1,1,1] op_sel_hi:[1,1,1]
    v_mfma_f32_32x32x16_bf16 v[96:111], a[136:139], v[196:199], v[96:111]
    buffer_load_dwordx4 v[128:131], v240, s[16:19], s32 offen offset:0
    v_cvt_pk_bf16_f32 v203, v230, v231
    v_fma_mix_f32 v226, v141, v217, v221 op_sel:[0,0,0] op_sel_hi:[1,1,1]
    v_fma_mix_f32 v227, v141, v217, v221 op_sel:[1,1,1] op_sel_hi:[1,1,1]
    v_cvt_pk_bf16_f32 v204, v224, v225
    v_mfma_f32_32x32x16_bf16 v[48:63], a[140:143], v[192:195], v[48:63]
    buffer_load_dwordx4 v[132:135], v241, s[16:19], s32 offen offset:0
    s_add_u32 m0, s29, s39
    v_fma_mix_f32 v228, v142, v218, v222 op_sel:[0,0,0] op_sel_hi:[1,1,1]
    v_fma_mix_f32 v229, v142, v218, v222 op_sel:[1,1,1] op_sel_hi:[1,1,1]
    v_cvt_pk_bf16_f32 v205, v226, v227
    v_mfma_f32_32x32x16_bf16 v[112:127], a[140:143], v[196:199], v[112:127]
    buffer_load_dwordx4 v232, s[44:47], s31 offen offset:0 lds
    v_fma_mix_f32 v230, v143, v219, v223 op_sel:[0,0,0] op_sel_hi:[1,1,1]
    v_fma_mix_f32 v231, v143, v219, v223 op_sel:[1,1,1] op_sel_hi:[1,1,1]
    v_cvt_pk_bf16_f32 v206, v228, v229
    v_cvt_pk_bf16_f32 v207, v230, v231
    s_waitcnt vmcnt(13) lgkmcnt(0)
    v_mfma_f32_32x32x16_bf16 v[0:15], a[144:147], v[200:203], v[0:15]
    ds_read_b128 v[216:219], v250 offset:192
    ds_read_b128 v[220:223], v250 offset:208
    v_fma_mix_f32 v224, v144, v208, v212 op_sel:[0,0,0] op_sel_hi:[1,1,1]
    v_fma_mix_f32 v225, v144, v208, v212 op_sel:[1,1,1] op_sel_hi:[1,1,1]
    v_fma_mix_f32 v226, v145, v209, v213 op_sel:[0,0,0] op_sel_hi:[1,1,1]
    v_mfma_f32_32x32x16_bf16 v[64:79], a[144:147], v[204:207], v[64:79]
    ds_read_b64_tr_b16 a[128:129], v246 offset:8960
    ds_read_b64_tr_b16 a[130:131], v246 offset:9216
    v_fma_mix_f32 v227, v145, v209, v213 op_sel:[1,1,1] op_sel_hi:[1,1,1]
    v_cvt_pk_bf16_f32 v192, v224, v225
    v_fma_mix_f32 v228, v146, v210, v214 op_sel:[0,0,0] op_sel_hi:[1,1,1]
    v_mfma_f32_32x32x16_bf16 v[16:31], a[148:151], v[200:203], v[16:31]
    ds_read_b64_tr_b16 a[132:133], v246 offset:9024
    ds_read_b64_tr_b16 a[134:135], v246 offset:9280
    v_fma_mix_f32 v229, v146, v210, v214 op_sel:[1,1,1] op_sel_hi:[1,1,1]
    v_cvt_pk_bf16_f32 v193, v226, v227
    v_fma_mix_f32 v230, v147, v211, v215 op_sel:[0,0,0] op_sel_hi:[1,1,1]
    v_mfma_f32_32x32x16_bf16 v[80:95], a[148:151], v[204:207], v[80:95]
    ds_read_b64_tr_b16 a[136:137], v246 offset:9088
    ds_read_b64_tr_b16 a[138:139], v246 offset:9344
    v_fma_mix_f32 v231, v147, v211, v215 op_sel:[1,1,1] op_sel_hi:[1,1,1]
    v_cvt_pk_bf16_f32 v194, v228, v229
    v_fma_mix_f32 v224, v148, v208, v212 op_sel:[0,0,0] op_sel_hi:[1,1,1]
    v_fma_mix_f32 v225, v148, v208, v212 op_sel:[1,1,1] op_sel_hi:[1,1,1]
    v_mfma_f32_32x32x16_bf16 v[32:47], a[152:155], v[200:203], v[32:47]
    ds_read_b64_tr_b16 a[140:141], v246 offset:9152
    ds_read_b64_tr_b16 a[142:143], v246 offset:9408
    v_cvt_pk_bf16_f32 v195, v230, v231
    v_fma_mix_f32 v226, v149, v209, v213 op_sel:[0,0,0] op_sel_hi:[1,1,1]
    v_fma_mix_f32 v227, v149, v209, v213 op_sel:[1,1,1] op_sel_hi:[1,1,1]
    v_mfma_f32_32x32x16_bf16 v[96:111], a[152:155], v[204:207], v[96:111]
    buffer_load_dwordx4 v[136:139], v240, s[16:19], s32 offen offset:1024
    s_add_u32 s29, s29, 17920
    s_cmp_ge_u32 s29, 125440
    v_cvt_pk_bf16_f32 v196, v224, v225
    v_fma_mix_f32 v228, v150, v210, v214 op_sel:[0,0,0] op_sel_hi:[1,1,1]
    v_mfma_f32_32x32x16_bf16 v[48:63], a[156:159], v[200:203], v[48:63]
    buffer_load_dwordx4 v[140:143], v241, s[16:19], s32 offen offset:1024
    s_cselect_b32 s37, 125440, 0
    s_sub_u32 s29, s29, s37
    v_fma_mix_f32 v229, v150, v210, v214 op_sel:[1,1,1] op_sel_hi:[1,1,1]
    v_cvt_pk_bf16_f32 v197, v226, v227
    v_mfma_f32_32x32x16_bf16 v[112:127], a[156:159], v[204:207], v[112:127]
    buffer_load_dwordx4 v233, s[44:47], s31 offen offset:1088 lds
    v_fma_mix_f32 v230, v151, v211, v215 op_sel:[0,0,0] op_sel_hi:[1,1,1]
    v_fma_mix_f32 v231, v151, v211, v215 op_sel:[1,1,1] op_sel_hi:[1,1,1]
    v_cvt_pk_bf16_f32 v198, v228, v229
    v_cvt_pk_bf16_f32 v199, v230, v231
    s_waitcnt vmcnt(14) lgkmcnt(0)
    v_mfma_f32_32x32x16_bf16 v[0:15], a[128:131], v[192:195], v[0:15]
    ds_read_b128 v[208:211], v250 offset:256
    ds_read_b128 v[212:215], v250 offset:272
    v_fma_mix_f32 v224, v152, v216, v220 op_sel:[0,0,0] op_sel_hi:[1,1,1]
    v_fma_mix_f32 v225, v152, v216, v220 op_sel:[1,1,1] op_sel_hi:[1,1,1]
    v_fma_mix_f32 v226, v153, v217, v221 op_sel:[0,0,0] op_sel_hi:[1,1,1]
    v_mfma_f32_32x32x16_bf16 v[64:79], a[128:131], v[196:199], v[64:79]
    ds_read_b64_tr_b16 a[144:145], v246 offset:13440
    ds_read_b64_tr_b16 a[146:147], v246 offset:13696
    v_fma_mix_f32 v227, v153, v217, v221 op_sel:[1,1,1] op_sel_hi:[1,1,1]
    v_cvt_pk_bf16_f32 v200, v224, v225
    v_fma_mix_f32 v228, v154, v218, v222 op_sel:[0,0,0] op_sel_hi:[1,1,1]
    v_mfma_f32_32x32x16_bf16 v[16:31], a[132:135], v[192:195], v[16:31]
    ds_read_b64_tr_b16 a[148:149], v246 offset:13504
    ds_read_b64_tr_b16 a[150:151], v246 offset:13760
    v_fma_mix_f32 v229, v154, v218, v222 op_sel:[1,1,1] op_sel_hi:[1,1,1]
    v_cvt_pk_bf16_f32 v201, v226, v227
    v_fma_mix_f32 v230, v155, v219, v223 op_sel:[0,0,0] op_sel_hi:[1,1,1]
    v_mfma_f32_32x32x16_bf16 v[80:95], a[132:135], v[196:199], v[80:95]
    ds_read_b64_tr_b16 a[152:153], v246 offset:13568
    ds_read_b64_tr_b16 a[154:155], v246 offset:13824
    v_fma_mix_f32 v231, v155, v219, v223 op_sel:[1,1,1] op_sel_hi:[1,1,1]
    v_cvt_pk_bf16_f32 v202, v228, v229
    v_fma_mix_f32 v224, v156, v216, v220 op_sel:[0,0,0] op_sel_hi:[1,1,1]
    v_fma_mix_f32 v225, v156, v216, v220 op_sel:[1,1,1] op_sel_hi:[1,1,1]
    v_mfma_f32_32x32x16_bf16 v[32:47], a[136:139], v[192:195], v[32:47]
    ds_read_b64_tr_b16 a[156:157], v246 offset:13632
    ds_read_b64_tr_b16 a[158:159], v246 offset:13888
    v_cvt_pk_bf16_f32 v203, v230, v231
    v_fma_mix_f32 v226, v157, v217, v221 op_sel:[0,0,0] op_sel_hi:[1,1,1]
    v_fma_mix_f32 v227, v157, v217, v221 op_sel:[1,1,1] op_sel_hi:[1,1,1]
    v_mfma_f32_32x32x16_bf16 v[96:111], a[136:139], v[196:199], v[96:111]
    s_add_u32 s30, s30, 17920
    s_cmp_ge_u32 s30, 125440
    buffer_load_dwordx4 v[144:147], v240, s[16:19], s32 offen offset:2048
    v_cvt_pk_bf16_f32 v204, v224, v225
    v_fma_mix_f32 v228, v158, v218, v222 op_sel:[0,0,0] op_sel_hi:[1,1,1]
    v_mfma_f32_32x32x16_bf16 v[48:63], a[140:143], v[192:195], v[48:63]
    s_cselect_b32 s38, 125440, 0
    s_sub_u32 s30, s30, s38
    buffer_load_dwordx4 v[148:151], v241, s[16:19], s32 offen offset:2048
    v_fma_mix_f32 v229, v158, v218, v222 op_sel:[1,1,1] op_sel_hi:[1,1,1]
    v_cvt_pk_bf16_f32 v205, v226, v227
    v_mfma_f32_32x32x16_bf16 v[112:127], a[140:143], v[196:199], v[112:127]
    buffer_load_dwordx4 v234, s[48:51], s31 offen offset:2176 lds
    v_fma_mix_f32 v230, v159, v219, v223 op_sel:[0,0,0] op_sel_hi:[1,1,1]
    v_fma_mix_f32 v231, v159, v219, v223 op_sel:[1,1,1] op_sel_hi:[1,1,1]
    v_cvt_pk_bf16_f32 v206, v228, v229
    v_cvt_pk_bf16_f32 v207, v230, v231
    s_waitcnt vmcnt(15) lgkmcnt(0)
    v_mfma_f32_32x32x16_bf16 v[0:15], a[144:147], v[200:203], v[0:15]
    ds_read_b128 v[216:219], v250 offset:320
    ds_read_b128 v[220:223], v250 offset:336
    s_barrier
    v_add_u32 v246, s30, v242
    v_mfma_f32_32x32x16_bf16 v[64:79], a[144:147], v[204:207], v[64:79]
    ds_read_b64_tr_b16 a[128:129], v246 offset:0
    ds_read_b64_tr_b16 a[130:131], v246 offset:256
    v_fma_mix_f32 v224, v160, v208, v212 op_sel:[0,0,0] op_sel_hi:[1,1,1]
    v_fma_mix_f32 v225, v160, v208, v212 op_sel:[1,1,1] op_sel_hi:[1,1,1]
    v_fma_mix_f32 v226, v161, v209, v213 op_sel:[0,0,0] op_sel_hi:[1,1,1]
    v_mfma_f32_32x32x16_bf16 v[16:31], a[148:151], v[200:203], v[16:31]
    ds_read_b64_tr_b16 a[132:133], v246 offset:64
    ds_read_b64_tr_b16 a[134:135], v246 offset:320
    v_fma_mix_f32 v227, v161, v209, v213 op_sel:[1,1,1] op_sel_hi:[1,1,1]
    v_cvt_pk_bf16_f32 v192, v224, v225
    v_fma_mix_f32 v228, v162, v210, v214 op_sel:[0,0,0] op_sel_hi:[1,1,1]
    v_mfma_f32_32x32x16_bf16 v[80:95], a[148:151], v[204:207], v[80:95]
    ds_read_b64_tr_b16 a[136:137], v246 offset:128
    ds_read_b64_tr_b16 a[138:139], v246 offset:384
    v_fma_mix_f32 v229, v162, v210, v214 op_sel:[1,1,1] op_sel_hi:[1,1,1]
    v_cvt_pk_bf16_f32 v193, v226, v227
    v_fma_mix_f32 v230, v163, v211, v215 op_sel:[0,0,0] op_sel_hi:[1,1,1]
    v_mfma_f32_32x32x16_bf16 v[32:47], a[152:155], v[200:203], v[32:47]
    ds_read_b64_tr_b16 a[140:141], v246 offset:192
    ds_read_b64_tr_b16 a[142:143], v246 offset:448
    v_fma_mix_f32 v231, v163, v211, v215 op_sel:[1,1,1] op_sel_hi:[1,1,1]
    v_cvt_pk_bf16_f32 v194, v228, v229
    v_fma_mix_f32 v224, v164, v208, v212 op_sel:[0,0,0] op_sel_hi:[1,1,1]
    v_mfma_f32_32x32x16_bf16 v[96:111], a[152:155], v[204:207], v[96:111]
    buffer_load_dwordx4 v[152:155], v240, s[16:19], s32 offen offset:3072
    v_fma_mix_f32 v225, v164, v208, v212 op_sel:[1,1,1] op_sel_hi:[1,1,1]
    v_cvt_pk_bf16_f32 v195, v230, v231
    v_fma_mix_f32 v226, v165, v209, v213 op_sel:[0,0,0] op_sel_hi:[1,1,1]
    v_fma_mix_f32 v227, v165, v209, v213 op_sel:[1,1,1] op_sel_hi:[1,1,1]
    v_mfma_f32_32x32x16_bf16 v[48:63], a[156:159], v[200:203], v[48:63]
    buffer_load_dwordx4 v[156:159], v241, s[16:19], s32 offen offset:3072
    v_cvt_pk_bf16_f32 v196, v224, v225
    v_fma_mix_f32 v228, v166, v210, v214 op_sel:[0,0,0] op_sel_hi:[1,1,1]
    v_fma_mix_f32 v229, v166, v210, v214 op_sel:[1,1,1] op_sel_hi:[1,1,1]
    v_cvt_pk_bf16_f32 v197, v226, v227
    v_mfma_f32_32x32x16_bf16 v[112:127], a[156:159], v[204:207], v[112:127]
    buffer_load_dwordx4 v235, s[48:51], s31 offen offset:3264 lds
    v_fma_mix_f32 v230, v167, v211, v215 op_sel:[0,0,0] op_sel_hi:[1,1,1]
    v_fma_mix_f32 v231, v167, v211, v215 op_sel:[1,1,1] op_sel_hi:[1,1,1]
    v_cvt_pk_bf16_f32 v198, v228, v229
    v_cvt_pk_bf16_f32 v199, v230, v231
    s_waitcnt vmcnt(16) lgkmcnt(0)
    v_mfma_f32_32x32x16_bf16 v[0:15], a[128:131], v[192:195], v[0:15]
    ds_read_b128 v[208:211], v250 offset:384
    ds_read_b128 v[212:215], v250 offset:400
    v_fma_mix_f32 v224, v168, v216, v220 op_sel:[0,0,0] op_sel_hi:[1,1,1]
    v_fma_mix_f32 v225, v168, v216, v220 op_sel:[1,1,1] op_sel_hi:[1,1,1]
    v_fma_mix_f32 v226, v169, v217, v221 op_sel:[0,0,0] op_sel_hi:[1,1,1]
    v_mfma_f32_32x32x16_bf16 v[64:79], a[128:131], v[196:199], v[64:79]
    ds_read_b64_tr_b16 a[144:145], v246 offset:4480
    ds_read_b64_tr_b16 a[146:147], v246 offset:4736
    s_add_u32 s32, s32, 4096
    v_fma_mix_f32 v227, v169, v217, v221 op_sel:[1,1,1] op_sel_hi:[1,1,1]
    v_cvt_pk_bf16_f32 v200, v224, v225
    v_mfma_f32_32x32x16_bf16 v[16:31], a[132:135], v[192:195], v[16:31]
    ds_read_b64_tr_b16 a[148:149], v246 offset:4544
    ds_read_b64_tr_b16 a[150:151], v246 offset:4800
    s_add_u32 s31, s31, s40
    v_fma_mix_f32 v228, v170, v218, v222 op_sel:[0,0,0] op_sel_hi:[1,1,1]
    v_fma_mix_f32 v229, v170, v218, v222 op_sel:[1,1,1] op_sel_hi:[1,1,1]
    v_mfma_f32_32x32x16_bf16 v[80:95], a[132:135], v[196:199], v[80:95]
    ds_read_b64_tr_b16 a[152:153], v246 offset:4608
    ds_read_b64_tr_b16 a[154:155], v246 offset:4864
    v_cvt_pk_bf16_f32 v201, v226, v227
    v_fma_mix_f32 v230, v171, v219, v223 op_sel:[0,0,0] op_sel_hi:[1,1,1]
    v_fma_mix_f32 v231, v171, v219, v223 op_sel:[1,1,1] op_sel_hi:[1,1,1]
    v_mfma_f32_32x32x16_bf16 v[32:47], a[136:139], v[192:195], v[32:47]
    ds_read_b64_tr_b16 a[156:157], v246 offset:4672
    ds_read_b64_tr_b16 a[158:159], v246 offset:4928
    v_cvt_pk_bf16_f32 v202, v228, v229
    v_fma_mix_f32 v224, v172, v216, v220 op_sel:[0,0,0] op_sel_hi:[1,1,1]
    v_fma_mix_f32 v225, v172, v216, v220 op_sel:[1,1,1] op_sel_hi:[1,1,1]
    v_mfma_f32_32x32x16_bf16 v[96:111], a[136:139], v[196:199], v[96:111]
    buffer_load_dwordx4 v[160:163], v240, s[16:19], s32 offen offset:0
    v_cvt_pk_bf16_f32 v203, v230, v231
    v_fma_mix_f32 v226, v173, v217, v221 op_sel:[0,0,0] op_sel_hi:[1,1,1]
    v_fma_mix_f32 v227, v173, v217, v221 op_sel:[1,1,1] op_sel_hi:[1,1,1]
    v_cvt_pk_bf16_f32 v204, v224, v225
    v_mfma_f32_32x32x16_bf16 v[48:63], a[140:143], v[192:195], v[48:63]
    buffer_load_dwordx4 v[164:167], v241, s[16:19], s32 offen offset:0
    s_add_u32 m0, s29, s39
    v_fma_mix_f32 v228, v174, v218, v222 op_sel:[0,0,0] op_sel_hi:[1,1,1]
    v_fma_mix_f32 v229, v174, v218, v222 op_sel:[1,1,1] op_sel_hi:[1,1,1]
    v_cvt_pk_bf16_f32 v205, v226, v227
    v_mfma_f32_32x32x16_bf16 v[112:127], a[140:143], v[196:199], v[112:127]
    buffer_load_dwordx4 v232, s[44:47], s31 offen offset:0 lds
    v_fma_mix_f32 v230, v175, v219, v223 op_sel:[0,0,0] op_sel_hi:[1,1,1]
    v_fma_mix_f32 v231, v175, v219, v223 op_sel:[1,1,1] op_sel_hi:[1,1,1]
    v_cvt_pk_bf16_f32 v206, v228, v229
    v_cvt_pk_bf16_f32 v207, v230, v231
    s_waitcnt vmcnt(17) lgkmcnt(0)
    v_mfma_f32_32x32x16_bf16 v[0:15], a[144:147], v[200:203], v[0:15]
    ds_read_b128 v[216:219], v250 offset:448
    ds_read_b128 v[220:223], v250 offset:464
    v_fma_mix_f32 v224, v176, v208, v212 op_sel:[0,0,0] op_sel_hi:[1,1,1]
    v_fma_mix_f32 v225, v176, v208, v212 op_sel:[1,1,1] op_sel_hi:[1,1,1]
    v_fma_mix_f32 v226, v177, v209, v213 op_sel:[0,0,0] op_sel_hi:[1,1,1]
    v_mfma_f32_32x32x16_bf16 v[64:79], a[144:147], v[204:207], v[64:79]
    ds_read_b64_tr_b16 a[128:129], v246 offset:8960
    ds_read_b64_tr_b16 a[130:131], v246 offset:9216
    v_fma_mix_f32 v227, v177, v209, v213 op_sel:[1,1,1] op_sel_hi:[1,1,1]
    v_cvt_pk_bf16_f32 v192, v224, v225
    v_fma_mix_f32 v228, v178, v210, v214 op_sel:[0,0,0] op_sel_hi:[1,1,1]
    v_mfma_f32_32x32x16_bf16 v[16:31], a[148:151], v[200:203], v[16:31]
    ds_read_b64_tr_b16 a[132:133], v246 offset:9024
    ds_read_b64_tr_b16 a[134:135], v246 offset:9280
    v_fma_mix_f32 v229, v178, v210, v214 op_sel:[1,1,1] op_sel_hi:[1,1,1]
    v_cvt_pk_bf16_f32 v193, v226, v227
    v_fma_mix_f32 v230, v179, v211, v215 op_sel:[0,0,0] op_sel_hi:[1,1,1]
    v_mfma_f32_32x32x16_bf16 v[80:95], a[148:151], v[204:207], v[80:95]
    ds_read_b64_tr_b16 a[136:137], v246 offset:9088
    ds_read_b64_tr_b16 a[138:139], v246 offset:9344
    v_fma_mix_f32 v231, v179, v211, v215 op_sel:[1,1,1] op_sel_hi:[1,1,1]
    v_cvt_pk_bf16_f32 v194, v228, v229
    v_fma_mix_f32 v224, v180, v208, v212 op_sel:[0,0,0] op_sel_hi:[1,1,1]
    v_fma_mix_f32 v225, v180, v208, v212 op_sel:[1,1,1] op_sel_hi:[1,1,1]
    v_mfma_f32_32x32x16_bf16 v[32:47], a[152:155], v[200:203], v[32:47]
    ds_read_b64_tr_b16 a[140:141], v246 offset:9152
    ds_read_b64_tr_b16 a[142:143], v246 offset:9408
    v_cvt_pk_bf16_f32 v195, v230, v231
    v_fma_mix_f32 v226, v181, v209, v213 op_sel:[0,0,0] op_sel_hi:[1,1,1]
    v_fma_mix_f32 v227, v181, v209, v213 op_sel:[1,1,1] op_sel_hi:[1,1,1]
    v_mfma_f32_32x32x16_bf16 v[96:111], a[152:155], v[204:207], v[96:111]
    buffer_load_dwordx4 v[168:171], v240, s[16:19], s32 offen offset:1024
    s_add_u32 s29, s29, 17920
    s_cmp_ge_u32 s29, 125440
    v_cvt_pk_bf16_f32 v196, v224, v225
    v_fma_mix_f32 v228, v182, v210, v214 op_sel:[0,0,0] op_sel_hi:[1,1,1]
    v_mfma_f32_32x32x16_bf16 v[48:63], a[156:159], v[200:203], v[48:63]
    buffer_load_dwordx4 v[172:175], v241, s[16:19], s32 offen offset:1024
    s_cselect_b32 s37, 125440, 0
    s_sub_u32 s29, s29, s37
    v_fma_mix_f32 v229, v182, v210, v214 op_sel:[1,1,1] op_sel_hi:[1,1,1]
    v_cvt_pk_bf16_f32 v197, v226, v227
    v_mfma_f32_32x32x16_bf16 v[112:127], a[156:159], v[204:207], v[112:127]
    buffer_load_dwordx4 v233, s[44:47], s31 offen offset:1088 lds
    v_fma_mix_f32 v230, v183, v211, v215 op_sel:[0,0,0] op_sel_hi:[1,1,1]
    v_fma_mix_f32 v231, v183, v211, v215 op_sel:[1,1,1] op_sel_hi:[1,1,1]
    v_cvt_pk_bf16_f32 v198, v228, v229
    v_cvt_pk_bf16_f32 v199, v230, v231
    s_waitcnt vmcnt(18) lgkmcnt(0)
    v_mfma_f32_32x32x16_bf16 v[0:15], a[128:131], v[192:195], v[0:15]
    v_add_u32 v250, 512, v250
    ds_read_b128 v[208:211], v250 offset:0
    ds_read_b128 v[212:215], v250 offset:16
    v_fma_mix_f32 v224, v184, v216, v220 op_sel:[0,0,0] op_sel_hi:[1,1,1]
    v_fma_mix_f32 v225, v184, v216, v220 op_sel:[1,1,1] op_sel_hi:[1,1,1]
    v_mfma_f32_32x32x16_bf16 v[64:79], a[128:131], v[196:199], v[64:79]
    ds_read_b64_tr_b16 a[144:145], v246 offset:13440
    ds_read_b64_tr_b16 a[146:147], v246 offset:13696
    v_fma_mix_f32 v226, v185, v217, v221 op_sel:[0,0,0] op_sel_hi:[1,1,1]
    v_fma_mix_f32 v227, v185, v217, v221 op_sel:[1,1,1] op_sel_hi:[1,1,1]
    v_cvt_pk_bf16_f32 v200, v224, v225
    v_fma_mix_f32 v228, v186, v218, v222 op_sel:[0,0,0] op_sel_hi:[1,1,1]
    v_mfma_f32_32x32x16_bf16 v[16:31], a[132:135], v[192:195], v[16:31]
    ds_read_b64_tr_b16 a[148:149], v246 offset:13504
    ds_read_b64_tr_b16 a[150:151], v246 offset:13760
    v_fma_mix_f32 v229, v186, v218, v222 op_sel:[1,1,1] op_sel_hi:[1,1,1]
    v_cvt_pk_bf16_f32 v201, v226, v227
    v_fma_mix_f32 v230, v187, v219, v223 op_sel:[0,0,0] op_sel_hi:[1,1,1]
    v_mfma_f32_32x32x16_bf16 v[80:95], a[132:135], v[196:199], v[80:95]
    ds_read_b64_tr_b16 a[152:153], v246 offset:13568
    ds_read_b64_tr_b16 a[154:155], v246 offset:13824
    v_fma_mix_f32 v231, v187, v219, v223 op_sel:[1,1,1] op_sel_hi:[1,1,1]
    v_cvt_pk_bf16_f32 v202, v228, v229
    v_fma_mix_f32 v224, v188, v216, v220 op_sel:[0,0,0] op_sel_hi:[1,1,1]
    v_mfma_f32_32x32x16_bf16 v[32:47], a[136:139], v[192:195], v[32:47]
    ds_read_b64_tr_b16 a[156:157], v246 offset:13632
    ds_read_b64_tr_b16 a[158:159], v246 offset:13888
    v_fma_mix_f32 v225, v188, v216, v220 op_sel:[1,1,1] op_sel_hi:[1,1,1]
    v_cvt_pk_bf16_f32 v203, v230, v231
    v_fma_mix_f32 v226, v189, v217, v221 op_sel:[0,0,0] op_sel_hi:[1,1,1]
    v_mfma_f32_32x32x16_bf16 v[96:111], a[136:139], v[196:199], v[96:111]
    s_add_u32 s30, s30, 17920
    s_cmp_ge_u32 s30, 125440
    buffer_load_dwordx4 v[176:179], v240, s[16:19], s32 offen offset:2048
    v_fma_mix_f32 v227, v189, v217, v221 op_sel:[1,1,1] op_sel_hi:[1,1,1]
    v_cvt_pk_bf16_f32 v204, v224, v225
    v_fma_mix_f32 v228, v190, v218, v222 op_sel:[0,0,0] op_sel_hi:[1,1,1]
    v_mfma_f32_32x32x16_bf16 v[48:63], a[140:143], v[192:195], v[48:63]
    s_cselect_b32 s38, 125440, 0
    s_sub_u32 s30, s30, s38
    buffer_load_dwordx4 v[180:183], v241, s[16:19], s32 offen offset:2048
    v_fma_mix_f32 v229, v190, v218, v222 op_sel:[1,1,1] op_sel_hi:[1,1,1]
    v_cvt_pk_bf16_f32 v205, v226, v227
    v_mfma_f32_32x32x16_bf16 v[112:127], a[140:143], v[196:199], v[112:127]
    buffer_load_dwordx4 v234, s[48:51], s31 offen offset:2176 lds
    v_fma_mix_f32 v230, v191, v219, v223 op_sel:[0,0,0] op_sel_hi:[1,1,1]
    v_fma_mix_f32 v231, v191, v219, v223 op_sel:[1,1,1] op_sel_hi:[1,1,1]
    v_cvt_pk_bf16_f32 v206, v228, v229
    v_cvt_pk_bf16_f32 v207, v230, v231
    s_waitcnt vmcnt(19) lgkmcnt(0)
    v_mfma_f32_32x32x16_bf16 v[0:15], a[144:147], v[200:203], v[0:15]
    ds_read_b128 v[216:219], v250 offset:64
    ds_read_b128 v[220:223], v250 offset:80
    s_barrier
    v_add_u32 v246, s30, v242
    v_mfma_f32_32x32x16_bf16 v[64:79], a[144:147], v[204:207], v[64:79]
    ds_read_b64_tr_b16 a[128:129], v246 offset:0
    ds_read_b64_tr_b16 a[130:131], v246 offset:256
    v_fma_mix_f32 v224, v128, v208, v212 op_sel:[0,0,0] op_sel_hi:[1,1,1]
    v_fma_mix_f32 v225, v128, v208, v212 op_sel:[1,1,1] op_sel_hi:[1,1,1]
    v_fma_mix_f32 v226, v129, v209, v213 op_sel:[0,0,0] op_sel_hi:[1,1,1]
    v_fma_mix_f32 v227, v129, v209, v213 op_sel:[1,1,1] op_sel_hi:[1,1,1]
    v_mfma_f32_32x32x16_bf16 v[16:31], a[148:151], v[200:203], v[16:31]
    ds_read_b64_tr_b16 a[132:133], v246 offset:64
    ds_read_b64_tr_b16 a[134:135], v246 offset:320
    v_cvt_pk_bf16_f32 v192, v224, v225
    v_fma_mix_f32 v228, v130, v210, v214 op_sel:[0,0,0] op_sel_hi:[1,1,1]
    v_fma_mix_f32 v229, v130, v210, v214 op_sel:[1,1,1] op_sel_hi:[1,1,1]
    v_mfma_f32_32x32x16_bf16 v[80:95], a[148:151], v[204:207], v[80:95]
    ds_read_b64_tr_b16 a[136:137], v246 offset:128
    ds_read_b64_tr_b16 a[138:139], v246 offset:384
    v_cvt_pk_bf16_f32 v193, v226, v227
    v_fma_mix_f32 v230, v131, v211, v215 op_sel:[0,0,0] op_sel_hi:[1,1,1]
    v_fma_mix_f32 v231, v131, v211, v215 op_sel:[1,1,1] op_sel_hi:[1,1,1]
    v_cvt_pk_bf16_f32 v194, v228, v229
    v_mfma_f32_32x32x16_bf16 v[32:47], a[152:155], v[200:203], v[32:47]
    ds_read_b64_tr_b16 a[140:141], v246 offset:192
    ds_read_b64_tr_b16 a[142:143], v246 offset:448
    v_fma_mix_f32 v224, v132, v208, v212 op_sel:[0,0,0] op_sel_hi:[1,1,1]
    v_fma_mix_f32 v225, v132, v208, v212 op_sel:[1,1,1] op_sel_hi:[1,1,1]
    v_cvt_pk_bf16_f32 v195, v230, v231
    v_mfma_f32_32x32x16_bf16 v[96:111], a[152:155], v[204:207], v[96:111]
    buffer_load_dwordx4 v[184:187], v240, s[16:19], s32 offen offset:3072
    v_fma_mix_f32 v226, v133, v209, v213 op_sel:[0,0,0] op_sel_hi:[1,1,1]
    v_fma_mix_f32 v227, v133, v209, v213 op_sel:[1,1,1] op_sel_hi:[1,1,1]
    v_cvt_pk_bf16_f32 v196, v224, v225
    v_fma_mix_f32 v228, v134, v210, v214 op_sel:[0,0,0] op_sel_hi:[1,1,1]
    v_mfma_f32_32x32x16_bf16 v[48:63], a[156:159], v[200:203], v[48:63]
    buffer_load_dwordx4 v[188:191], v241, s[16:19], s32 offen offset:3072
    s_sub_u32 s33, s33, 1
    s_cmp_eq_u32 s33, 1
    s_cselect_b32 s18, 0, s18
    v_fma_mix_f32 v229, v134, v210, v214 op_sel:[1,1,1] op_sel_hi:[1,1,1]
    v_cvt_pk_bf16_f32 v197, v226, v227
    v_mfma_f32_32x32x16_bf16 v[112:127], a[156:159], v[204:207], v[112:127]
    buffer_load_dwordx4 v235, s[48:51], s31 offen offset:3264 lds
    v_fma_mix_f32 v230, v135, v211, v215 op_sel:[0,0,0] op_sel_hi:[1,1,1]
    v_fma_mix_f32 v231, v135, v211, v215 op_sel:[1,1,1] op_sel_hi:[1,1,1]
    v_cvt_pk_bf16_f32 v198, v228, v229
    v_cvt_pk_bf16_f32 v199, v230, v231
    s_cmp_eq_u32 s33, 2
    s_cbranch_scc0 attn_kernel_p1s_3
    s_mov_b32 s44, s8
    s_mov_b32 s48, s12
    v_mov_b32 v232, v236
    s_mov_b32 s45, s9
    s_mov_b32 s49, s13
    v_mov_b32 v233, v237
    s_mov_b32 s46, s10
    s_mov_b32 s50, s14
    v_mov_b32 v234, v238
    s_mov_b32 s47, s11
    s_mov_b32 s51, s15
    v_mov_b32 v235, v239
    s_mov_b32 s40, 8192
    s_mov_b32 s31, -8192
attn_kernel_p1s_3:
    s_cmp_lg_u32 s33, 0
    s_cbranch_scc1 attn_kernel_p1_2
    v_add_u32 v247, s30, v243
    v_add_u32 v248, s30, v244
    v_add_u32 v249, s30, v245
    ds_read_b128 a[64:67], v247 offset:0
    ds_read_b128 a[68:71], v248 offset:0
    ds_read_b128 a[72:75], v247 offset:64
    ds_read_b128 a[76:79], v248 offset:64
    ds_read_b128 a[80:83], v247 offset:128
    ds_read_b128 a[84:87], v248 offset:128
    ds_read_b128 a[88:91], v247 offset:192
    ds_read_b128 a[92:95], v248 offset:192
    v_cvt_pk_bf16_f32 v224, v0, v1
    v_cvt_pk_bf16_f32 v225, v2, v3
    v_accvgpr_write_b32 a0, v224
    s_add_u32 s31, s31, s40
    v_cvt_pk_bf16_f32 v226, v4, v5
    v_accvgpr_write_b32 a1, v225
    v_cvt_pk_bf16_f32 v227, v6, v7
    s_add_u32 m0, s29, s39
    v_accvgpr_write_b32 a2, v226
    v_cvt_pk_bf16_f32 v224, v8, v9
    v_accvgpr_write_b32 a3, v227
    buffer_load_dwordx4 v232, s[44:47], s31 offen offset:0 lds
    v_cvt_pk_bf16_f32 v225, v10, v11
    v_accvgpr_write_b32 a4, v224
    v_cvt_pk_bf16_f32 v226, v12, v13
    buffer_load_dwordx4 v233, s[44:47], s31 offen offset:1088 lds
    v_accvgpr_write_b32 a5, v225
    v_cvt_pk_bf16_f32 v227, v14, v15
    v_accvgpr_write_b32 a6, v226
    buffer_load_dwordx4 v234, s[48:51], s31 offen offset:2176 lds
    v_cvt_pk_bf16_f32 v224, v16, v17
    v_accvgpr_write_b32 a7, v227
    v_cvt_pk_bf16_f32 v225, v18, v19
    buffer_load_dwordx4 v235, s[48:51], s31 offen offset:3264 lds
    v_accvgpr_write_b32 a8, v224
    v_cvt_pk_bf16_f32 v226, v20, v21
    v_accvgpr_write_b32 a9, v225
    s_add_u32 s29, s29, 17920
    v_cvt_pk_bf16_f32 v227, v22, v23
    v_accvgpr_write_b32 a10, v226
    v_cvt_pk_bf16_f32 v224, v24, v25
    s_cmp_ge_u32 s29, 125440
    v_accvgpr_write_b32 a11, v227
    v_cvt_pk_bf16_f32 v225, v26, v27
    v_accvgpr_write_b32 a12, v224
    s_cselect_b32 s37, 125440, 0
    v_cvt_pk_bf16_f32 v226, v28, v29
    v_accvgpr_write_b32 a13, v225
    v_cvt_pk_bf16_f32 v227, v30, v31
    s_sub_u32 s29, s29, s37
    v_accvgpr_write_b32 a14, v226
    v_cvt_pk_bf16_f32 v224, v32, v33
    v_accvgpr_write_b32 a15, v227
    s_add_u32 s31, s31, s40
    v_cvt_pk_bf16_f32 v225, v34, v35
    v_accvgpr_write_b32 a16, v224
    v_cvt_pk_bf16_f32 v226, v36, v37
    s_add_u32 m0, s29, s39
    v_accvgpr_write_b32 a17, v225
    v_cvt_pk_bf16_f32 v227, v38, v39
    v_accvgpr_write_b32 a18, v226
    buffer_load_dwordx4 v232, s[44:47], s31 offen offset:0 lds
    v_cvt_pk_bf16_f32 v224, v40, v41
    v_accvgpr_write_b32 a19, v227
    v_cvt_pk_bf16_f32 v225, v42, v43
    buffer_load_dwordx4 v233, s[44:47], s31 offen offset:1088 lds
    v_accvgpr_write_b32 a20, v224
    v_cvt_pk_bf16_f32 v226, v44, v45
    v_accvgpr_write_b32 a21, v225
    buffer_load_dwordx4 v234, s[48:51], s31 offen offset:2176 lds
    v_cvt_pk_bf16_f32 v227, v46, v47
    v_accvgpr_write_b32 a22, v226
    v_cvt_pk_bf16_f32 v224, v48, v49
    buffer_load_dwordx4 v235, s[48:51], s31 offen offset:3264 lds
    v_accvgpr_write_b32 a23, v227
    v_cvt_pk_bf16_f32 v225, v50, v51
    v_accvgpr_write_b32 a24, v224
    s_add_u32 s29, s29, 17920
    v_cvt_pk_bf16_f32 v226, v52, v53
    v_accvgpr_write_b32 a25, v225
    v_cvt_pk_bf16_f32 v227, v54, v55
    s_cmp_ge_u32 s29, 125440
    v_accvgpr_write_b32 a26, v226
    v_cvt_pk_bf16_f32 v224, v56, v57
    v_accvgpr_write_b32 a27, v227
    s_cselect_b32 s37, 125440, 0
    v_cvt_pk_bf16_f32 v225, v58, v59
    v_accvgpr_write_b32 a28, v224
    v_cvt_pk_bf16_f32 v226, v60, v61
    s_sub_u32 s29, s29, s37
    v_accvgpr_write_b32 a29, v225
    v_cvt_pk_bf16_f32 v227, v62, v63
    v_accvgpr_write_b32 a30, v226
    s_add_u32 s31, s31, s40
    v_accvgpr_write_b32 a31, v227
    s_mov_b32 s42, s30
    s_add_u32 s42, s42, 17920
    s_cmp_ge_u32 s42, 125440
    s_cselect_b32 s38, 125440, 0
    s_sub_u32 s42, s42, s38
    s_cmp_lg_u32 s36, 0
    s_cselect_b64 s[52:53], -1, 0
    s_waitcnt vmcnt(27) lgkmcnt(7)
    v_mfma_f32_32x32x16_bf16 v[128:143], a[64:67], a[0:3], 0
    ds_read_b64_tr_b16 a[96:97], v249 offset:0
    ds_read_b64_tr_b16 a[98:99], v249 offset:512
    v_add_u32 v247, s42, v243
    v_add_u32 v248, s42, v244
    v_cvt_pk_bf16_f32 v224, v64, v65
    v_cvt_pk_bf16_f32 v225, v66, v67
    v_accvgpr_write_b32 a32, v224
    v_cvt_pk_bf16_f32 v226, v68, v69
    v_accvgpr_write_b32 a33, v225
    v_cvt_pk_bf16_f32 v227, v70, v71
    s_waitcnt lgkmcnt(8)
    v_mfma_f32_32x32x16_bf16 v[128:143], a[68:71], a[4:7], v[128:143]
    ds_read_b64_tr_b16 a[100:101], v249 offset:64
    ds_read_b64_tr_b16 a[102:103], v249 offset:576
    v_accvgpr_write_b32 a34, v226
    v_cvt_pk_bf16_f32 v224, v72, v73
    v_accvgpr_write_b32 a35, v227
    v_cvt_pk_bf16_f32 v225, v74, v75
    v_accvgpr_write_b32 a36, v224
    v_cvt_pk_bf16_f32 v226, v76, v77
    v_accvgpr_write_b32 a37, v225
    v_cvt_pk_bf16_f32 v227, v78, v79
    v_accvgpr_write_b32 a38, v226
    s_waitcnt lgkmcnt(9)
    v_mfma_f32_32x32x16_bf16 v[128:143], a[72:75], a[8:11], v[128:143]
    ds_read_b64_tr_b16 a[104:105], v249 offset:128
    ds_read_b64_tr_b16 a[106:107], v249 offset:640
    v_cvt_pk_bf16_f32 v224, v80, v81
    v_accvgpr_write_b32 a39, v227
    v_cvt_pk_bf16_f32 v225, v82, v83
    v_accvgpr_write_b32 a40, v224
    v_cvt_pk_bf16_f32 v226, v84, v85
    v_accvgpr_write_b32 a41, v225
    v_cvt_pk_bf16_f32 v227, v86, v87
    v_accvgpr_write_b32 a42, v226
    s_waitcnt lgkmcnt(10)
    v_mfma_f32_32x32x16_bf16 v[128:143], a[76:79], a[12:15], v[128:143]
    ds_read_b64_tr_b16 a[108:109], v249 offset:192
    ds_read_b64_tr_b16 a[110:111], v249 offset:704
    v_cvt_pk_bf16_f32 v224, v88, v89
    v_accvgpr_write_b32 a43, v227
    v_cvt_pk_bf16_f32 v225, v90, v91
    v_accvgpr_write_b32 a44, v224
    v_cvt_pk_bf16_f32 v226, v92, v93
    v_accvgpr_write_b32 a45, v225
    v_cvt_pk_bf16_f32 v227, v94, v95
    v_accvgpr_write_b32 a46, v226
    s_waitcnt lgkmcnt(11)
    v_mfma_f32_32x32x16_bf16 v[128:143], a[80:83], a[16:19], v[128:143]
    ds_read_b64_tr_b16 a[112:113], v249 offset:8960
    ds_read_b64_tr_b16 a[114:115], v249 offset:9472
    v_cvt_pk_bf16_f32 v224, v96, v97
    v_accvgpr_write_b32 a47, v227
    v_cvt_pk_bf16_f32 v225, v98, v99
    v_accvgpr_write_b32 a48, v224
    v_cvt_pk_bf16_f32 v226, v100, v101
    v_accvgpr_write_b32 a49, v225
    v_cvt_pk_bf16_f32 v227, v102, v103
    v_accvgpr_write_b32 a50, v226
    s_waitcnt lgkmcnt(12)
    v_mfma_f32_32x32x16_bf16 v[128:143], a[84:87], a[20:23], v[128:143]
    ds_read_b64_tr_b16 a[116:117], v249 offset:9024
    ds_read_b64_tr_b16 a[118:119], v249 offset:9536
    v_cvt_pk_bf16_f32 v224, v104, v105
    v_accvgpr_write_b32 a51, v227
    v_cvt_pk_bf16_f32 v225, v106, v107
    v_accvgpr_write_b32 a52, v224
    v_cvt_pk_bf16_f32 v226, v108, v109
    v_accvgpr_write_b32 a53, v225
    v_cvt_pk_bf16_f32 v227, v110, v111
    v_accvgpr_write_b32 a54, v226
    v_cvt_pk_bf16_f32 v224, v112, v113
    s_waitcnt lgkmcnt(13)
    v_mfma_f32_32x32x16_bf16 v[128:143], a[88:91], a[24:27], v[128:143]
    ds_read_b64_tr_b16 a[120:121], v249 offset:9088
    ds_read_b64_tr_b16 a[122:123], v249 offset:9600
    v_accvgpr_write_b32 a55, v227
    v_cvt_pk_bf16_f32 v225, v114, v115
    v_accvgpr_write_b32 a56, v224
    v_cvt_pk_bf16_f32 v226, v116, v117
    v_accvgpr_write_b32 a57, v225
    v_cvt_pk_bf16_f32 v227, v118, v119
    v_accvgpr_write_b32 a58, v226
    v_cvt_pk_bf16_f32 v224, v120, v121
    s_waitcnt lgkmcnt(14)
    v_mfma_f32_32x32x16_bf16 v[128:143], a[92:95], a[28:31], v[128:143]
    ds_read_b64_tr_b16 a[124:125], v249 offset:9152
    ds_read_b64_tr_b16 a[126:127], v249 offset:9664
    v_accvgpr_write_b32 a59, v227
    v_cvt_pk_bf16_f32 v225, v122, v123
    v_accvgpr_write_b32 a60, v224
    v_cvt_pk_bf16_f32 v226, v124, v125
    v_accvgpr_write_b32 a61, v225
    v_cvt_pk_bf16_f32 v227, v126, v127
    v_accvgpr_write_b32 a62, v226
    v_accvgpr_write_b32 a63, v227
    s_barrier
    s_waitcnt vmcnt(21)
    v_mfma_f32_32x32x16_bf16 v[144:159], a[64:67], a[32:35], 0
    ds_read_b128 a[64:67], v247 offset:0
    v_mov_b32 v208, 0
    v_mov_b32 v209, 0
    v_mov_b32 v210, 0
    v_mov_b32 v211, 0
    v_mfma_f32_32x32x16_bf16 v[144:159], a[68:71], a[36:39], v[144:159]
    ds_read_b128 a[68:71], v248 offset:0
    v_mfma_f32_32x32x16_bf16 v[144:159], a[72:75], a[40:43], v[144:159]
    ds_read_b128 a[72:75], v247 offset:64
    v_max3_f32 v228, v128, v129, v130
    v_max3_f32 v229, v131, v132, v133
    v_max3_f32 v228, v228, v134, v135
    v_max3_f32 v229, v229, v136, v137
    v_max3_f32 v228, v228, v138, v139
    v_max3_f32 v229, v229, v140, v141
    v_max3_f32 v228, v228, v142, v143
    v_max_f32 v228, v228, v229
    v_mfma_f32_32x32x16_bf16 v[144:159], a[76:79], a[44:47], v[144:159]
    ds_read_b128 a[76:79], v248 offset:64
    v_mov_b32 v229, v228
    s_nop 1
    v_permlane32_swap_b32 v228, v229
    v_max_f32 v228, v228, v229
    v_sub_f32 v228, 0xc2200000, v228
    v_cndmask_b32 v228, v228, v253, s[52:53]
    v_add_f32 v128, v128, v228
    v_add_f32 v129, v129, v228
    v_mfma_f32_32x32x16_bf16 v[144:159], a[80:83], a[48:51], v[144:159]
    ds_read_b128 a[80:83], v247 offset:128
    v_add_f32 v130, v130, v228
    v_add_f32 v131, v131, v228
    v_add_f32 v132, v132, v228
    v_add_f32 v133, v133, v228
    v_add_f32 v134, v134, v228
    v_add_f32 v135, v135, v228
    v_add_f32 v136, v136, v228
    v_add_f32 v137, v137, v228
    v_mfma_f32_32x32x16_bf16 v[144:159], a[84:87], a[52:55], v[144:159]
    ds_read_b128 a[84:87], v248 offset:128
    v_add_f32 v138, v138, v228
    v_add_f32 v139, v139, v228
    v_add_f32 v140, v140, v228
    v_add_f32 v141, v141, v228
    v_add_f32 v142, v142, v228
    v_add_f32 v143, v143, v228
    v_exp_f32 v128, v128
    v_mfma_f32_32x32x16_bf16 v[144:159], a[88:91], a[56:59], v[144:159]
    ds_read_b128 a[88:91], v247 offset:192
    v_exp_f32 v129, v129
    v_exp_f32 v130, v130
    v_exp_f32 v131, v131
    v_cvt_pk_bf16_f32 v192, v128, v129
    v_mfma_f32_32x32x16_bf16 v[144:159], a[92:95], a[60:63], v[144:159]
    ds_read_b128 a[92:95], v248 offset:192
    v_add_f32 v208, v208, v128
    v_add_f32 v209, v209, v129
    v_exp_f32 v132, v132
    v_exp_f32 v133, v133
    v_cvt_pk_bf16_f32 v193, v130, v131
    v_add_f32 v208, v208, v130
    v_add_f32 v209, v209, v131
    v_exp_f32 v134, v134
    v_exp_f32 v135, v135
    v_cvt_pk_bf16_f32 v194, v132, v133
    v_add_f32 v208, v208, v132
    v_add_f32 v209, v209, v133
    v_exp_f32 v136, v136
    v_exp_f32 v137, v137
    v_cvt_pk_bf16_f32 v195, v134, v135
    v_add_f32 v208, v208, v134
    v_add_f32 v209, v209, v135
    v_exp_f32 v138, v138
    v_exp_f32 v139, v139
    v_cvt_pk_bf16_f32 v196, v136, v137
    v_add_f32 v208, v208, v136
    v_add_f32 v209, v209, v137
    v_exp_f32 v140, v140
    v_exp_f32 v141, v141
    v_cvt_pk_bf16_f32 v197, v138, v139
    v_add_f32 v208, v208, v138
    v_add_f32 v209, v209, v139
    v_exp_f32 v142, v142
    v_exp_f32 v143, v143
    v_cvt_pk_bf16_f32 v198, v140, v141
    v_add_f32 v208, v208, v140
    v_add_f32 v209, v209, v141
    v_cvt_pk_bf16_f32 v199, v142, v143
    v_add_f32 v208, v208, v142
    v_add_f32 v209, v209, v143
    s_mov_b32 s33, 2
attn_kernel_ent_5:
    s_waitcnt lgkmcnt(8)
    v_mfma_f32_32x32x16_bf16 v[0:15], a[96:99], v[192:195], 0
    s_add_u32 m0, s29, s39
    s_waitcnt vmcnt(19)
    v_mov_b32 v160, v228
    v_mov_b32 v161, v228
    v_mov_b32 v162, v228
    v_max3_f32 v230, v144, v145, v146
    v_max3_f32 v231, v147, v148, v149
    v_max3_f32 v230, v230, v150, v151
    v_max3_f32 v231, v231, v152, v153
    v_mfma_f32_32x32x16_bf16 v[16:31], a[100:103], v[192:195], 0
    buffer_load_dwordx4 v232, s[44:47], s31 offen offset:0 lds
    v_mov_b32 v163, v228
    s_waitcnt vmcnt(19)
    v_mov_b32 v164, v228
    v_max3_f32 v230, v230, v154, v155
    v_max3_f32 v231, v231, v156, v157
    v_max3_f32 v230, v230, v158, v159
    v_max_f32 v230, v230, v231
    v_mfma_f32_32x32x16_bf16 v[32:47], a[104:107], v[192:195], 0
    buffer_load_dwordx4 v233, s[44:47], s31 offen offset:1088 lds
    v_mov_b32 v165, v228
    v_mov_b32 v166, v228
    v_mov_b32 v167, v228
    v_mov_b32 v231, v230
    s_nop 1
    v_permlane32_swap_b32 v230, v231
    v_max_f32 v230, v230, v231
    v_sub_f32 v230, 0xc2200000, v230
    v_mfma_f32_32x32x16_bf16 v[48:63], a[108:111], v[192:195], 0
    buffer_load_dwordx4 v234, s[48:51], s31 offen offset:2176 lds
    s_waitcnt vmcnt(19)
    v_mov_b32 v168, v228
    v_mov_b32 v169, v228
    v_cndmask_b32 v230, v230, v254, s[52:53]
    v_add_f32 v144, v144, v230
    v_add_f32 v145, v145, v230
    v_add_f32 v146, v146, v230
    v_mfma_f32_32x32x16_bf16 v[0:15], a[112:115], v[196:199], v[0:15]
    buffer_load_dwordx4 v235, s[48:51], s31 offen offset:3264 lds
    v_mov_b32 v170, v228
    v_mov_b32 v171, v228
    s_waitcnt vmcnt(19)
    v_mov_b32 v172, v228
    v_add_f32 v147, v147, v230
    v_add_f32 v148, v148, v230
    v_add_f32 v149, v149, v230
    v_add_f32 v150, v150, v230
    v_mfma_f32_32x32x16_bf16 v[16:31], a[116:119], v[196:199], v[16:31]
    s_add_u32 s29, s29, 17920
    s_cmp_ge_u32 s29, 125440
    v_mov_b32 v173, v228
    v_add_f32 v151, v151, v230
    v_add_f32 v152, v152, v230
    v_add_f32 v153, v153, v230
    v_add_f32 v154, v154, v230
    v_mfma_f32_32x32x16_bf16 v[32:47], a[120:123], v[196:199], v[32:47]
    s_cselect_b32 s37, 125440, 0
    s_sub_u32 s29, s29, s37
    v_mov_b32 v174, v228
    v_mov_b32 v175, v228
    v_add_f32 v155, v155, v230
    v_add_f32 v156, v156, v230
    v_add_f32 v157, v157, v230
    v_add_f32 v158, v158, v230
    v_mfma_f32_32x32x16_bf16 v[48:63], a[124:127], v[196:199], v[48:63]
    s_add_u32 s31, s31, s40
    v_add_f32 v159, v159, v230
    v_exp_f32 v144, v144
    v_exp_f32 v145, v145
    v_exp_f32 v146, v146
    s_waitcnt lgkmcnt(0)
    v_mfma_f32_32x32x16_bf16 v[128:143], a[64:67], a[0:3], v[160:175]
    v_add_u32 v249, s42, v245
    v_exp_f32 v147, v147
    v_cvt_pk_bf16_f32 v200, v144, v145
    v_add_f32 v210, v210, v144
    v_add_f32 v211, v211, v145
    v_mfma_f32_32x32x16_bf16 v[128:143], a[68:71], a[4:7], v[128:143]
    s_add_u32 s42, s42, 17920
    s_cmp_ge_u32 s42, 125440
    v_exp_f32 v148, v148
    v_exp_f32 v149, v149
    v_cvt_pk_bf16_f32 v201, v146, v147
    v_add_f32 v210, v210, v146
    v_mfma_f32_32x32x16_bf16 v[128:143], a[72:75], a[8:11], v[128:143]
    s_cselect_b32 s38, 125440, 0
    s_sub_u32 s42, s42, s38
    v_add_f32 v211, v211, v147
    v_exp_f32 v150, v150
    v_exp_f32 v151, v151
    v_cvt_pk_bf16_f32 v202, v148, v149
    v_mfma_f32_32x32x16_bf16 v[128:143], a[76:79], a[12:15], v[128:143]
    v_add_u32 v247, s42, v243
    v_add_f32 v210, v210, v148
    v_add_f32 v211, v211, v149
    v_exp_f32 v152, v152
    v_exp_f32 v153, v153
    v_mfma_f32_32x32x16_bf16 v[128:143], a[80:83], a[16:19], v[128:143]
    v_add_u32 v248, s42, v244
    v_cvt_pk_bf16_f32 v203, v150, v151
    v_add_f32 v210, v210, v150
    v_add_f32 v211, v211, v151
    v_exp_f32 v154, v154
    v_exp_f32 v155, v155
    v_mfma_f32_32x32x16_bf16 v[128:143], a[84:87], a[20:23], v[128:143]
    v_cvt_pk_bf16_f32 v204, v152, v153
    v_add_f32 v210, v210, v152
    v_add_f32 v211, v211, v153
    v_exp_f32 v156, v156
    v_exp_f32 v157, v157
    v_mfma_f32_32x32x16_bf16 v[128:143], a[88:91], a[24:27], v[128:143]
    v_cvt_pk_bf16_f32 v205, v154, v155
    v_add_f32 v210, v210, v154
    v_add_f32 v211, v211, v155
    v_exp_f32 v158, v158
    v_exp_f32 v159, v159
    v_cvt_pk_bf16_f32 v206, v156, v157
    v_mfma_f32_32x32x16_bf16 v[128:143], a[92:95], a[28:31], v[128:143]
    s_barrier
    v_add_f32 v210, v210, v156
    v_add_f32 v211, v211, v157
    v_cvt_pk_bf16_f32 v207, v158, v159
    v_add_f32 v210, v210, v158
    v_add_f32 v211, v211, v159
    v_mfma_f32_32x32x16_bf16 v[64:79], a[96:99], v[200:203], 0
    ds_read_b64_tr_b16 a[96:97], v249 offset:0
    ds_read_b64_tr_b16 a[98:99], v249 offset:512
    s_waitcnt vmcnt(17)
    v_mov_b32 v176, v230
    v_mov_b32 v177, v230
    v_mfma_f32_32x32x16_bf16 v[80:95], a[100:103], v[200:203], 0
    ds_read_b64_tr_b16 a[100:101], v249 offset:64
    ds_read_b64_tr_b16 a[102:103], v249 offset:576
    v_mov_b32 v178, v230
    v_mov_b32 v179, v230
    s_waitcnt vmcnt(16)
    v_mov_b32 v180, v230
    v_mfma_f32_32x32x16_bf16 v[96:111], a[104:107], v[200:203], 0
    ds_read_b64_tr_b16 a[104:105], v249 offset:128
    ds_read_b64_tr_b16 a[106:107], v249 offset:640
    v_mov_b32 v181, v230
    v_mov_b32 v182, v230
    v_exp_f32 v128, v128
    v_mfma_f32_32x32x16_bf16 v[112:127], a[108:111], v[200:203], 0
    ds_read_b64_tr_b16 a[108:109], v249 offset:192
    ds_read_b64_tr_b16 a[110:111], v249 offset:704
    v_mov_b32 v183, v230
    s_waitcnt vmcnt(14)
    v_mov_b32 v184, v230
    v_exp_f32 v129, v129
    v_mfma_f32_32x32x16_bf16 v[64:79], a[112:115], v[204:207], v[64:79]
    ds_read_b64_tr_b16 a[112:113], v249 offset:8960
    ds_read_b64_tr_b16 a[114:115], v249 offset:9472
    v_mov_b32 v185, v230
    v_mov_b32 v186, v230
    v_exp_f32 v130, v130
    v_mfma_f32_32x32x16_bf16 v[80:95], a[116:119], v[204:207], v[80:95]
    ds_read_b64_tr_b16 a[116:117], v249 offset:9024
    ds_read_b64_tr_b16 a[118:119], v249 offset:9536
    v_mov_b32 v187, v230
    s_waitcnt vmcnt(13)
    v_mov_b32 v188, v230
    v_mov_b32 v189, v230
    v_exp_f32 v131, v131
    v_mfma_f32_32x32x16_bf16 v[96:111], a[120:123], v[204:207], v[96:111]
    ds_read_b64_tr_b16 a[120:121], v249 offset:9088
    ds_read_b64_tr_b16 a[122:123], v249 offset:9600
    v_mov_b32 v190, v230
    v_mov_b32 v191, v230
    v_cvt_pk_bf16_f32 v192, v128, v129
    v_add_f32 v208, v208, v128
    v_mfma_f32_32x32x16_bf16 v[112:127], a[124:127], v[204:207], v[112:127]
    ds_read_b64_tr_b16 a[124:125], v249 offset:9152
    ds_read_b64_tr_b16 a[126:127], v249 offset:9664
    v_add_f32 v209, v209, v129
    v_exp_f32 v132, v132
    v_exp_f32 v133, v133
    v_mfma_f32_32x32x16_bf16 v[144:159], a[64:67], a[32:35], v[176:191]
    ds_read_b128 a[64:67], v247 offset:0
    v_cvt_pk_bf16_f32 v193, v130, v131
    v_add_f32 v208, v208, v130
    v_add_f32 v209, v209, v131
    v_exp_f32 v134, v134
    v_mfma_f32_32x32x16_bf16 v[144:159], a[68:71], a[36:39], v[144:159]
    ds_read_b128 a[68:71], v248 offset:0
    v_exp_f32 v135, v135
    v_cvt_pk_bf16_f32 v194, v132, v133
    v_add_f32 v208, v208, v132
    v_add_f32 v209, v209, v133
    v_mfma_f32_32x32x16_bf16 v[144:159], a[72:75], a[40:43], v[144:159]
    ds_read_b128 a[72:75], v247 offset:64
    v_exp_f32 v136, v136
    v_exp_f32 v137, v137
    v_cvt_pk_bf16_f32 v195, v134, v135
    v_mfma_f32_32x32x16_bf16 v[144:159], a[76:79], a[44:47], v[144:159]
    ds_read_b128 a[76:79], v248 offset:64
    v_add_f32 v208, v208, v134
    v_add_f32 v209, v209, v135
    v_exp_f32 v138, v138
    v_exp_f32 v139, v139
    v_mfma_f32_32x32x16_bf16 v[144:159], a[80:83], a[48:51], v[144:159]
    ds_read_b128 a[80:83], v247 offset:128
    v_cvt_pk_bf16_f32 v196, v136, v137
    v_add_f32 v208, v208, v136
    v_add_f32 v209, v209, v137
    v_exp_f32 v140, v140
    v_mfma_f32_32x32x16_bf16 v[144:159], a[84:87], a[52:55], v[144:159]
    ds_read_b128 a[84:87], v248 offset:128
    v_exp_f32 v141, v141
    v_cvt_pk_bf16_f32 v197, v138, v139
    v_add_f32 v208, v208, v138
    v_add_f32 v209, v209, v139
    v_mfma_f32_32x32x16_bf16 v[144:159], a[88:91], a[56:59], v[144:159]
    ds_read_b128 a[88:91], v247 offset:192
    v_exp_f32 v142, v142
    v_exp_f32 v143, v143
    v_cvt_pk_bf16_f32 v198, v140, v141
    v_mfma_f32_32x32x16_bf16 v[144:159], a[92:95], a[60:63], v[144:159]
    ds_read_b128 a[92:95], v248 offset:192
    v_add_f32 v208, v208, v140
    v_add_f32 v209, v209, v141
    v_cvt_pk_bf16_f32 v199, v142, v143
    v_add_f32 v208, v208, v142
    v_add_f32 v209, v209, v143
    s_waitcnt lgkmcnt(8)
    v_mfma_f32_32x32x16_bf16 v[0:15], a[96:99], v[192:195], v[0:15]
    s_add_u32 m0, s29, s39
    v_mfma_f32_32x32x16_bf16 v[16:31], a[100:103], v[192:195], v[16:31]
    buffer_load_dwordx4 v232, s[44:47], s31 offen offset:0 lds
    v_mfma_f32_32x32x16_bf16 v[32:47], a[104:107], v[192:195], v[32:47]
    buffer_load_dwordx4 v233, s[44:47], s31 offen offset:1088 lds
    v_exp_f32 v144, v144
    v_exp_f32 v145, v145
    v_mfma_f32_32x32x16_bf16 v[48:63], a[108:111], v[192:195], v[48:63]
    buffer_load_dwordx4 v234, s[48:51], s31 offen offset:2176 lds
    v_exp_f32 v146, v146
    v_exp_f32 v147, v147
    v_mfma_f32_32x32x16_bf16 v[0:15], a[112:115], v[196:199], v[0:15]
    buffer_load_dwordx4 v235, s[48:51], s31 offen offset:3264 lds
    v_cvt_pk_bf16_f32 v200, v144, v145
    v_add_f32 v210, v210, v144
    v_add_f32 v211, v211, v145
    v_exp_f32 v148, v148
    v_mfma_f32_32x32x16_bf16 v[16:31], a[116:119], v[196:199], v[16:31]
    s_add_u32 s29, s29, 17920
    s_cmp_ge_u32 s29, 125440
    v_exp_f32 v149, v149
    v_cvt_pk_bf16_f32 v201, v146, v147
    v_mfma_f32_32x32x16_bf16 v[32:47], a[120:123], v[196:199], v[32:47]
    s_cselect_b32 s37, 125440, 0
    s_sub_u32 s29, s29, s37
    v_add_f32 v210, v210, v146
    v_add_f32 v211, v211, v147
    v_exp_f32 v150, v150
    v_mfma_f32_32x32x16_bf16 v[48:63], a[124:127], v[196:199], v[48:63]
    s_add_u32 s31, s31, s40
    v_exp_f32 v151, v151
    v_cvt_pk_bf16_f32 v202, v148, v149
    s_waitcnt lgkmcnt(0)
    v_mfma_f32_32x32x16_bf16 v[128:143], a[64:67], a[0:3], v[160:175]
    v_add_u32 v249, s42, v245
    v_add_f32 v210, v210, v148
    v_add_f32 v211, v211, v149
    v_exp_f32 v152, v152
    v_mfma_f32_32x32x16_bf16 v[128:143], a[68:71], a[4:7], v[128:143]
    s_add_u32 s42, s42, 17920
    s_cmp_ge_u32 s42, 125440
    v_exp_f32 v153, v153
    v_cvt_pk_bf16_f32 v203, v150, v151
    v_add_f32 v210, v210, v150
    v_mfma_f32_32x32x16_bf16 v[128:143], a[72:75], a[8:11], v[128:143]
    s_cselect_b32 s38, 125440, 0
    s_sub_u32 s42, s42, s38
    v_add_f32 v211, v211, v151
    v_exp_f32 v154, v154
    v_mfma_f32_32x32x16_bf16 v[128:143], a[76:79], a[12:15], v[128:143]
    v_add_u32 v247, s42, v243
    v_exp_f32 v155, v155
    v_cvt_pk_bf16_f32 v204, v152, v153
    v_add_f32 v210, v210, v152
    v_mfma_f32_32x32x16_bf16 v[128:143], a[80:83], a[16:19], v[128:143]
    v_add_u32 v248, s42, v244
    v_add_f32 v211, v211, v153
    v_exp_f32 v156, v156
    v_exp_f32 v157, v157
    v_mfma_f32_32x32x16_bf16 v[128:143], a[84:87], a[20:23], v[128:143]
    v_cvt_pk_bf16_f32 v205, v154, v155
    v_add_f32 v210, v210, v154
    v_add_f32 v211, v211, v155
    v_exp_f32 v158, v158
    v_mfma_f32_32x32x16_bf16 v[128:143], a[88:91], a[24:27], v[128:143]
    v_exp_f32 v159, v159
    v_cvt_pk_bf16_f32 v206, v156, v157
    v_add_f32 v210, v210, v156
    v_add_f32 v211, v211, v157
    v_mfma_f32_32x32x16_bf16 v[128:143], a[92:95], a[28:31], v[128:143]
    s_waitcnt vmcnt(16)
    s_barrier
    v_cvt_pk_bf16_f32 v207, v158, v159
    v_add_f32 v210, v210, v158
    v_add_f32 v211, v211, v159
    v_mfma_f32_32x32x16_bf16 v[64:79], a[96:99], v[200:203], v[64:79]
    ds_read_b64_tr_b16 a[96:97], v249 offset:0
    ds_read_b64_tr_b16 a[98:99], v249 offset:512
    v_mfma_f32_32x32x16_bf16 v[80:95], a[100:103], v[200:203], v[80:95]
    ds_read_b64_tr_b16 a[100:101], v249 offset:64
    ds_read_b64_tr_b16 a[102:103], v249 offset:576
    v_mfma_f32_32x32x16_bf16 v[96:111], a[104:107], v[200:203], v[96:111]
    ds_read_b64_tr_b16 a[104:105], v249 offset:128
    ds_read_b64_tr_b16 a[106:107], v249 offset:640
    v_exp_f32 v128, v128
    v_exp_f32 v129, v129
    v_mfma_f32_32x32x16_bf16 v[112:127], a[108:111], v[200:203], v[112:127]
    ds_read_b64_tr_b16 a[108:109], v249 offset:192
    ds_read_b64_tr_b16 a[110:111], v249 offset:704
    v_exp_f32 v130, v130
    v_mfma_f32_32x32x16_bf16 v[64:79], a[112:115], v[204:207], v[64:79]
    ds_read_b64_tr_b16 a[112:113], v249 offset:8960
    ds_read_b64_tr_b16 a[114:115], v249 offset:9472
    v_exp_f32 v131, v131
    v_cvt_pk_bf16_f32 v192, v128, v129
    v_add_f32 v208, v208, v128
    v_mfma_f32_32x32x16_bf16 v[80:95], a[116:119], v[204:207], v[80:95]
    ds_read_b64_tr_b16 a[116:117], v249 offset:9024
    ds_read_b64_tr_b16 a[118:119], v249 offset:9536
    v_add_f32 v209, v209, v129
    v_exp_f32 v132, v132
    v_mfma_f32_32x32x16_bf16 v[96:111], a[120:123], v[204:207], v[96:111]
    ds_read_b64_tr_b16 a[120:121], v249 offset:9088
    ds_read_b64_tr_b16 a[122:123], v249 offset:9600
    v_exp_f32 v133, v133
    v_cvt_pk_bf16_f32 v193, v130, v131
    v_add_f32 v208, v208, v130
    v_mfma_f32_32x32x16_bf16 v[112:127], a[124:127], v[204:207], v[112:127]
    ds_read_b64_tr_b16 a[124:125], v249 offset:9152
    ds_read_b64_tr_b16 a[126:127], v249 offset:9664
    v_add_f32 v209, v209, v131
    v_exp_f32 v134, v134
    v_mfma_f32_32x32x16_bf16 v[144:159], a[64:67], a[32:35], v[176:191]
    ds_read_b128 a[64:67], v247 offset:0
    v_exp_f32 v135, v135
    v_cvt_pk_bf16_f32 v194, v132, v133
    v_add_f32 v208, v208, v132
    v_add_f32 v209, v209, v133
    v_mfma_f32_32x32x16_bf16 v[144:159], a[68:71], a[36:39], v[144:159]
    ds_read_b128 a[68:71], v248 offset:0
    v_exp_f32 v136, v136
    v_exp_f32 v137, v137
    v_mfma_f32_32x32x16_bf16 v[144:159], a[72:75], a[40:43], v[144:159]
    ds_read_b128 a[72:75], v247 offset:64
    v_cvt_pk_bf16_f32 v195, v134, v135
    v_add_f32 v208, v208, v134
    v_add_f32 v209, v209, v135
    v_exp_f32 v138, v138
    v_mfma_f32_32x32x16_bf16 v[144:159], a[76:79], a[44:47], v[144:159]
    ds_read_b128 a[76:79], v248 offset:64
    v_exp_f32 v139, v139
    v_cvt_pk_bf16_f32 v196, v136, v137
    v_add_f32 v208, v208, v136
    v_mfma_f32_32x32x16_bf16 v[144:159], a[80:83], a[48:51], v[144:159]
    ds_read_b128 a[80:83], v247 offset:128
    v_add_f32 v209, v209, v137
    v_exp_f32 v140, v140
    v_exp_f32 v141, v141
    v_mfma_f32_32x32x16_bf16 v[144:159], a[84:87], a[52:55], v[144:159]
    ds_read_b128 a[84:87], v248 offset:128
    v_cvt_pk_bf16_f32 v197, v138, v139
    v_add_f32 v208, v208, v138
    v_add_f32 v209, v209, v139
    v_exp_f32 v142, v142
    v_mfma_f32_32x32x16_bf16 v[144:159], a[88:91], a[56:59], v[144:159]
    ds_read_b128 a[88:91], v247 offset:192
    v_exp_f32 v143, v143
    v_cvt_pk_bf16_f32 v198, v140, v141
    v_add_f32 v208, v208, v140
    v_mfma_f32_32x32x16_bf16 v[144:159], a[92:95], a[60:63], v[144:159]
    ds_read_b128 a[92:95], v248 offset:192
    v_add_f32 v209, v209, v141
    v_cvt_pk_bf16_f32 v199, v142, v143
    v_add_f32 v208, v208, v142
    v_add_f32 v209, v209, v143
    s_waitcnt lgkmcnt(8)
    v_mfma_f32_32x32x16_bf16 v[0:15], a[96:99], v[192:195], v[0:15]
    s_add_u32 m0, s29, s39
    v_mfma_f32_32x32x16_bf16 v[16:31], a[100:103], v[192:195], v[16:31]
    buffer_load_dwordx4 v232, s[44:47], s31 offen offset:0 lds
    v_mfma_f32_32x32x16_bf16 v[32:47], a[104:107], v[192:195], v[32:47]
    buffer_load_dwordx4 v233, s[44:47], s31 offen offset:1088 lds
    v_exp_f32 v144, v144
    v_exp_f32 v145, v145
    v_mfma_f32_32x32x16_bf16 v[48:63], a[108:111], v[192:195], v[48:63]
    buffer_load_dwordx4 v234, s[48:51], s31 offen offset:2176 lds
    v_exp_f32 v146, v146
    v_exp_f32 v147, v147
    v_mfma_f32_32x32x16_bf16 v[0:15], a[112:115], v[196:199], v[0:15]
    buffer_load_dwordx4 v235, s[48:51], s31 offen offset:3264 lds
    v_cvt_pk_bf16_f32 v200, v144, v145
    v_add_f32 v210, v210, v144
    v_add_f32 v211, v211, v145
    v_exp_f32 v148, v148
    v_mfma_f32_32x32x16_bf16 v[16:31], a[116:119], v[196:199], v[16:31]
    s_add_u32 s29, s29, 17920
    s_cmp_ge_u32 s29, 125440
    v_exp_f32 v149, v149
    v_cvt_pk_bf16_f32 v201, v146, v147
    v_mfma_f32_32x32x16_bf16 v[32:47], a[120:123], v[196:199], v[32:47]
    s_cselect_b32 s37, 125440, 0
    s_sub_u32 s29, s29, s37
    v_add_f32 v210, v210, v146
    v_add_f32 v211, v211, v147
    v_exp_f32 v150, v150
    v_mfma_f32_32x32x16_bf16 v[48:63], a[124:127], v[196:199], v[48:63]
    s_add_u32 s31, s31, s40
    v_exp_f32 v151, v151
    v_cvt_pk_bf16_f32 v202, v148, v149
    s_waitcnt lgkmcnt(0)
    v_mfma_f32_32x32x16_bf16 v[128:143], a[64:67], a[0:3], v[160:175]
    v_add_u32 v249, s42, v245
    v_add_f32 v210, v210, v148
    v_add_f32 v211, v211, v149
    v_exp_f32 v152, v152
    v_mfma_f32_32x32x16_bf16 v[128:143], a[68:71], a[4:7], v[128:143]
    s_add_u32 s42, s42, 17920
    s_cmp_ge_u32 s42, 125440
    v_exp_f32 v153, v153
    v_cvt_pk_bf16_f32 v203, v150, v151
    v_add_f32 v210, v210, v150
    v_mfma_f32_32x32x16_bf16 v[128:143], a[72:75], a[8:11], v[128:143]
    s_cselect_b32 s38, 125440, 0
    s_sub_u32 s42, s42, s38
    v_add_f32 v211, v211, v151
    v_exp_f32 v154, v154
    v_mfma_f32_32x32x16_bf16 v[128:143], a[76:79], a[12:15], v[128:143]
    v_add_u32 v247, s42, v243
    v_exp_f32 v155, v155
    v_cvt_pk_bf16_f32 v204, v152, v153
    v_add_f32 v210, v210, v152
    v_mfma_f32_32x32x16_bf16 v[128:143], a[80:83], a[16:19], v[128:143]
    v_add_u32 v248, s42, v244
    v_add_f32 v211, v211, v153
    v_exp_f32 v156, v156
    v_exp_f32 v157, v157
    v_mfma_f32_32x32x16_bf16 v[128:143], a[84:87], a[20:23], v[128:143]
    v_cvt_pk_bf16_f32 v205, v154, v155
    v_add_f32 v210, v210, v154
    v_add_f32 v211, v211, v155
    v_exp_f32 v158, v158
    v_mfma_f32_32x32x16_bf16 v[128:143], a[88:91], a[24:27], v[128:143]
    v_exp_f32 v159, v159
    v_cvt_pk_bf16_f32 v206, v156, v157
    v_add_f32 v210, v210, v156
    v_add_f32 v211, v211, v157
    v_mfma_f32_32x32x16_bf16 v[128:143], a[92:95], a[28:31], v[128:143]
    s_waitcnt vmcnt(16)
    s_barrier
    v_cvt_pk_bf16_f32 v207, v158, v159
    v_add_f32 v210, v210, v158
    v_add_f32 v211, v211, v159
    v_mfma_f32_32x32x16_bf16 v[64:79], a[96:99], v[200:203], v[64:79]
    ds_read_b64_tr_b16 a[96:97], v249 offset:0
    ds_read_b64_tr_b16 a[98:99], v249 offset:512
    v_mfma_f32_32x32x16_bf16 v[80:95], a[100:103], v[200:203], v[80:95]
    ds_read_b64_tr_b16 a[100:101], v249 offset:64
    ds_read_b64_tr_b16 a[102:103], v249 offset:576
    v_mfma_f32_32x32x16_bf16 v[96:111], a[104:107], v[200:203], v[96:111]
    ds_read_b64_tr_b16 a[104:105], v249 offset:128
    ds_read_b64_tr_b16 a[106:107], v249 offset:640
    v_exp_f32 v128, v128
    v_exp_f32 v129, v129
    v_mfma_f32_32x32x16_bf16 v[112:127], a[108:111], v[200:203], v[112:127]
    ds_read_b64_tr_b16 a[108:109], v249 offset:192
    ds_read_b64_tr_b16 a[110:111], v249 offset:704
    v_exp_f32 v130, v130
    v_mfma_f32_32x32x16_bf16 v[64:79], a[112:115], v[204:207], v[64:79]
    ds_read_b64_tr_b16 a[112:113], v249 offset:8960
    ds_read_b64_tr_b16 a[114:115], v249 offset:9472
    v_exp_f32 v131, v131
    v_cvt_pk_bf16_f32 v192, v128, v129
    v_add_f32 v208, v208, v128
    v_mfma_f32_32x32x16_bf16 v[80:95], a[116:119], v[204:207], v[80:95]
    ds_read_b64_tr_b16 a[116:117], v249 offset:9024
    ds_read_b64_tr_b16 a[118:119], v249 offset:9536
    v_add_f32 v209, v209, v129
    v_exp_f32 v132, v132
    v_mfma_f32_32x32x16_bf16 v[96:111], a[120:123], v[204:207], v[96:111]
    ds_read_b64_tr_b16 a[120:121], v249 offset:9088
    ds_read_b64_tr_b16 a[122:123], v249 offset:9600
    v_exp_f32 v133, v133
    v_cvt_pk_bf16_f32 v193, v130, v131
    v_add_f32 v208, v208, v130
    v_mfma_f32_32x32x16_bf16 v[112:127], a[124:127], v[204:207], v[112:127]
    ds_read_b64_tr_b16 a[124:125], v249 offset:9152
    ds_read_b64_tr_b16 a[126:127], v249 offset:9664
    v_add_f32 v209, v209, v131
    v_exp_f32 v134, v134
    v_mfma_f32_32x32x16_bf16 v[144:159], a[64:67], a[32:35], v[176:191]
    ds_read_b128 a[64:67], v247 offset:0
    v_exp_f32 v135, v135
    v_cvt_pk_bf16_f32 v194, v132, v133
    v_add_f32 v208, v208, v132
    v_add_f32 v209, v209, v133
    v_mfma_f32_32x32x16_bf16 v[144:159], a[68:71], a[36:39], v[144:159]
    ds_read_b128 a[68:71], v248 offset:0
    v_exp_f32 v136, v136
    v_exp_f32 v137, v137
    v_mfma_f32_32x32x16_bf16 v[144:159], a[72:75], a[40:43], v[144:159]
    ds_read_b128 a[72:75], v247 offset:64
    v_cvt_pk_bf16_f32 v195, v134, v135
    v_add_f32 v208, v208, v134
    v_add_f32 v209, v209, v135
    v_exp_f32 v138, v138
    v_mfma_f32_32x32x16_bf16 v[144:159], a[76:79], a[44:47], v[144:159]
    ds_read_b128 a[76:79], v248 offset:64
    v_exp_f32 v139, v139
    v_cvt_pk_bf16_f32 v196, v136, v137
    v_add_f32 v208, v208, v136
    v_mfma_f32_32x32x16_bf16 v[144:159], a[80:83], a[48:51], v[144:159]
    ds_read_b128 a[80:83], v247 offset:128
    v_add_f32 v209, v209, v137
    v_exp_f32 v140, v140
    v_exp_f32 v141, v141
    v_mfma_f32_32x32x16_bf16 v[144:159], a[84:87], a[52:55], v[144:159]
    ds_read_b128 a[84:87], v248 offset:128
    v_cvt_pk_bf16_f32 v197, v138, v139
    v_add_f32 v208, v208, v138
    v_add_f32 v209, v209, v139
    v_exp_f32 v142, v142
    v_mfma_f32_32x32x16_bf16 v[144:159], a[88:91], a[56:59], v[144:159]
    ds_read_b128 a[88:91], v247 offset:192
    v_exp_f32 v143, v143
    v_cvt_pk_bf16_f32 v198, v140, v141
    v_add_f32 v208, v208, v140
    v_mfma_f32_32x32x16_bf16 v[144:159], a[92:95], a[60:63], v[144:159]
    ds_read_b128 a[92:95], v248 offset:192
    v_add_f32 v209, v209, v141
    v_cvt_pk_bf16_f32 v199, v142, v143
    v_add_f32 v208, v208, v142
    v_add_f32 v209, v209, v143
    s_waitcnt lgkmcnt(8)
    v_mfma_f32_32x32x16_bf16 v[0:15], a[96:99], v[192:195], v[0:15]
    s_add_u32 m0, s29, s39
    v_mfma_f32_32x32x16_bf16 v[16:31], a[100:103], v[192:195], v[16:31]
    buffer_load_dwordx4 v232, s[44:47], s31 offen offset:0 lds
    v_mfma_f32_32x32x16_bf16 v[32:47], a[104:107], v[192:195], v[32:47]
    buffer_load_dwordx4 v233, s[44:47], s31 offen offset:1088 lds
    v_exp_f32 v144, v144
    v_exp_f32 v145, v145
    v_mfma_f32_32x32x16_bf16 v[48:63], a[108:111], v[192:195], v[48:63]
    buffer_load_dwordx4 v234, s[48:51], s31 offen offset:2176 lds
    v_exp_f32 v146, v146
    v_exp_f32 v147, v147
    v_mfma_f32_32x32x16_bf16 v[0:15], a[112:115], v[196:199], v[0:15]
    buffer_load_dwordx4 v235, s[48:51], s31 offen offset:3264 lds
    v_cvt_pk_bf16_f32 v200, v144, v145
    v_add_f32 v210, v210, v144
    v_add_f32 v211, v211, v145
    v_exp_f32 v148, v148
    v_mfma_f32_32x32x16_bf16 v[16:31], a[116:119], v[196:199], v[16:31]
    s_add_u32 s29, s29, 17920
    s_cmp_ge_u32 s29, 125440
    v_exp_f32 v149, v149
    v_cvt_pk_bf16_f32 v201, v146, v147
    v_mfma_f32_32x32x16_bf16 v[32:47], a[120:123], v[196:199], v[32:47]
    s_cselect_b32 s37, 125440, 0
    s_sub_u32 s29, s29, s37
    v_add_f32 v210, v210, v146
    v_add_f32 v211, v211, v147
    v_exp_f32 v150, v150
    v_mfma_f32_32x32x16_bf16 v[48:63], a[124:127], v[196:199], v[48:63]
    s_add_u32 s31, s31, s40
    v_exp_f32 v151, v151
    v_cvt_pk_bf16_f32 v202, v148, v149
    s_waitcnt lgkmcnt(0)
    v_mfma_f32_32x32x16_bf16 v[128:143], a[64:67], a[0:3], v[160:175]
    v_add_u32 v249, s42, v245
    v_add_f32 v210, v210, v148
    v_add_f32 v211, v211, v149
    v_exp_f32 v152, v152
    v_mfma_f32_32x32x16_bf16 v[128:143], a[68:71], a[4:7], v[128:143]
    s_add_u32 s42, s42, 17920
    s_cmp_ge_u32 s42, 125440
    v_exp_f32 v153, v153
    v_cvt_pk_bf16_f32 v203, v150, v151
    v_add_f32 v210, v210, v150
    v_mfma_f32_32x32x16_bf16 v[128:143], a[72:75], a[8:11], v[128:143]
    s_cselect_b32 s38, 125440, 0
    s_sub_u32 s42, s42, s38
    v_add_f32 v211, v211, v151
    v_exp_f32 v154, v154
    v_mfma_f32_32x32x16_bf16 v[128:143], a[76:79], a[12:15], v[128:143]
    v_add_u32 v247, s42, v243
    v_exp_f32 v155, v155
    v_cvt_pk_bf16_f32 v204, v152, v153
    v_add_f32 v210, v210, v152
    v_mfma_f32_32x32x16_bf16 v[128:143], a[80:83], a[16:19], v[128:143]
    v_add_u32 v248, s42, v244
    v_add_f32 v211, v211, v153
    v_exp_f32 v156, v156
    v_exp_f32 v157, v157
    v_mfma_f32_32x32x16_bf16 v[128:143], a[84:87], a[20:23], v[128:143]
    v_cvt_pk_bf16_f32 v205, v154, v155
    v_add_f32 v210, v210, v154
    v_add_f32 v211, v211, v155
    v_exp_f32 v158, v158
    v_mfma_f32_32x32x16_bf16 v[128:143], a[88:91], a[24:27], v[128:143]
    v_exp_f32 v159, v159
    v_cvt_pk_bf16_f32 v206, v156, v157
    v_add_f32 v210, v210, v156
    v_add_f32 v211, v211, v157
    v_mfma_f32_32x32x16_bf16 v[128:143], a[92:95], a[28:31], v[128:143]
    s_waitcnt vmcnt(16)
    s_barrier
    v_cvt_pk_bf16_f32 v207, v158, v159
    v_add_f32 v210, v210, v158
    v_add_f32 v211, v211, v159
    v_mfma_f32_32x32x16_bf16 v[64:79], a[96:99], v[200:203], v[64:79]
    ds_read_b64_tr_b16 a[96:97], v249 offset:0
    ds_read_b64_tr_b16 a[98:99], v249 offset:512
    v_mfma_f32_32x32x16_bf16 v[80:95], a[100:103], v[200:203], v[80:95]
    ds_read_b64_tr_b16 a[100:101], v249 offset:64
    ds_read_b64_tr_b16 a[102:103], v249 offset:576
    v_mfma_f32_32x32x16_bf16 v[96:111], a[104:107], v[200:203], v[96:111]
    ds_read_b64_tr_b16 a[104:105], v249 offset:128
    ds_read_b64_tr_b16 a[106:107], v249 offset:640
    v_exp_f32 v128, v128
    v_exp_f32 v129, v129
    v_mfma_f32_32x32x16_bf16 v[112:127], a[108:111], v[200:203], v[112:127]
    ds_read_b64_tr_b16 a[108:109], v249 offset:192
    ds_read_b64_tr_b16 a[110:111], v249 offset:704
    v_exp_f32 v130, v130
    v_mfma_f32_32x32x16_bf16 v[64:79], a[112:115], v[204:207], v[64:79]
    ds_read_b64_tr_b16 a[112:113], v249 offset:8960
    ds_read_b64_tr_b16 a[114:115], v249 offset:9472
    v_exp_f32 v131, v131
    v_cvt_pk_bf16_f32 v192, v128, v129
    v_add_f32 v208, v208, v128
    v_mfma_f32_32x32x16_bf16 v[80:95], a[116:119], v[204:207], v[80:95]
    ds_read_b64_tr_b16 a[116:117], v249 offset:9024
    ds_read_b64_tr_b16 a[118:119], v249 offset:9536
    v_add_f32 v209, v209, v129
    v_exp_f32 v132, v132
    v_mfma_f32_32x32x16_bf16 v[96:111], a[120:123], v[204:207], v[96:111]
    ds_read_b64_tr_b16 a[120:121], v249 offset:9088
    ds_read_b64_tr_b16 a[122:123], v249 offset:9600
    v_exp_f32 v133, v133
    v_cvt_pk_bf16_f32 v193, v130, v131
    v_add_f32 v208, v208, v130
    v_mfma_f32_32x32x16_bf16 v[112:127], a[124:127], v[204:207], v[112:127]
    ds_read_b64_tr_b16 a[124:125], v249 offset:9152
    ds_read_b64_tr_b16 a[126:127], v249 offset:9664
    v_add_f32 v209, v209, v131
    v_exp_f32 v134, v134
    v_mfma_f32_32x32x16_bf16 v[144:159], a[64:67], a[32:35], v[176:191]
    ds_read_b128 a[64:67], v247 offset:0
    v_exp_f32 v135, v135
    v_cvt_pk_bf16_f32 v194, v132, v133
    v_add_f32 v208, v208, v132
    v_add_f32 v209, v209, v133
    v_mfma_f32_32x32x16_bf16 v[144:159], a[68:71], a[36:39], v[144:159]
    ds_read_b128 a[68:71], v248 offset:0
    v_exp_f32 v136, v136
    v_exp_f32 v137, v137
    v_mfma_f32_32x32x16_bf16 v[144:159], a[72:75], a[40:43], v[144:159]
    ds_read_b128 a[72:75], v247 offset:64
    v_cvt_pk_bf16_f32 v195, v134, v135
    v_add_f32 v208, v208, v134
    v_add_f32 v209, v209, v135
    v_exp_f32 v138, v138
    v_mfma_f32_32x32x16_bf16 v[144:159], a[76:79], a[44:47], v[144:159]
    ds_read_b128 a[76:79], v248 offset:64
    v_exp_f32 v139, v139
    v_cvt_pk_bf16_f32 v196, v136, v137
    v_add_f32 v208, v208, v136
    v_mfma_f32_32x32x16_bf16 v[144:159], a[80:83], a[48:51], v[144:159]
    ds_read_b128 a[80:83], v247 offset:128
    v_add_f32 v209, v209, v137
    v_exp_f32 v140, v140
    v_exp_f32 v141, v141
    v_mfma_f32_32x32x16_bf16 v[144:159], a[84:87], a[52:55], v[144:159]
    ds_read_b128 a[84:87], v248 offset:128
    v_cvt_pk_bf16_f32 v197, v138, v139
    v_add_f32 v208, v208, v138
    v_add_f32 v209, v209, v139
    v_exp_f32 v142, v142
    v_mfma_f32_32x32x16_bf16 v[144:159], a[88:91], a[56:59], v[144:159]
    ds_read_b128 a[88:91], v247 offset:192
    v_exp_f32 v143, v143
    v_cvt_pk_bf16_f32 v198, v140, v141
    v_add_f32 v208, v208, v140
    v_mfma_f32_32x32x16_bf16 v[144:159], a[92:95], a[60:63], v[144:159]
    ds_read_b128 a[92:95], v248 offset:192
    v_add_f32 v209, v209, v141
    v_cvt_pk_bf16_f32 v199, v142, v143
    v_add_f32 v208, v208, v142
    v_add_f32 v209, v209, v143
    s_waitcnt lgkmcnt(8)
    v_mfma_f32_32x32x16_bf16 v[0:15], a[96:99], v[192:195], v[0:15]
    s_add_u32 m0, s29, s39
    v_mfma_f32_32x32x16_bf16 v[16:31], a[100:103], v[192:195], v[16:31]
    buffer_load_dwordx4 v232, s[44:47], s31 offen offset:0 lds
    v_mfma_f32_32x32x16_bf16 v[32:47], a[104:107], v[192:195], v[32:47]
    buffer_load_dwordx4 v233, s[44:47], s31 offen offset:1088 lds
    v_exp_f32 v144, v144
    v_exp_f32 v145, v145
    v_mfma_f32_32x32x16_bf16 v[48:63], a[108:111], v[192:195], v[48:63]
    buffer_load_dwordx4 v234, s[48:51], s31 offen offset:2176 lds
    v_exp_f32 v146, v146
    v_exp_f32 v147, v147
    v_mfma_f32_32x32x16_bf16 v[0:15], a[112:115], v[196:199], v[0:15]
    buffer_load_dwordx4 v235, s[48:51], s31 offen offset:3264 lds
    v_cvt_pk_bf16_f32 v200, v144, v145
    v_add_f32 v210, v210, v144
    v_add_f32 v211, v211, v145
    v_exp_f32 v148, v148
    v_mfma_f32_32x32x16_bf16 v[16:31], a[116:119], v[196:199], v[16:31]
    s_add_u32 s29, s29, 17920
    s_cmp_ge_u32 s29, 125440
    v_exp_f32 v149, v149
    v_cvt_pk_bf16_f32 v201, v146, v147
    v_mfma_f32_32x32x16_bf16 v[32:47], a[120:123], v[196:199], v[32:47]
    s_cselect_b32 s37, 125440, 0
    s_sub_u32 s29, s29, s37
    v_add_f32 v210, v210, v146
    v_add_f32 v211, v211, v147
    v_exp_f32 v150, v150
    v_mfma_f32_32x32x16_bf16 v[48:63], a[124:127], v[196:199], v[48:63]
    s_add_u32 s31, s31, s40
    v_exp_f32 v151, v151
    v_cvt_pk_bf16_f32 v202, v148, v149
    s_waitcnt lgkmcnt(0)
    v_mfma_f32_32x32x16_bf16 v[128:143], a[64:67], a[0:3], v[160:175]
    v_add_u32 v249, s42, v245
    v_add_f32 v210, v210, v148
    v_add_f32 v211, v211, v149
    v_exp_f32 v152, v152
    v_mfma_f32_32x32x16_bf16 v[128:143], a[68:71], a[4:7], v[128:143]
    s_add_u32 s42, s42, 17920
    s_cmp_ge_u32 s42, 125440
    v_exp_f32 v153, v153
    v_cvt_pk_bf16_f32 v203, v150, v151
    v_add_f32 v210, v210, v150
    v_mfma_f32_32x32x16_bf16 v[128:143], a[72:75], a[8:11], v[128:143]
    s_cselect_b32 s38, 125440, 0
    s_sub_u32 s42, s42, s38
    v_add_f32 v211, v211, v151
    v_exp_f32 v154, v154
    v_mfma_f32_32x32x16_bf16 v[128:143], a[76:79], a[12:15], v[128:143]
    v_add_u32 v247, s42, v243
    v_exp_f32 v155, v155
    v_cvt_pk_bf16_f32 v204, v152, v153
    v_add_f32 v210, v210, v152
    v_mfma_f32_32x32x16_bf16 v[128:143], a[80:83], a[16:19], v[128:143]
    v_add_u32 v248, s42, v244
    v_add_f32 v211, v211, v153
    v_exp_f32 v156, v156
    v_exp_f32 v157, v157
    v_mfma_f32_32x32x16_bf16 v[128:143], a[84:87], a[20:23], v[128:143]
    v_cvt_pk_bf16_f32 v205, v154, v155
    v_add_f32 v210, v210, v154
    v_add_f32 v211, v211, v155
    v_exp_f32 v158, v158
    v_mfma_f32_32x32x16_bf16 v[128:143], a[88:91], a[24:27], v[128:143]
    v_exp_f32 v159, v159
    v_cvt_pk_bf16_f32 v206, v156, v157
    v_add_f32 v210, v210, v156
    v_add_f32 v211, v211, v157
    v_mfma_f32_32x32x16_bf16 v[128:143], a[92:95], a[28:31], v[128:143]
    s_waitcnt vmcnt(16)
    s_barrier
    v_cvt_pk_bf16_f32 v207, v158, v159
    v_add_f32 v210, v210, v158
    v_add_f32 v211, v211, v159
    v_mfma_f32_32x32x16_bf16 v[64:79], a[96:99], v[200:203], v[64:79]
    ds_read_b64_tr_b16 a[96:97], v249 offset:0
    ds_read_b64_tr_b16 a[98:99], v249 offset:512
    v_mfma_f32_32x32x16_bf16 v[80:95], a[100:103], v[200:203], v[80:95]
    ds_read_b64_tr_b16 a[100:101], v249 offset:64
    ds_read_b64_tr_b16 a[102:103], v249 offset:576
    v_mfma_f32_32x32x16_bf16 v[96:111], a[104:107], v[200:203], v[96:111]
    ds_read_b64_tr_b16 a[104:105], v249 offset:128
    ds_read_b64_tr_b16 a[106:107], v249 offset:640
    v_exp_f32 v128, v128
    v_exp_f32 v129, v129
    v_mfma_f32_32x32x16_bf16 v[112:127], a[108:111], v[200:203], v[112:127]
    ds_read_b64_tr_b16 a[108:109], v249 offset:192
    ds_read_b64_tr_b16 a[110:111], v249 offset:704
    v_exp_f32 v130, v130
    v_mfma_f32_32x32x16_bf16 v[64:79], a[112:115], v[204:207], v[64:79]
    ds_read_b64_tr_b16 a[112:113], v249 offset:8960
    ds_read_b64_tr_b16 a[114:115], v249 offset:9472
    v_exp_f32 v131, v131
    v_cvt_pk_bf16_f32 v192, v128, v129
    v_add_f32 v208, v208, v128
    v_mfma_f32_32x32x16_bf16 v[80:95], a[116:119], v[204:207], v[80:95]
    ds_read_b64_tr_b16 a[116:117], v249 offset:9024
    ds_read_b64_tr_b16 a[118:119], v249 offset:9536
    v_add_f32 v209, v209, v129
    v_exp_f32 v132, v132
    v_mfma_f32_32x32x16_bf16 v[96:111], a[120:123], v[204:207], v[96:111]
    ds_read_b64_tr_b16 a[120:121], v249 offset:9088
    ds_read_b64_tr_b16 a[122:123], v249 offset:9600
    v_exp_f32 v133, v133
    v_cvt_pk_bf16_f32 v193, v130, v131
    v_add_f32 v208, v208, v130
    v_mfma_f32_32x32x16_bf16 v[112:127], a[124:127], v[204:207], v[112:127]
    ds_read_b64_tr_b16 a[124:125], v249 offset:9152
    ds_read_b64_tr_b16 a[126:127], v249 offset:9664
    v_add_f32 v209, v209, v131
    v_exp_f32 v134, v134
    v_mfma_f32_32x32x16_bf16 v[144:159], a[64:67], a[32:35], v[176:191]
    ds_read_b128 a[64:67], v247 offset:0
    v_exp_f32 v135, v135
    v_cvt_pk_bf16_f32 v194, v132, v133
    v_add_f32 v208, v208, v132
    v_add_f32 v209, v209, v133
    v_mfma_f32_32x32x16_bf16 v[144:159], a[68:71], a[36:39], v[144:159]
    ds_read_b128 a[68:71], v248 offset:0
    v_exp_f32 v136, v136
    v_exp_f32 v137, v137
    v_mfma_f32_32x32x16_bf16 v[144:159], a[72:75], a[40:43], v[144:159]
    ds_read_b128 a[72:75], v247 offset:64
    v_cvt_pk_bf16_f32 v195, v134, v135
    v_add_f32 v208, v208, v134
    v_add_f32 v209, v209, v135
    v_exp_f32 v138, v138
    v_mfma_f32_32x32x16_bf16 v[144:159], a[76:79], a[44:47], v[144:159]
    ds_read_b128 a[76:79], v248 offset:64
    v_exp_f32 v139, v139
    v_cvt_pk_bf16_f32 v196, v136, v137
    v_add_f32 v208, v208, v136
    v_mfma_f32_32x32x16_bf16 v[144:159], a[80:83], a[48:51], v[144:159]
    ds_read_b128 a[80:83], v247 offset:128
    v_add_f32 v209, v209, v137
    v_exp_f32 v140, v140
    v_exp_f32 v141, v141
    v_mfma_f32_32x32x16_bf16 v[144:159], a[84:87], a[52:55], v[144:159]
    ds_read_b128 a[84:87], v248 offset:128
    v_cvt_pk_bf16_f32 v197, v138, v139
    v_add_f32 v208, v208, v138
    v_add_f32 v209, v209, v139
    v_exp_f32 v142, v142
    v_mfma_f32_32x32x16_bf16 v[144:159], a[88:91], a[56:59], v[144:159]
    ds_read_b128 a[88:91], v247 offset:192
    v_exp_f32 v143, v143
    v_cvt_pk_bf16_f32 v198, v140, v141
    v_add_f32 v208, v208, v140
    v_mfma_f32_32x32x16_bf16 v[144:159], a[92:95], a[60:63], v[144:159]
    ds_read_b128 a[92:95], v248 offset:192
    v_add_f32 v209, v209, v141
    v_cvt_pk_bf16_f32 v199, v142, v143
    v_add_f32 v208, v208, v142
    v_add_f32 v209, v209, v143
    s_waitcnt lgkmcnt(8)
    v_mfma_f32_32x32x16_bf16 v[0:15], a[96:99], v[192:195], v[0:15]
    s_add_u32 m0, s29, s39
    v_mfma_f32_32x32x16_bf16 v[16:31], a[100:103], v[192:195], v[16:31]
    buffer_load_dwordx4 v232, s[44:47], s31 offen offset:0 lds
    v_mfma_f32_32x32x16_bf16 v[32:47], a[104:107], v[192:195], v[32:47]
    buffer_load_dwordx4 v233, s[44:47], s31 offen offset:1088 lds
    v_exp_f32 v144, v144
    v_exp_f32 v145, v145
    v_mfma_f32_32x32x16_bf16 v[48:63], a[108:111], v[192:195], v[48:63]
    buffer_load_dwordx4 v234, s[48:51], s31 offen offset:2176 lds
    v_exp_f32 v146, v146
    v_exp_f32 v147, v147
    v_cvt_pk_bf16_f32 v200, v144, v145
    v_mfma_f32_32x32x16_bf16 v[0:15], a[112:115], v[196:199], v[0:15]
    buffer_load_dwordx4 v235, s[48:51], s31 offen offset:3264 lds
    v_add_f32 v210, v210, v144
    v_add_f32 v211, v211, v145
    v_exp_f32 v148, v148
    v_mfma_f32_32x32x16_bf16 v[16:31], a[116:119], v[196:199], v[16:31]
    s_add_u32 s29, s29, 17920
    s_cmp_ge_u32 s29, 125440
    v_exp_f32 v149, v149
    v_cvt_pk_bf16_f32 v201, v146, v147
    v_add_f32 v210, v210, v146
    v_mfma_f32_32x32x16_bf16 v[32:47], a[120:123], v[196:199], v[32:47]
    s_cselect_b32 s37, 125440, 0
    s_sub_u32 s29, s29, s37
    v_add_f32 v211, v211, v147
    v_exp_f32 v150, v150
    v_mfma_f32_32x32x16_bf16 v[48:63], a[124:127], v[196:199], v[48:63]
    s_add_u32 s31, s31, s40
    v_exp_f32 v151, v151
    v_cvt_pk_bf16_f32 v202, v148, v149
    v_add_f32 v210, v210, v148
    v_add_f32 v211, v211, v149
    s_waitcnt lgkmcnt(0)
    v_mfma_f32_32x32x16_bf16 v[128:143], a[64:67], a[0:3], v[160:175]
    v_add_u32 v249, s42, v245
    v_add_u32 v224, 0, v252
    v_exp_f32 v152, v152
    v_exp_f32 v153, v153
    v_mfma_f32_32x32x16_bf16 v[128:143], a[68:71], a[4:7], v[128:143]
    s_add_u32 s42, s42, 17920
    s_cmp_ge_u32 s42, 125440
    v_cvt_pk_bf16_f32 v203, v150, v151
    v_add_f32 v210, v210, v150
    v_mfma_f32_32x32x16_bf16 v[128:143], a[72:75], a[8:11], v[128:143]
    s_cselect_b32 s38, 125440, 0
    s_sub_u32 s42, s42, s38
    v_add_f32 v211, v211, v151
    v_exp_f32 v154, v154
    v_mfma_f32_32x32x16_bf16 v[128:143], a[76:79], a[12:15], v[128:143]
    v_add_u32 v247, s42, v243
    v_mul_u32_u24 v225, 6554, v224
    v_exp_f32 v155, v155
    v_cvt_pk_bf16_f32 v204, v152, v153
    v_add_f32 v210, v210, v152
    v_mfma_f32_32x32x16_bf16 v[128:143], a[80:83], a[16:19], v[128:143]
    v_add_u32 v248, s42, v244
    v_add_f32 v211, v211, v153
    v_exp_f32 v156, v156
    v_exp_f32 v157, v157
    v_mfma_f32_32x32x16_bf16 v[128:143], a[84:87], a[20:23], v[128:143]
    v_cvt_pk_bf16_f32 v205, v154, v155
    v_add_f32 v210, v210, v154
    v_add_f32 v211, v211, v155
    v_exp_f32 v158, v158
    v_mfma_f32_32x32x16_bf16 v[128:143], a[88:91], a[24:27], v[128:143]
    v_lshrrev_b32 v225, 16, v225
    v_exp_f32 v159, v159
    v_cvt_pk_bf16_f32 v206, v156, v157
    v_add_f32 v210, v210, v156
    v_add_f32 v211, v211, v157
    v_mfma_f32_32x32x16_bf16 v[128:143], a[92:95], a[28:31], v[128:143]
    s_waitcnt vmcnt(16)
    s_barrier
    v_cvt_pk_bf16_f32 v207, v158, v159
    v_add_f32 v210, v210, v158
    v_add_f32 v211, v211, v159
    v_mfma_f32_32x32x16_bf16 v[64:79], a[96:99], v[200:203], v[64:79]
    ds_read_b64_tr_b16 a[96:97], v249 offset:0
    ds_read_b64_tr_b16 a[98:99], v249 offset:512
    v_mfma_f32_32x32x16_bf16 v[80:95], a[100:103], v[200:203], v[80:95]
    ds_read_b64_tr_b16 a[100:101], v249 offset:64
    ds_read_b64_tr_b16 a[102:103], v249 offset:576
    v_mul_u32_u24 v225, 1120, v225
    v_mfma_f32_32x32x16_bf16 v[96:111], a[104:107], v[200:203], v[96:111]
    ds_read_b64_tr_b16 a[104:105], v249 offset:128
    ds_read_b64_tr_b16 a[106:107], v249 offset:640
    v_exp_f32 v128, v128
    v_exp_f32 v129, v129
    v_mfma_f32_32x32x16_bf16 v[112:127], a[108:111], v[200:203], v[112:127]
    ds_read_b64_tr_b16 a[108:109], v249 offset:192
    ds_read_b64_tr_b16 a[110:111], v249 offset:704
    v_exp_f32 v130, v130
    v_exp_f32 v131, v131
    v_mfma_f32_32x32x16_bf16 v[64:79], a[112:115], v[204:207], v[64:79]
    ds_read_b64_tr_b16 a[112:113], v249 offset:8960
    ds_read_b64_tr_b16 a[114:115], v249 offset:9472
    v_lshl_add_u32 v225, v224, 4, v225
    v_cvt_pk_bf16_f32 v192, v128, v129
    v_add_f32 v208, v208, v128
    v_mfma_f32_32x32x16_bf16 v[80:95], a[116:119], v[204:207], v[80:95]
    ds_read_b64_tr_b16 a[116:117], v249 offset:9024
    ds_read_b64_tr_b16 a[118:119], v249 offset:9536
    v_add_f32 v209, v209, v129
    v_exp_f32 v132, v132
    v_mfma_f32_32x32x16_bf16 v[96:111], a[120:123], v[204:207], v[96:111]
    ds_read_b64_tr_b16 a[120:121], v249 offset:9088
    ds_read_b64_tr_b16 a[122:123], v249 offset:9600
    v_exp_f32 v133, v133
    v_cvt_pk_bf16_f32 v193, v130, v131
    v_add_f32 v208, v208, v130
    v_mfma_f32_32x32x16_bf16 v[112:127], a[124:127], v[204:207], v[112:127]
    ds_read_b64_tr_b16 a[124:125], v249 offset:9152
    ds_read_b64_tr_b16 a[126:127], v249 offset:9664
    buffer_load_dwordx4 a[160:163], v225, s[84:87], 0 offen
    v_add_f32 v209, v209, v131
    v_exp_f32 v134, v134
    v_mfma_f32_32x32x16_bf16 v[144:159], a[64:67], a[32:35], v[176:191]
    ds_read_b128 a[64:67], v247 offset:0
    v_exp_f32 v135, v135
    v_cvt_pk_bf16_f32 v194, v132, v133
    v_add_f32 v208, v208, v132
    v_add_f32 v209, v209, v133
    v_mfma_f32_32x32x16_bf16 v[144:159], a[68:71], a[36:39], v[144:159]
    ds_read_b128 a[68:71], v248 offset:0
    v_exp_f32 v136, v136
    v_exp_f32 v137, v137
    v_mfma_f32_32x32x16_bf16 v[144:159], a[72:75], a[40:43], v[144:159]
    ds_read_b128 a[72:75], v247 offset:64
    buffer_load_dwordx4 a[180:183], v225, s[88:91], 0 offen
    v_cvt_pk_bf16_f32 v195, v134, v135
    v_add_f32 v208, v208, v134
    v_add_f32 v209, v209, v135
    v_mfma_f32_32x32x16_bf16 v[144:159], a[76:79], a[44:47], v[144:159]
    ds_read_b128 a[76:79], v248 offset:64
    v_exp_f32 v138, v138
    v_exp_f32 v139, v139
    v_cvt_pk_bf16_f32 v196, v136, v137
    v_mfma_f32_32x32x16_bf16 v[144:159], a[80:83], a[48:51], v[144:159]
    ds_read_b128 a[80:83], v247 offset:128
    v_add_f32 v208, v208, v136
    v_add_f32 v209, v209, v137
    v_exp_f32 v140, v140
    v_exp_f32 v141, v141
    v_mfma_f32_32x32x16_bf16 v[144:159], a[84:87], a[52:55], v[144:159]
    ds_read_b128 a[84:87], v248 offset:128
    v_cvt_pk_bf16_f32 v197, v138, v139
    v_add_f32 v208, v208, v138
    v_add_f32 v209, v209, v139
    v_mfma_f32_32x32x16_bf16 v[144:159], a[88:91], a[56:59], v[144:159]
    ds_read_b128 a[88:91], v247 offset:192
    v_exp_f32 v142, v142
    v_exp_f32 v143, v143
    v_cvt_pk_bf16_f32 v198, v140, v141
    v_mfma_f32_32x32x16_bf16 v[144:159], a[92:95], a[60:63], v[144:159]
    ds_read_b128 a[92:95], v248 offset:192
    v_add_f32 v208, v208, v140
    v_add_f32 v209, v209, v141
    v_cvt_pk_bf16_f32 v199, v142, v143
    v_add_f32 v208, v208, v142
    v_add_f32 v209, v209, v143
    s_waitcnt lgkmcnt(8)
    v_mfma_f32_32x32x16_bf16 v[0:15], a[96:99], v[192:195], v[0:15]
    s_add_u32 m0, s29, s39
    v_mfma_f32_32x32x16_bf16 v[16:31], a[100:103], v[192:195], v[16:31]
    buffer_load_dwordx4 v232, s[44:47], s31 offen offset:0 lds
    v_mfma_f32_32x32x16_bf16 v[32:47], a[104:107], v[192:195], v[32:47]
    buffer_load_dwordx4 v233, s[44:47], s31 offen offset:1088 lds
    v_exp_f32 v144, v144
    v_exp_f32 v145, v145
    v_mfma_f32_32x32x16_bf16 v[48:63], a[108:111], v[192:195], v[48:63]
    buffer_load_dwordx4 v234, s[48:51], s31 offen offset:2176 lds
    v_exp_f32 v146, v146
    v_exp_f32 v147, v147
    v_cvt_pk_bf16_f32 v200, v144, v145
    v_mfma_f32_32x32x16_bf16 v[0:15], a[112:115], v[196:199], v[0:15]
    buffer_load_dwordx4 v235, s[48:51], s31 offen offset:3264 lds
    v_add_f32 v210, v210, v144
    v_add_f32 v211, v211, v145
    v_exp_f32 v148, v148
    v_mfma_f32_32x32x16_bf16 v[16:31], a[116:119], v[196:199], v[16:31]
    s_add_u32 s29, s29, 17920
    s_cmp_ge_u32 s29, 125440
    v_exp_f32 v149, v149
    v_cvt_pk_bf16_f32 v201, v146, v147
    v_add_f32 v210, v210, v146
    v_mfma_f32_32x32x16_bf16 v[32:47], a[120:123], v[196:199], v[32:47]
    s_cselect_b32 s37, 125440, 0
    s_sub_u32 s29, s29, s37
    v_add_f32 v211, v211, v147
    v_exp_f32 v150, v150
    v_mfma_f32_32x32x16_bf16 v[48:63], a[124:127], v[196:199], v[48:63]
    s_add_u32 s31, s31, s40
    v_exp_f32 v151, v151
    v_cvt_pk_bf16_f32 v202, v148, v149
    v_add_f32 v210, v210, v148
    v_add_f32 v211, v211, v149
    s_waitcnt lgkmcnt(0)
    v_mfma_f32_32x32x16_bf16 v[128:143], a[64:67], a[0:3], v[160:175]
    v_add_u32 v249, s42, v245
    v_add_u32 v226, 64, v252
    v_exp_f32 v152, v152
    v_exp_f32 v153, v153
    v_mfma_f32_32x32x16_bf16 v[128:143], a[68:71], a[4:7], v[128:143]
    s_add_u32 s42, s42, 17920
    s_cmp_ge_u32 s42, 125440
    v_cvt_pk_bf16_f32 v203, v150, v151
    v_add_f32 v210, v210, v150
    v_mfma_f32_32x32x16_bf16 v[128:143], a[72:75], a[8:11], v[128:143]
    s_cselect_b32 s38, 125440, 0
    s_sub_u32 s42, s42, s38
    v_add_f32 v211, v211, v151
    v_exp_f32 v154, v154
    v_mfma_f32_32x32x16_bf16 v[128:143], a[76:79], a[12:15], v[128:143]
    v_add_u32 v247, s42, v243
    v_mul_u32_u24 v227, 6554, v226
    v_exp_f32 v155, v155
    v_cvt_pk_bf16_f32 v204, v152, v153
    v_add_f32 v210, v210, v152
    v_mfma_f32_32x32x16_bf16 v[128:143], a[80:83], a[16:19], v[128:143]
    v_add_u32 v248, s42, v244
    v_add_f32 v211, v211, v153
    v_exp_f32 v156, v156
    v_exp_f32 v157, v157
    v_mfma_f32_32x32x16_bf16 v[128:143], a[84:87], a[20:23], v[128:143]
    v_cvt_pk_bf16_f32 v205, v154, v155
    v_add_f32 v210, v210, v154
    v_add_f32 v211, v211, v155
    v_exp_f32 v158, v158
    v_mfma_f32_32x32x16_bf16 v[128:143], a[88:91], a[24:27], v[128:143]
    v_lshrrev_b32 v227, 16, v227
    v_exp_f32 v159, v159
    v_cvt_pk_bf16_f32 v206, v156, v157
    v_add_f32 v210, v210, v156
    v_add_f32 v211, v211, v157
    v_mfma_f32_32x32x16_bf16 v[128:143], a[92:95], a[28:31], v[128:143]
    s_waitcnt vmcnt(18)
    s_barrier
    v_cvt_pk_bf16_f32 v207, v158, v159
    v_add_f32 v210, v210, v158
    v_add_f32 v211, v211, v159
    v_mfma_f32_32x32x16_bf16 v[64:79], a[96:99], v[200:203], v[64:79]
    ds_read_b64_tr_b16 a[96:97], v249 offset:0
    ds_read_b64_tr_b16 a[98:99], v249 offset:512
    v_mfma_f32_32x32x16_bf16 v[80:95], a[100:103], v[200:203], v[80:95]
    ds_read_b64_tr_b16 a[100:101], v249 offset:64
    ds_read_b64_tr_b16 a[102:103], v249 offset:576
    v_mul_u32_u24 v227, 1120, v227
    v_mfma_f32_32x32x16_bf16 v[96:111], a[104:107], v[200:203], v[96:111]
    ds_read_b64_tr_b16 a[104:105], v249 offset:128
    ds_read_b64_tr_b16 a[106:107], v249 offset:640
    v_exp_f32 v128, v128
    v_exp_f32 v129, v129
    v_mfma_f32_32x32x16_bf16 v[112:127], a[108:111], v[200:203], v[112:127]
    ds_read_b64_tr_b16 a[108:109], v249 offset:192
    ds_read_b64_tr_b16 a[110:111], v249 offset:704
    v_exp_f32 v130, v130
    v_exp_f32 v131, v131
    v_mfma_f32_32x32x16_bf16 v[64:79], a[112:115], v[204:207], v[64:79]
    ds_read_b64_tr_b16 a[112:113], v249 offset:8960
    ds_read_b64_tr_b16 a[114:115], v249 offset:9472
    v_lshl_add_u32 v227, v226, 4, v227
    v_cvt_pk_bf16_f32 v192, v128, v129
    v_add_f32 v208, v208, v128
    v_mfma_f32_32x32x16_bf16 v[80:95], a[116:119], v[204:207], v[80:95]
    ds_read_b64_tr_b16 a[116:117], v249 offset:9024
    ds_read_b64_tr_b16 a[118:119], v249 offset:9536
    v_add_f32 v209, v209, v129
    v_exp_f32 v132, v132
    v_mfma_f32_32x32x16_bf16 v[96:111], a[120:123], v[204:207], v[96:111]
    ds_read_b64_tr_b16 a[120:121], v249 offset:9088
    ds_read_b64_tr_b16 a[122:123], v249 offset:9600
    v_exp_f32 v133, v133
    v_cvt_pk_bf16_f32 v193, v130, v131
    v_add_f32 v208, v208, v130
    v_mfma_f32_32x32x16_bf16 v[112:127], a[124:127], v[204:207], v[112:127]
    ds_read_b64_tr_b16 a[124:125], v249 offset:9152
    ds_read_b64_tr_b16 a[126:127], v249 offset:9664
    buffer_load_dwordx4 a[164:167], v227, s[84:87], 0 offen
    v_add_f32 v209, v209, v131
    v_exp_f32 v134, v134
    v_mfma_f32_32x32x16_bf16 v[144:159], a[64:67], a[32:35], v[176:191]
    ds_read_b128 a[64:67], v247 offset:0
    v_exp_f32 v135, v135
    v_cvt_pk_bf16_f32 v194, v132, v133
    v_add_f32 v208, v208, v132
    v_add_f32 v209, v209, v133
    v_mfma_f32_32x32x16_bf16 v[144:159], a[68:71], a[36:39], v[144:159]
    ds_read_b128 a[68:71], v248 offset:0
    v_exp_f32 v136, v136
    v_exp_f32 v137, v137
    v_mfma_f32_32x32x16_bf16 v[144:159], a[72:75], a[40:43], v[144:159]
    ds_read_b128 a[72:75], v247 offset:64
    buffer_load_dwordx4 a[184:187], v227, s[88:91], 0 offen
    v_cvt_pk_bf16_f32 v195, v134, v135
    v_add_f32 v208, v208, v134
    v_add_f32 v209, v209, v135
    v_mfma_f32_32x32x16_bf16 v[144:159], a[76:79], a[44:47], v[144:159]
    ds_read_b128 a[76:79], v248 offset:64
    v_exp_f32 v138, v138
    v_exp_f32 v139, v139
    v_cvt_pk_bf16_f32 v196, v136, v137
    v_mfma_f32_32x32x16_bf16 v[144:159], a[80:83], a[48:51], v[144:159]
    ds_read_b128 a[80:83], v247 offset:128
    v_add_f32 v208, v208, v136
    v_add_f32 v209, v209, v137
    v_exp_f32 v140, v140
    v_exp_f32 v141, v141
    v_mfma_f32_32x32x16_bf16 v[144:159], a[84:87], a[52:55], v[144:159]
    ds_read_b128 a[84:87], v248 offset:128
    v_cvt_pk_bf16_f32 v197, v138, v139
    v_add_f32 v208, v208, v138
    v_add_f32 v209, v209, v139
    v_mfma_f32_32x32x16_bf16 v[144:159], a[88:91], a[56:59], v[144:159]
    ds_read_b128 a[88:91], v247 offset:192
    v_exp_f32 v142, v142
    v_exp_f32 v143, v143
    v_cvt_pk_bf16_f32 v198, v140, v141
    v_mfma_f32_32x32x16_bf16 v[144:159], a[92:95], a[60:63], v[144:159]
    ds_read_b128 a[92:95], v248 offset:192
    v_add_f32 v208, v208, v140
    v_add_f32 v209, v209, v141
    v_cvt_pk_bf16_f32 v199, v142, v143
    v_add_f32 v208, v208, v142
    v_add_f32 v209, v209, v143
    s_waitcnt lgkmcnt(8)
    v_mfma_f32_32x32x16_bf16 v[0:15], a[96:99], v[192:195], v[0:15]
    s_add_u32 m0, s29, s39
    v_mfma_f32_32x32x16_bf16 v[16:31], a[100:103], v[192:195], v[16:31]
    buffer_load_dwordx4 v232, s[44:47], s31 offen offset:0 lds
    v_mfma_f32_32x32x16_bf16 v[32:47], a[104:107], v[192:195], v[32:47]
    buffer_load_dwordx4 v233, s[44:47], s31 offen offset:1088 lds
    v_exp_f32 v144, v144
    v_exp_f32 v145, v145
    v_mfma_f32_32x32x16_bf16 v[48:63], a[108:111], v[192:195], v[48:63]
    buffer_load_dwordx4 v234, s[48:51], s31 offen offset:2176 lds
    v_exp_f32 v146, v146
    v_exp_f32 v147, v147
    v_cvt_pk_bf16_f32 v200, v144, v145
    v_mfma_f32_32x32x16_bf16 v[0:15], a[112:115], v[196:199], v[0:15]
    buffer_load_dwordx4 v235, s[48:51], s31 offen offset:3264 lds
    v_add_f32 v210, v210, v144
    v_add_f32 v211, v211, v145
    v_exp_f32 v148, v148
    v_mfma_f32_32x32x16_bf16 v[16:31], a[116:119], v[196:199], v[16:31]
    s_add_u32 s29, s29, 17920
    s_cmp_ge_u32 s29, 125440
    v_exp_f32 v149, v149
    v_cvt_pk_bf16_f32 v201, v146, v147
    v_add_f32 v210, v210, v146
    v_mfma_f32_32x32x16_bf16 v[32:47], a[120:123], v[196:199], v[32:47]
    s_cselect_b32 s37, 125440, 0
    s_sub_u32 s29, s29, s37
    v_add_f32 v211, v211, v147
    v_exp_f32 v150, v150
    v_mfma_f32_32x32x16_bf16 v[48:63], a[124:127], v[196:199], v[48:63]
    s_add_u32 s31, s31, s40
    v_exp_f32 v151, v151
    v_cvt_pk_bf16_f32 v202, v148, v149
    v_add_f32 v210, v210, v148
    v_add_f32 v211, v211, v149
    s_waitcnt lgkmcnt(0)
    v_mfma_f32_32x32x16_bf16 v[128:143], a[64:67], a[0:3], v[160:175]
    v_add_u32 v249, s42, v245
    v_add_u32 v224, 128, v252
    v_exp_f32 v152, v152
    v_exp_f32 v153, v153
    v_mfma_f32_32x32x16_bf16 v[128:143], a[68:71], a[4:7], v[128:143]
    s_add_u32 s42, s42, 17920
    s_cmp_ge_u32 s42, 125440
    v_cvt_pk_bf16_f32 v203, v150, v151
    v_add_f32 v210, v210, v150
    v_mfma_f32_32x32x16_bf16 v[128:143], a[72:75], a[8:11], v[128:143]
    s_cselect_b32 s38, 125440, 0
    s_sub_u32 s42, s42, s38
    v_add_f32 v211, v211, v151
    v_exp_f32 v154, v154
    v_mfma_f32_32x32x16_bf16 v[128:143], a[76:79], a[12:15], v[128:143]
    v_add_u32 v247, s42, v243
    v_mul_u32_u24 v225, 6554, v224
    v_exp_f32 v155, v155
    v_cvt_pk_bf16_f32 v204, v152, v153
    v_add_f32 v210, v210, v152
    v_mfma_f32_32x32x16_bf16 v[128:143], a[80:83], a[16:19], v[128:143]
    v_add_u32 v248, s42, v244
    v_add_f32 v211, v211, v153
    v_exp_f32 v156, v156
    v_exp_f32 v157, v157
    v_mfma_f32_32x32x16_bf16 v[128:143], a[84:87], a[20:23], v[128:143]
    v_cvt_pk_bf16_f32 v205, v154, v155
    v_add_f32 v210, v210, v154
    v_add_f32 v211, v211, v155
    v_exp_f32 v158, v158
    v_mfma_f32_32x32x16_bf16 v[128:143], a[88:91], a[24:27], v[128:143]
    v_lshrrev_b32 v225, 16, v225
    v_exp_f32 v159, v159
    v_cvt_pk_bf16_f32 v206, v156, v157
    v_add_f32 v210, v210, v156
    v_add_f32 v211, v211, v157
    v_mfma_f32_32x32x16_bf16 v[128:143], a[92:95], a[28:31], v[128:143]
    s_waitcnt vmcnt(20)
    s_barrier
    v_cvt_pk_bf16_f32 v207, v158, v159
    v_add_f32 v210, v210, v158
    v_add_f32 v211, v211, v159
    v_mfma_f32_32x32x16_bf16 v[64:79], a[96:99], v[200:203], v[64:79]
    ds_read_b64_tr_b16 a[96:97], v249 offset:0
    ds_read_b64_tr_b16 a[98:99], v249 offset:512
    v_mfma_f32_32x32x16_bf16 v[80:95], a[100:103], v[200:203], v[80:95]
    ds_read_b64_tr_b16 a[100:101], v249 offset:64
    ds_read_b64_tr_b16 a[102:103], v249 offset:576
    v_mul_u32_u24 v225, 1120, v225
    v_mfma_f32_32x32x16_bf16 v[96:111], a[104:107], v[200:203], v[96:111]
    ds_read_b64_tr_b16 a[104:105], v249 offset:128
    ds_read_b64_tr_b16 a[106:107], v249 offset:640
    v_exp_f32 v128, v128
    v_exp_f32 v129, v129
    v_mfma_f32_32x32x16_bf16 v[112:127], a[108:111], v[200:203], v[112:127]
    ds_read_b64_tr_b16 a[108:109], v249 offset:192
    ds_read_b64_tr_b16 a[110:111], v249 offset:704
    v_exp_f32 v130, v130
    v_exp_f32 v131, v131
    v_mfma_f32_32x32x16_bf16 v[64:79], a[112:115], v[204:207], v[64:79]
    ds_read_b64_tr_b16 a[112:113], v249 offset:8960
    ds_read_b64_tr_b16 a[114:115], v249 offset:9472
    v_lshl_add_u32 v225, v224, 4, v225
    v_cvt_pk_bf16_f32 v192, v128, v129
    v_add_f32 v208, v208, v128
    v_mfma_f32_32x32x16_bf16 v[80:95], a[116:119], v[204:207], v[80:95]
    ds_read_b64_tr_b16 a[116:117], v249 offset:9024
    ds_read_b64_tr_b16 a[118:119], v249 offset:9536
    v_add_f32 v209, v209, v129
    v_exp_f32 v132, v132
    v_mfma_f32_32x32x16_bf16 v[96:111], a[120:123], v[204:207], v[96:111]
    ds_read_b64_tr_b16 a[120:121], v249 offset:9088
    ds_read_b64_tr_b16 a[122:123], v249 offset:9600
    v_exp_f32 v133, v133
    v_cvt_pk_bf16_f32 v193, v130, v131
    v_add_f32 v208, v208, v130
    v_mfma_f32_32x32x16_bf16 v[112:127], a[124:127], v[204:207], v[112:127]
    ds_read_b64_tr_b16 a[124:125], v249 offset:9152
    ds_read_b64_tr_b16 a[126:127], v249 offset:9664
    buffer_load_dwordx4 a[168:171], v225, s[84:87], 0 offen
    v_add_f32 v209, v209, v131
    v_exp_f32 v134, v134
    v_mfma_f32_32x32x16_bf16 v[144:159], a[64:67], a[32:35], v[176:191]
    ds_read_b128 a[64:67], v247 offset:0
    v_exp_f32 v135, v135
    v_cvt_pk_bf16_f32 v194, v132, v133
    v_add_f32 v208, v208, v132
    v_add_f32 v209, v209, v133
    v_mfma_f32_32x32x16_bf16 v[144:159], a[68:71], a[36:39], v[144:159]
    ds_read_b128 a[68:71], v248 offset:0
    v_exp_f32 v136, v136
    v_exp_f32 v137, v137
    v_mfma_f32_32x32x16_bf16 v[144:159], a[72:75], a[40:43], v[144:159]
    ds_read_b128 a[72:75], v247 offset:64
    buffer_load_dwordx4 a[188:191], v225, s[88:91], 0 offen
    v_cvt_pk_bf16_f32 v195, v134, v135
    v_add_f32 v208, v208, v134
    v_add_f32 v209, v209, v135
    v_mfma_f32_32x32x16_bf16 v[144:159], a[76:79], a[44:47], v[144:159]
    ds_read_b128 a[76:79], v248 offset:64
    v_exp_f32 v138, v138
    v_exp_f32 v139, v139
    v_cvt_pk_bf16_f32 v196, v136, v137
    v_mfma_f32_32x32x16_bf16 v[144:159], a[80:83], a[48:51], v[144:159]
    ds_read_b128 a[80:83], v247 offset:128
    v_add_f32 v208, v208, v136
    v_add_f32 v209, v209, v137
    v_exp_f32 v140, v140
    v_exp_f32 v141, v141
    v_mfma_f32_32x32x16_bf16 v[144:159], a[84:87], a[52:55], v[144:159]
    ds_read_b128 a[84:87], v248 offset:128
    v_cvt_pk_bf16_f32 v197, v138, v139
    v_add_f32 v208, v208, v138
    v_add_f32 v209, v209, v139
    v_mfma_f32_32x32x16_bf16 v[144:159], a[88:91], a[56:59], v[144:159]
    ds_read_b128 a[88:91], v247 offset:192
    v_exp_f32 v142, v142
    v_exp_f32 v143, v143
    v_cvt_pk_bf16_f32 v198, v140, v141
    v_mfma_f32_32x32x16_bf16 v[144:159], a[92:95], a[60:63], v[144:159]
    ds_read_b128 a[92:95], v248 offset:192
    v_add_f32 v208, v208, v140
    v_add_f32 v209, v209, v141
    v_cvt_pk_bf16_f32 v199, v142, v143
    v_add_f32 v208, v208, v142
    v_add_f32 v209, v209, v143
    s_waitcnt lgkmcnt(8)
    v_mfma_f32_32x32x16_bf16 v[0:15], a[96:99], v[192:195], v[0:15]
    s_add_u32 m0, s29, s39
    v_mfma_f32_32x32x16_bf16 v[16:31], a[100:103], v[192:195], v[16:31]
    buffer_load_dwordx4 v232, s[44:47], s31 offen offset:0 lds
    v_mfma_f32_32x32x16_bf16 v[32:47], a[104:107], v[192:195], v[32:47]
    buffer_load_dwordx4 v233, s[44:47], s31 offen offset:1088 lds
    v_exp_f32 v144, v144
    v_exp_f32 v145, v145
    v_mfma_f32_32x32x16_bf16 v[48:63], a[108:111], v[192:195], v[48:63]
    buffer_load_dwordx4 v234, s[48:51], s31 offen offset:2176 lds
    v_exp_f32 v146, v146
    v_exp_f32 v147, v147
    v_cvt_pk_bf16_f32 v200, v144, v145
    v_mfma_f32_32x32x16_bf16 v[0:15], a[112:115], v[196:199], v[0:15]
    buffer_load_dwordx4 v235, s[48:51], s31 offen offset:3264 lds
    v_add_f32 v210, v210, v144
    v_add_f32 v211, v211, v145
    v_exp_f32 v148, v148
    v_mfma_f32_32x32x16_bf16 v[16:31], a[116:119], v[196:199], v[16:31]
    s_add_u32 s29, s29, 17920
    s_cmp_ge_u32 s29, 125440
    v_exp_f32 v149, v149
    v_cvt_pk_bf16_f32 v201, v146, v147
    v_add_f32 v210, v210, v146
    v_mfma_f32_32x32x16_bf16 v[32:47], a[120:123], v[196:199], v[32:47]
    s_cselect_b32 s37, 125440, 0
    s_sub_u32 s29, s29, s37
    v_add_f32 v211, v211, v147
    v_exp_f32 v150, v150
    v_mfma_f32_32x32x16_bf16 v[48:63], a[124:127], v[196:199], v[48:63]
    s_add_u32 s31, s31, s40
    v_exp_f32 v151, v151
    v_cvt_pk_bf16_f32 v202, v148, v149
    v_add_f32 v210, v210, v148
    v_add_f32 v211, v211, v149
    s_waitcnt lgkmcnt(0)
    v_mfma_f32_32x32x16_bf16 v[128:143], a[64:67], a[0:3], v[160:175]
    v_add_u32 v249, s42, v245
    v_add_u32 v226, 192, v252
    v_exp_f32 v152, v152
    v_exp_f32 v153, v153
    v_mfma_f32_32x32x16_bf16 v[128:143], a[68:71], a[4:7], v[128:143]
    s_add_u32 s42, s42, 17920
    s_cmp_ge_u32 s42, 125440
    v_cvt_pk_bf16_f32 v203, v150, v151
    v_add_f32 v210, v210, v150
    v_mfma_f32_32x32x16_bf16 v[128:143], a[72:75], a[8:11], v[128:143]
    s_cselect_b32 s38, 125440, 0
    s_sub_u32 s42, s42, s38
    v_add_f32 v211, v211, v151
    v_exp_f32 v154, v154
    v_mfma_f32_32x32x16_bf16 v[128:143], a[76:79], a[12:15], v[128:143]
    v_add_u32 v247, s42, v243
    v_mul_u32_u24 v227, 6554, v226
    v_exp_f32 v155, v155
    v_cvt_pk_bf16_f32 v204, v152, v153
    v_add_f32 v210, v210, v152
    v_mfma_f32_32x32x16_bf16 v[128:143], a[80:83], a[16:19], v[128:143]
    v_add_u32 v248, s42, v244
    v_add_f32 v211, v211, v153
    v_exp_f32 v156, v156
    v_exp_f32 v157, v157
    v_mfma_f32_32x32x16_bf16 v[128:143], a[84:87], a[20:23], v[128:143]
    v_cvt_pk_bf16_f32 v205, v154, v155
    v_add_f32 v210, v210, v154
    v_add_f32 v211, v211, v155
    v_exp_f32 v158, v158
    v_mfma_f32_32x32x16_bf16 v[128:143], a[88:91], a[24:27], v[128:143]
    v_lshrrev_b32 v227, 16, v227
    v_exp_f32 v159, v159
    v_cvt_pk_bf16_f32 v206, v156, v157
    v_add_f32 v210, v210, v156
    v_add_f32 v211, v211, v157
    v_mfma_f32_32x32x16_bf16 v[128:143], a[92:95], a[28:31], v[128:143]
    s_waitcnt vmcnt(22)
    s_barrier
    v_cvt_pk_bf16_f32 v207, v158, v159
    v_add_f32 v210, v210, v158
    v_add_f32 v211, v211, v159
    v_mfma_f32_32x32x16_bf16 v[64:79], a[96:99], v[200:203], v[64:79]
    ds_read_b64_tr_b16 a[96:97], v249 offset:0
    ds_read_b64_tr_b16 a[98:99], v249 offset:512
    v_mfma_f32_32x32x16_bf16 v[80:95], a[100:103], v[200:203], v[80:95]
    ds_read_b64_tr_b16 a[100:101], v249 offset:64
    ds_read_b64_tr_b16 a[102:103], v249 offset:576
    v_mul_u32_u24 v227, 1120, v227
    v_mfma_f32_32x32x16_bf16 v[96:111], a[104:107], v[200:203], v[96:111]
    ds_read_b64_tr_b16 a[104:105], v249 offset:128
    ds_read_b64_tr_b16 a[106:107], v249 offset:640
    v_exp_f32 v128, v128
    v_exp_f32 v129, v129
    v_mfma_f32_32x32x16_bf16 v[112:127], a[108:111], v[200:203], v[112:127]
    ds_read_b64_tr_b16 a[108:109], v249 offset:192
    ds_read_b64_tr_b16 a[110:111], v249 offset:704
    v_exp_f32 v130, v130
    v_exp_f32 v131, v131
    v_mfma_f32_32x32x16_bf16 v[64:79], a[112:115], v[204:207], v[64:79]
    ds_read_b64_tr_b16 a[112:113], v249 offset:8960
    ds_read_b64_tr_b16 a[114:115], v249 offset:9472
    v_lshl_add_u32 v227, v226, 4, v227
    v_cvt_pk_bf16_f32 v192, v128, v129
    v_add_f32 v208, v208, v128
    v_mfma_f32_32x32x16_bf16 v[80:95], a[116:119], v[204:207], v[80:95]
    ds_read_b64_tr_b16 a[116:117], v249 offset:9024
    ds_read_b64_tr_b16 a[118:119], v249 offset:9536
    v_add_f32 v209, v209, v129
    v_exp_f32 v132, v132
    v_mfma_f32_32x32x16_bf16 v[96:111], a[120:123], v[204:207], v[96:111]
    ds_read_b64_tr_b16 a[120:121], v249 offset:9088
    ds_read_b64_tr_b16 a[122:123], v249 offset:9600
    v_exp_f32 v133, v133
    v_cvt_pk_bf16_f32 v193, v130, v131
    v_add_f32 v208, v208, v130
    v_mfma_f32_32x32x16_bf16 v[112:127], a[124:127], v[204:207], v[112:127]
    ds_read_b64_tr_b16 a[124:125], v249 offset:9152
    ds_read_b64_tr_b16 a[126:127], v249 offset:9664
    buffer_load_dwordx4 a[172:175], v227, s[84:87], 0 offen
    v_add_f32 v209, v209, v131
    v_exp_f32 v134, v134
    v_mfma_f32_32x32x16_bf16 v[144:159], a[64:67], a[32:35], v[176:191]
    ds_read_b128 a[64:67], v247 offset:0
    v_exp_f32 v135, v135
    v_cvt_pk_bf16_f32 v194, v132, v133
    v_add_f32 v208, v208, v132
    v_add_f32 v209, v209, v133
    v_mfma_f32_32x32x16_bf16 v[144:159], a[68:71], a[36:39], v[144:159]
    ds_read_b128 a[68:71], v248 offset:0
    v_exp_f32 v136, v136
    v_exp_f32 v137, v137
    v_mfma_f32_32x32x16_bf16 v[144:159], a[72:75], a[40:43], v[144:159]
    ds_read_b128 a[72:75], v247 offset:64
    buffer_load_dwordx4 a[192:195], v227, s[88:91], 0 offen
    v_cvt_pk_bf16_f32 v195, v134, v135
    v_add_f32 v208, v208, v134
    v_add_f32 v209, v209, v135
    v_mfma_f32_32x32x16_bf16 v[144:159], a[76:79], a[44:47], v[144:159]
    ds_read_b128 a[76:79], v248 offset:64
    v_exp_f32 v138, v138
    v_exp_f32 v139, v139
    v_cvt_pk_bf16_f32 v196, v136, v137
    v_mfma_f32_32x32x16_bf16 v[144:159], a[80:83], a[48:51], v[144:159]
    ds_read_b128 a[80:83], v247 offset:128
    v_add_f32 v208, v208, v136
    v_add_f32 v209, v209, v137
    v_exp_f32 v140, v140
    v_exp_f32 v141, v141
    v_mfma_f32_32x32x16_bf16 v[144:159], a[84:87], a[52:55], v[144:159]
    ds_read_b128 a[84:87], v248 offset:128
    v_cvt_pk_bf16_f32 v197, v138, v139
    v_add_f32 v208, v208, v138
    v_add_f32 v209, v209, v139
    v_mfma_f32_32x32x16_bf16 v[144:159], a[88:91], a[56:59], v[144:159]
    ds_read_b128 a[88:91], v247 offset:192
    v_exp_f32 v142, v142
    v_exp_f32 v143, v143
    v_cvt_pk_bf16_f32 v198, v140, v141
    v_mfma_f32_32x32x16_bf16 v[144:159], a[92:95], a[60:63], v[144:159]
    ds_read_b128 a[92:95], v248 offset:192
    v_add_f32 v208, v208, v140
    v_add_f32 v209, v209, v141
    v_cvt_pk_bf16_f32 v199, v142, v143
    v_add_f32 v208, v208, v142
    v_add_f32 v209, v209, v143
    s_waitcnt lgkmcnt(8)
    v_mfma_f32_32x32x16_bf16 v[0:15], a[96:99], v[192:195], v[0:15]
    s_add_u32 m0, s29, s39
    v_mfma_f32_32x32x16_bf16 v[16:31], a[100:103], v[192:195], v[16:31]
    buffer_load_dwordx4 v232, s[44:47], s31 offen offset:0 lds
    v_mfma_f32_32x32x16_bf16 v[32:47], a[104:107], v[192:195], v[32:47]
    buffer_load_dwordx4 v233, s[44:47], s31 offen offset:1088 lds
    v_exp_f32 v144, v144
    v_exp_f32 v145, v145
    v_mfma_f32_32x32x16_bf16 v[48:63], a[108:111], v[192:195], v[48:63]
    buffer_load_dwordx4 v234, s[48:51], s31 offen offset:2176 lds
    v_exp_f32 v146, v146
    v_exp_f32 v147, v147
    v_cvt_pk_bf16_f32 v200, v144, v145
    v_mfma_f32_32x32x16_bf16 v[0:15], a[112:115], v[196:199], v[0:15]
    buffer_load_dwordx4 v235, s[48:51], s31 offen offset:3264 lds
    v_add_f32 v210, v210, v144
    v_add_f32 v211, v211, v145
    v_exp_f32 v148, v148
    v_mfma_f32_32x32x16_bf16 v[16:31], a[116:119], v[196:199], v[16:31]
    s_add_u32 s29, s29, 17920
    s_cmp_ge_u32 s29, 125440
    v_exp_f32 v149, v149
    v_cvt_pk_bf16_f32 v201, v146, v147
    v_add_f32 v210, v210, v146
    v_mfma_f32_32x32x16_bf16 v[32:47], a[120:123], v[196:199], v[32:47]
    s_cselect_b32 s37, 125440, 0
    s_sub_u32 s29, s29, s37
    v_add_f32 v211, v211, v147
    v_exp_f32 v150, v150
    v_mfma_f32_32x32x16_bf16 v[48:63], a[124:127], v[196:199], v[48:63]
    s_add_u32 s31, s31, s40
    v_exp_f32 v151, v151
    v_cvt_pk_bf16_f32 v202, v148, v149
    v_add_f32 v210, v210, v148
    v_add_f32 v211, v211, v149
    s_waitcnt lgkmcnt(0)
    v_mfma_f32_32x32x16_bf16 v[128:143], a[64:67], a[0:3], v[160:175]
    v_add_u32 v249, s42, v245
    v_add_u32 v224, 256, v252
    v_exp_f32 v152, v152
    v_exp_f32 v153, v153
    v_mfma_f32_32x32x16_bf16 v[128:143], a[68:71], a[4:7], v[128:143]
    s_add_u32 s42, s42, 17920
    s_cmp_ge_u32 s42, 125440
    v_cvt_pk_bf16_f32 v203, v150, v151
    v_add_f32 v210, v210, v150
    v_mfma_f32_32x32x16_bf16 v[128:143], a[72:75], a[8:11], v[128:143]
    s_cselect_b32 s38, 125440, 0
    s_sub_u32 s42, s42, s38
    v_add_f32 v211, v211, v151
    v_exp_f32 v154, v154
    v_mfma_f32_32x32x16_bf16 v[128:143], a[76:79], a[12:15], v[128:143]
    v_add_u32 v247, s42, v243
    v_mul_u32_u24 v225, 6554, v224
    v_exp_f32 v155, v155
    v_cvt_pk_bf16_f32 v204, v152, v153
    v_add_f32 v210, v210, v152
    v_mfma_f32_32x32x16_bf16 v[128:143], a[80:83], a[16:19], v[128:143]
    v_add_u32 v248, s42, v244
    v_add_f32 v211, v211, v153
    v_exp_f32 v156, v156
    v_exp_f32 v157, v157
    v_mfma_f32_32x32x16_bf16 v[128:143], a[84:87], a[20:23], v[128:143]
    v_cvt_pk_bf16_f32 v205, v154, v155
    v_add_f32 v210, v210, v154
    v_add_f32 v211, v211, v155
    v_exp_f32 v158, v158
    v_mfma_f32_32x32x16_bf16 v[128:143], a[88:91], a[24:27], v[128:143]
    v_lshrrev_b32 v225, 16, v225
    v_exp_f32 v159, v159
    v_cvt_pk_bf16_f32 v206, v156, v157
    v_add_f32 v210, v210, v156
    v_add_f32 v211, v211, v157
    v_mfma_f32_32x32x16_bf16 v[128:143], a[92:95], a[28:31], v[128:143]
    s_waitcnt vmcnt(24)
    s_barrier
    v_cvt_pk_bf16_f32 v207, v158, v159
    v_add_f32 v210, v210, v158
    v_add_f32 v211, v211, v159
    v_mfma_f32_32x32x16_bf16 v[64:79], a[96:99], v[200:203], v[64:79]
    ds_read_b64_tr_b16 a[96:97], v249 offset:0
    ds_read_b64_tr_b16 a[98:99], v249 offset:512
    v_mfma_f32_32x32x16_bf16 v[80:95], a[100:103], v[200:203], v[80:95]
    ds_read_b64_tr_b16 a[100:101], v249 offset:64
    ds_read_b64_tr_b16 a[102:103], v249 offset:576
    v_mul_u32_u24 v225, 1120, v225
    v_mfma_f32_32x32x16_bf16 v[96:111], a[104:107], v[200:203], v[96:111]
    ds_read_b64_tr_b16 a[104:105], v249 offset:128
    ds_read_b64_tr_b16 a[106:107], v249 offset:640
    v_exp_f32 v128, v128
    v_exp_f32 v129, v129
    v_mfma_f32_32x32x16_bf16 v[112:127], a[108:111], v[200:203], v[112:127]
    ds_read_b64_tr_b16 a[108:109], v249 offset:192
    ds_read_b64_tr_b16 a[110:111], v249 offset:704
    v_exp_f32 v130, v130
    v_exp_f32 v131, v131
    v_mfma_f32_32x32x16_bf16 v[64:79], a[112:115], v[204:207], v[64:79]
    ds_read_b64_tr_b16 a[112:113], v249 offset:8960
    ds_read_b64_tr_b16 a[114:115], v249 offset:9472
    v_lshl_add_u32 v225, v224, 4, v225
    v_cvt_pk_bf16_f32 v192, v128, v129
    v_add_f32 v208, v208, v128
    v_mfma_f32_32x32x16_bf16 v[80:95], a[116:119], v[204:207], v[80:95]
    ds_read_b64_tr_b16 a[116:117], v249 offset:9024
    ds_read_b64_tr_b16 a[118:119], v249 offset:9536
    v_add_f32 v209, v209, v129
    v_exp_f32 v132, v132
    v_mfma_f32_32x32x16_bf16 v[96:111], a[120:123], v[204:207], v[96:111]
    ds_read_b64_tr_b16 a[120:121], v249 offset:9088
    ds_read_b64_tr_b16 a[122:123], v249 offset:9600
    v_exp_f32 v133, v133
    v_cvt_pk_bf16_f32 v193, v130, v131
    v_add_f32 v208, v208, v130
    v_mfma_f32_32x32x16_bf16 v[112:127], a[124:127], v[204:207], v[112:127]
    ds_read_b64_tr_b16 a[124:125], v249 offset:9152
    ds_read_b64_tr_b16 a[126:127], v249 offset:9664
    buffer_load_dwordx4 a[176:179], v225, s[84:87], 0 offen
    v_add_f32 v209, v209, v131
    v_exp_f32 v134, v134
    v_mfma_f32_32x32x16_bf16 v[144:159], a[64:67], a[32:35], v[176:191]
    ds_read_b128 a[64:67], v247 offset:0
    v_exp_f32 v135, v135
    v_cvt_pk_bf16_f32 v194, v132, v133
    v_add_f32 v208, v208, v132
    v_add_f32 v209, v209, v133
    v_mfma_f32_32x32x16_bf16 v[144:159], a[68:71], a[36:39], v[144:159]
    ds_read_b128 a[68:71], v248 offset:0
    v_exp_f32 v136, v136
    v_exp_f32 v137, v137
    v_mfma_f32_32x32x16_bf16 v[144:159], a[72:75], a[40:43], v[144:159]
    ds_read_b128 a[72:75], v247 offset:64
    buffer_load_dwordx4 a[196:199], v225, s[88:91], 0 offen
    v_cvt_pk_bf16_f32 v195, v134, v135
    v_add_f32 v208, v208, v134
    v_add_f32 v209, v209, v135
    v_mfma_f32_32x32x16_bf16 v[144:159], a[76:79], a[44:47], v[144:159]
    ds_read_b128 a[76:79], v248 offset:64
    v_exp_f32 v138, v138
    v_exp_f32 v139, v139
    v_cvt_pk_bf16_f32 v196, v136, v137
    v_mfma_f32_32x32x16_bf16 v[144:159], a[80:83], a[48:51], v[144:159]
    ds_read_b128 a[80:83], v247 offset:128
    v_add_f32 v208, v208, v136
    v_add_f32 v209, v209, v137
    v_exp_f32 v140, v140
    v_exp_f32 v141, v141
    v_mfma_f32_32x32x16_bf16 v[144:159], a[84:87], a[52:55], v[144:159]
    ds_read_b128 a[84:87], v248 offset:128
    v_cvt_pk_bf16_f32 v197, v138, v139
    v_add_f32 v208, v208, v138
    v_add_f32 v209, v209, v139
    v_mfma_f32_32x32x16_bf16 v[144:159], a[88:91], a[56:59], v[144:159]
    ds_read_b128 a[88:91], v247 offset:192
    v_exp_f32 v142, v142
    v_exp_f32 v143, v143
    v_cvt_pk_bf16_f32 v198, v140, v141
    v_mfma_f32_32x32x16_bf16 v[144:159], a[92:95], a[60:63], v[144:159]
    ds_read_b128 a[92:95], v248 offset:192
    v_add_f32 v208, v208, v140
    v_add_f32 v209, v209, v141
    v_cvt_pk_bf16_f32 v199, v142, v143
    v_add_f32 v208, v208, v142
    v_add_f32 v209, v209, v143
    s_waitcnt lgkmcnt(8)
    v_mfma_f32_32x32x16_bf16 v[0:15], a[96:99], v[192:195], v[0:15]
    v_mfma_f32_32x32x16_bf16 v[16:31], a[100:103], v[192:195], v[16:31]
    v_mfma_f32_32x32x16_bf16 v[32:47], a[104:107], v[192:195], v[32:47]
    s_nop 1
    v_exp_f32 v144, v144
    v_exp_f32 v145, v145
    v_mfma_f32_32x32x16_bf16 v[48:63], a[108:111], v[192:195], v[48:63]
    v_exp_f32 v146, v146
    v_exp_f32 v147, v147
    v_cvt_pk_bf16_f32 v200, v144, v145
    v_mfma_f32_32x32x16_bf16 v[0:15], a[112:115], v[196:199], v[0:15]
    v_add_f32 v210, v210, v144
    v_add_f32 v211, v211, v145
    v_exp_f32 v148, v148
    v_exp_f32 v149, v149
    v_mfma_f32_32x32x16_bf16 v[16:31], a[116:119], v[196:199], v[16:31]
    v_cvt_pk_bf16_f32 v201, v146, v147
    v_add_f32 v210, v210, v146
    v_add_f32 v211, v211, v147
    v_mfma_f32_32x32x16_bf16 v[32:47], a[120:123], v[196:199], v[32:47]
    v_exp_f32 v150, v150
    v_exp_f32 v151, v151
    v_cvt_pk_bf16_f32 v202, v148, v149
    v_add_f32 v210, v210, v148
    v_mfma_f32_32x32x16_bf16 v[48:63], a[124:127], v[196:199], v[48:63]
    v_add_f32 v211, v211, v149
    v_exp_f32 v152, v152
    v_exp_f32 v153, v153
    s_waitcnt lgkmcnt(0)
    v_mfma_f32_32x32x16_bf16 v[128:143], a[64:67], a[0:3], v[160:175]
    v_add_u32 v249, s42, v245
    s_waitcnt vmcnt(25)
    buffer_store_dwordx4 a[160:163], v255, s[92:95], 0 offen offset:0 sc1
    v_cvt_pk_bf16_f32 v203, v150, v151
    v_add_f32 v210, v210, v150
    v_mfma_f32_32x32x16_bf16 v[128:143], a[68:71], a[4:7], v[128:143]
    s_add_u32 s42, s42, 17920
    s_cmp_ge_u32 s42, 125440
    v_add_f32 v211, v211, v151
    v_exp_f32 v154, v154
    v_mfma_f32_32x32x16_bf16 v[128:143], a[72:75], a[8:11], v[128:143]
    s_cselect_b32 s38, 125440, 0
    s_sub_u32 s42, s42, s38
    v_exp_f32 v155, v155
    v_mfma_f32_32x32x16_bf16 v[128:143], a[76:79], a[12:15], v[128:143]
    v_add_u32 v247, s42, v243
    v_cvt_pk_bf16_f32 v204, v152, v153
    v_add_f32 v210, v210, v152
    v_add_f32 v211, v211, v153
    v_exp_f32 v156, v156
    v_mfma_f32_32x32x16_bf16 v[128:143], a[80:83], a[16:19], v[128:143]
    v_add_u32 v248, s42, v244
    v_exp_f32 v157, v157
    v_cvt_pk_bf16_f32 v205, v154, v155
    v_mfma_f32_32x32x16_bf16 v[128:143], a[84:87], a[20:23], v[128:143]
    v_add_f32 v210, v210, v154
    v_add_f32 v211, v211, v155
    v_exp_f32 v158, v158
    v_mfma_f32_32x32x16_bf16 v[128:143], a[88:91], a[24:27], v[128:143]
    v_exp_f32 v159, v159
    v_cvt_pk_bf16_f32 v206, v156, v157
    v_add_f32 v210, v210, v156
    v_add_f32 v211, v211, v157
    v_mfma_f32_32x32x16_bf16 v[128:143], a[92:95], a[28:31], v[128:143]
    s_waitcnt vmcnt(21)
    s_barrier
    v_cvt_pk_bf16_f32 v207, v158, v159
    v_add_f32 v210, v210, v158
    v_add_f32 v211, v211, v159
    v_mfma_f32_32x32x16_bf16 v[64:79], a[96:99], v[200:203], v[64:79]
    ds_read_b64_tr_b16 a[96:97], v249 offset:0
    ds_read_b64_tr_b16 a[98:99], v249 offset:512
    v_mfma_f32_32x32x16_bf16 v[80:95], a[100:103], v[200:203], v[80:95]
    ds_read_b64_tr_b16 a[100:101], v249 offset:64
    ds_read_b64_tr_b16 a[102:103], v249 offset:576
    v_mfma_f32_32x32x16_bf16 v[96:111], a[104:107], v[200:203], v[96:111]
    ds_read_b64_tr_b16 a[104:105], v249 offset:128
    ds_read_b64_tr_b16 a[106:107], v249 offset:640
    v_exp_f32 v128, v128
    v_exp_f32 v129, v129
    v_mfma_f32_32x32x16_bf16 v[112:127], a[108:111], v[200:203], v[112:127]
    ds_read_b64_tr_b16 a[108:109], v249 offset:192
    ds_read_b64_tr_b16 a[110:111], v249 offset:704
    buffer_store_dwordx4 a[180:183], v255, s[96:99], 0 offen offset:0 sc1
    v_exp_f32 v130, v130
    v_mfma_f32_32x32x16_bf16 v[64:79], a[112:115], v[204:207], v[64:79]
    ds_read_b64_tr_b16 a[112:113], v249 offset:8960
    ds_read_b64_tr_b16 a[114:115], v249 offset:9472
    v_exp_f32 v131, v131
    v_cvt_pk_bf16_f32 v192, v128, v129
    v_add_f32 v208, v208, v128
    v_mfma_f32_32x32x16_bf16 v[80:95], a[116:119], v[204:207], v[80:95]
    ds_read_b64_tr_b16 a[116:117], v249 offset:9024
    ds_read_b64_tr_b16 a[118:119], v249 offset:9536
    v_add_f32 v209, v209, v129
    v_exp_f32 v132, v132
    v_mfma_f32_32x32x16_bf16 v[96:111], a[120:123], v[204:207], v[96:111]
    ds_read_b64_tr_b16 a[120:121], v249 offset:9088
    ds_read_b64_tr_b16 a[122:123], v249 offset:9600
    v_exp_f32 v133, v133
    v_cvt_pk_bf16_f32 v193, v130, v131
    v_add_f32 v208, v208, v130
    v_mfma_f32_32x32x16_bf16 v[112:127], a[124:127], v[204:207], v[112:127]
    ds_read_b64_tr_b16 a[124:125], v249 offset:9152
    ds_read_b64_tr_b16 a[126:127], v249 offset:9664
    v_add_f32 v209, v209, v131
    v_exp_f32 v134, v134
    v_mfma_f32_32x32x16_bf16 v[144:159], a[64:67], a[32:35], v[176:191]
    ds_read_b128 a[64:67], v247 offset:0
    v_exp_f32 v135, v135
    v_cvt_pk_bf16_f32 v194, v132, v133
    v_add_f32 v208, v208, v132
    v_add_f32 v209, v209, v133
    v_mfma_f32_32x32x16_bf16 v[144:159], a[68:71], a[36:39], v[144:159]
    ds_read_b128 a[68:71], v248 offset:0
    v_exp_f32 v136, v136
    v_exp_f32 v137, v137
    v_mfma_f32_32x32x16_bf16 v[144:159], a[72:75], a[40:43], v[144:159]
    ds_read_b128 a[72:75], v247 offset:64
    v_cvt_pk_bf16_f32 v195, v134, v135
    v_add_f32 v208, v208, v134
    v_add_f32 v209, v209, v135
    v_exp_f32 v138, v138
    v_mfma_f32_32x32x16_bf16 v[144:159], a[76:79], a[44:47], v[144:159]
    ds_read_b128 a[76:79], v248 offset:64
    v_exp_f32 v139, v139
    v_cvt_pk_bf16_f32 v196, v136, v137
    v_add_f32 v208, v208, v136
    v_mfma_f32_32x32x16_bf16 v[144:159], a[80:83], a[48:51], v[144:159]
    ds_read_b128 a[80:83], v247 offset:128
    v_add_f32 v209, v209, v137
    v_exp_f32 v140, v140
    v_exp_f32 v141, v141
    v_mfma_f32_32x32x16_bf16 v[144:159], a[84:87], a[52:55], v[144:159]
    ds_read_b128 a[84:87], v248 offset:128
    v_cvt_pk_bf16_f32 v197, v138, v139
    v_add_f32 v208, v208, v138
    v_add_f32 v209, v209, v139
    v_exp_f32 v142, v142
    v_mfma_f32_32x32x16_bf16 v[144:159], a[88:91], a[56:59], v[144:159]
    ds_read_b128 a[88:91], v247 offset:192
    v_exp_f32 v143, v143
    v_cvt_pk_bf16_f32 v198, v140, v141
    v_add_f32 v208, v208, v140
    v_mfma_f32_32x32x16_bf16 v[144:159], a[92:95], a[60:63], v[144:159]
    ds_read_b128 a[92:95], v248 offset:192
    v_add_f32 v209, v209, v141
    v_cvt_pk_bf16_f32 v199, v142, v143
    v_add_f32 v208, v208, v142
    v_add_f32 v209, v209, v143
    s_waitcnt lgkmcnt(8)
    v_mfma_f32_32x32x16_bf16 v[0:15], a[96:99], v[192:195], v[0:15]
    v_mfma_f32_32x32x16_bf16 v[16:31], a[100:103], v[192:195], v[16:31]
    v_mfma_f32_32x32x16_bf16 v[32:47], a[104:107], v[192:195], v[32:47]
    s_nop 2
    v_exp_f32 v144, v144
    v_exp_f32 v145, v145
    v_mfma_f32_32x32x16_bf16 v[48:63], a[108:111], v[192:195], v[48:63]
    v_exp_f32 v146, v146
    v_exp_f32 v147, v147
    v_cvt_pk_bf16_f32 v200, v144, v145
    v_mfma_f32_32x32x16_bf16 v[0:15], a[112:115], v[196:199], v[0:15]
    v_add_f32 v210, v210, v144
    v_add_f32 v211, v211, v145
    v_exp_f32 v148, v148
    v_exp_f32 v149, v149
    v_mfma_f32_32x32x16_bf16 v[16:31], a[116:119], v[196:199], v[16:31]
    v_cvt_pk_bf16_f32 v201, v146, v147
    v_add_f32 v210, v210, v146
    v_add_f32 v211, v211, v147
    v_mfma_f32_32x32x16_bf16 v[32:47], a[120:123], v[196:199], v[32:47]
    v_exp_f32 v150, v150
    v_exp_f32 v151, v151
    v_cvt_pk_bf16_f32 v202, v148, v149
    v_add_f32 v210, v210, v148
    v_mfma_f32_32x32x16_bf16 v[48:63], a[124:127], v[196:199], v[48:63]
    v_add_f32 v211, v211, v149
    v_exp_f32 v152, v152
    v_exp_f32 v153, v153
    s_waitcnt lgkmcnt(0)
    v_mfma_f32_32x32x16_bf16 v[128:143], a[64:67], a[0:3], v[160:175]
    v_add_u32 v249, s42, v245
    s_waitcnt vmcnt(21)
    buffer_store_dwordx4 a[164:167], v255, s[92:95], 0 offen offset:1024 sc1
    v_cvt_pk_bf16_f32 v203, v150, v151
    v_add_f32 v210, v210, v150
    v_mfma_f32_32x32x16_bf16 v[128:143], a[68:71], a[4:7], v[128:143]
    s_add_u32 s42, s42, 17920
    s_cmp_ge_u32 s42, 125440
    v_add_f32 v211, v211, v151
    v_exp_f32 v154, v154
    v_mfma_f32_32x32x16_bf16 v[128:143], a[72:75], a[8:11], v[128:143]
    s_cselect_b32 s38, 125440, 0
    s_sub_u32 s42, s42, s38
    v_exp_f32 v155, v155
    v_mfma_f32_32x32x16_bf16 v[128:143], a[76:79], a[12:15], v[128:143]
    v_add_u32 v247, s42, v243
    v_cvt_pk_bf16_f32 v204, v152, v153
    v_add_f32 v210, v210, v152
    v_add_f32 v211, v211, v153
    v_exp_f32 v156, v156
    v_mfma_f32_32x32x16_bf16 v[128:143], a[80:83], a[16:19], v[128:143]
    v_add_u32 v248, s42, v244
    v_exp_f32 v157, v157
    v_cvt_pk_bf16_f32 v205, v154, v155
    v_mfma_f32_32x32x16_bf16 v[128:143], a[84:87], a[20:23], v[128:143]
    v_add_f32 v210, v210, v154
    v_add_f32 v211, v211, v155
    v_exp_f32 v158, v158
    v_mfma_f32_32x32x16_bf16 v[128:143], a[88:91], a[24:27], v[128:143]
    v_exp_f32 v159, v159
    v_cvt_pk_bf16_f32 v206, v156, v157
    v_add_f32 v210, v210, v156
    v_add_f32 v211, v211, v157
    v_mfma_f32_32x32x16_bf16 v[128:143], a[92:95], a[28:31], v[128:143]
    s_waitcnt vmcnt(17)
    s_barrier
    v_cvt_pk_bf16_f32 v207, v158, v159
    v_add_f32 v210, v210, v158
    v_add_f32 v211, v211, v159
    v_mfma_f32_32x32x16_bf16 v[64:79], a[96:99], v[200:203], v[64:79]
    ds_read_b64_tr_b16 a[96:97], v249 offset:0
    ds_read_b64_tr_b16 a[98:99], v249 offset:512
    v_mfma_f32_32x32x16_bf16 v[80:95], a[100:103], v[200:203], v[80:95]
    ds_read_b64_tr_b16 a[100:101], v249 offset:64
    ds_read_b64_tr_b16 a[102:103], v249 offset:576
    v_mfma_f32_32x32x16_bf16 v[96:111], a[104:107], v[200:203], v[96:111]
    ds_read_b64_tr_b16 a[104:105], v249 offset:128
    ds_read_b64_tr_b16 a[106:107], v249 offset:640
    v_exp_f32 v128, v128
    v_exp_f32 v129, v129
    v_mfma_f32_32x32x16_bf16 v[112:127], a[108:111], v[200:203], v[112:127]
    ds_read_b64_tr_b16 a[108:109], v249 offset:192
    ds_read_b64_tr_b16 a[110:111], v249 offset:704
    buffer_store_dwordx4 a[184:187], v255, s[96:99], 0 offen offset:1024 sc1
    v_exp_f32 v130, v130
    v_mfma_f32_32x32x16_bf16 v[64:79], a[112:115], v[204:207], v[64:79]
    ds_read_b64_tr_b16 a[112:113], v249 offset:8960
    ds_read_b64_tr_b16 a[114:115], v249 offset:9472
    v_exp_f32 v131, v131
    v_cvt_pk_bf16_f32 v192, v128, v129
    v_add_f32 v208, v208, v128
    v_mfma_f32_32x32x16_bf16 v[80:95], a[116:119], v[204:207], v[80:95]
    ds_read_b64_tr_b16 a[116:117], v249 offset:9024
    ds_read_b64_tr_b16 a[118:119], v249 offset:9536
    v_add_f32 v209, v209, v129
    v_exp_f32 v132, v132
    v_mfma_f32_32x32x16_bf16 v[96:111], a[120:123], v[204:207], v[96:111]
    ds_read_b64_tr_b16 a[120:121], v249 offset:9088
    ds_read_b64_tr_b16 a[122:123], v249 offset:9600
    v_exp_f32 v133, v133
    v_cvt_pk_bf16_f32 v193, v130, v131
    v_add_f32 v208, v208, v130
    v_mfma_f32_32x32x16_bf16 v[112:127], a[124:127], v[204:207], v[112:127]
    ds_read_b64_tr_b16 a[124:125], v249 offset:9152
    ds_read_b64_tr_b16 a[126:127], v249 offset:9664
    v_add_f32 v209, v209, v131
    v_exp_f32 v134, v134
    v_mfma_f32_32x32x16_bf16 v[144:159], a[64:67], a[32:35], v[176:191]
    ds_read_b128 a[64:67], v247 offset:0
    v_exp_f32 v135, v135
    v_cvt_pk_bf16_f32 v194, v132, v133
    v_add_f32 v208, v208, v132
    v_add_f32 v209, v209, v133
    v_mfma_f32_32x32x16_bf16 v[144:159], a[68:71], a[36:39], v[144:159]
    ds_read_b128 a[68:71], v248 offset:0
    v_exp_f32 v136, v136
    v_exp_f32 v137, v137
    v_mfma_f32_32x32x16_bf16 v[144:159], a[72:75], a[40:43], v[144:159]
    ds_read_b128 a[72:75], v247 offset:64
    v_cvt_pk_bf16_f32 v195, v134, v135
    v_add_f32 v208, v208, v134
    v_add_f32 v209, v209, v135
    v_exp_f32 v138, v138
    v_mfma_f32_32x32x16_bf16 v[144:159], a[76:79], a[44:47], v[144:159]
    ds_read_b128 a[76:79], v248 offset:64
    v_exp_f32 v139, v139
    v_cvt_pk_bf16_f32 v196, v136, v137
    v_add_f32 v208, v208, v136
    v_mfma_f32_32x32x16_bf16 v[144:159], a[80:83], a[48:51], v[144:159]
    ds_read_b128 a[80:83], v247 offset:128
    v_add_f32 v209, v209, v137
    v_exp_f32 v140, v140
    v_exp_f32 v141, v141
    v_mfma_f32_32x32x16_bf16 v[144:159], a[84:87], a[52:55], v[144:159]
    ds_read_b128 a[84:87], v248 offset:128
    v_cvt_pk_bf16_f32 v197, v138, v139
    v_add_f32 v208, v208, v138
    v_add_f32 v209, v209, v139
    v_exp_f32 v142, v142
    v_mfma_f32_32x32x16_bf16 v[144:159], a[88:91], a[56:59], v[144:159]
    ds_read_b128 a[88:91], v247 offset:192
    v_exp_f32 v143, v143
    v_cvt_pk_bf16_f32 v198, v140, v141
    v_add_f32 v208, v208, v140
    v_mfma_f32_32x32x16_bf16 v[144:159], a[92:95], a[60:63], v[144:159]
    ds_read_b128 a[92:95], v248 offset:192
    v_add_f32 v209, v209, v141
    v_cvt_pk_bf16_f32 v199, v142, v143
    v_add_f32 v208, v208, v142
    v_add_f32 v209, v209, v143
    s_waitcnt lgkmcnt(8)
    v_mfma_f32_32x32x16_bf16 v[0:15], a[96:99], v[192:195], v[0:15]
    v_mfma_f32_32x32x16_bf16 v[16:31], a[100:103], v[192:195], v[16:31]
    v_mfma_f32_32x32x16_bf16 v[32:47], a[104:107], v[192:195], v[32:47]
    s_nop 2
    v_exp_f32 v144, v144
    v_exp_f32 v145, v145
    v_mfma_f32_32x32x16_bf16 v[48:63], a[108:111], v[192:195], v[48:63]
    v_exp_f32 v146, v146
    v_exp_f32 v147, v147
    v_cvt_pk_bf16_f32 v200, v144, v145
    v_mfma_f32_32x32x16_bf16 v[0:15], a[112:115], v[196:199], v[0:15]
    v_add_f32 v210, v210, v144
    v_add_f32 v211, v211, v145
    v_exp_f32 v148, v148
    v_exp_f32 v149, v149
    v_mfma_f32_32x32x16_bf16 v[16:31], a[116:119], v[196:199], v[16:31]
    v_cvt_pk_bf16_f32 v201, v146, v147
    v_add_f32 v210, v210, v146
    v_add_f32 v211, v211, v147
    v_mfma_f32_32x32x16_bf16 v[32:47], a[120:123], v[196:199], v[32:47]
    v_exp_f32 v150, v150
    v_exp_f32 v151, v151
    v_cvt_pk_bf16_f32 v202, v148, v149
    v_add_f32 v210, v210, v148
    v_mfma_f32_32x32x16_bf16 v[48:63], a[124:127], v[196:199], v[48:63]
    v_add_f32 v211, v211, v149
    v_exp_f32 v152, v152
    v_exp_f32 v153, v153
    s_waitcnt lgkmcnt(0)
    v_mfma_f32_32x32x16_bf16 v[128:143], a[64:67], a[0:3], v[160:175]
    v_add_u32 v249, s42, v245
    s_waitcnt vmcnt(17)
    buffer_store_dwordx4 a[168:171], v255, s[92:95], 0 offen offset:2048 sc1
    v_cvt_pk_bf16_f32 v203, v150, v151
    v_add_f32 v210, v210, v150
    v_mfma_f32_32x32x16_bf16 v[128:143], a[68:71], a[4:7], v[128:143]
    s_add_u32 s42, s42, 17920
    s_cmp_ge_u32 s42, 125440
    v_add_f32 v211, v211, v151
    v_exp_f32 v154, v154
    v_mfma_f32_32x32x16_bf16 v[128:143], a[72:75], a[8:11], v[128:143]
    s_cselect_b32 s38, 125440, 0
    s_sub_u32 s42, s42, s38
    v_exp_f32 v155, v155
    v_mfma_f32_32x32x16_bf16 v[128:143], a[76:79], a[12:15], v[128:143]
    v_add_u32 v247, s42, v243
    v_cvt_pk_bf16_f32 v204, v152, v153
    v_add_f32 v210, v210, v152
    v_add_f32 v211, v211, v153
    v_exp_f32 v156, v156
    v_mfma_f32_32x32x16_bf16 v[128:143], a[80:83], a[16:19], v[128:143]
    v_add_u32 v248, s42, v244
    v_exp_f32 v157, v157
    v_cvt_pk_bf16_f32 v205, v154, v155
    v_mfma_f32_32x32x16_bf16 v[128:143], a[84:87], a[20:23], v[128:143]
    v_add_f32 v210, v210, v154
    v_add_f32 v211, v211, v155
    v_exp_f32 v158, v158
    v_mfma_f32_32x32x16_bf16 v[128:143], a[88:91], a[24:27], v[128:143]
    v_exp_f32 v159, v159
    v_cvt_pk_bf16_f32 v206, v156, v157
    v_add_f32 v210, v210, v156
    v_add_f32 v211, v211, v157
    v_mfma_f32_32x32x16_bf16 v[128:143], a[92:95], a[28:31], v[128:143]
    s_waitcnt vmcnt(13)
    s_barrier
    v_cvt_pk_bf16_f32 v207, v158, v159
    v_add_f32 v210, v210, v158
    v_add_f32 v211, v211, v159
    v_mfma_f32_32x32x16_bf16 v[64:79], a[96:99], v[200:203], v[64:79]
    ds_read_b64_tr_b16 a[96:97], v249 offset:0
    ds_read_b64_tr_b16 a[98:99], v249 offset:512
    v_mfma_f32_32x32x16_bf16 v[80:95], a[100:103], v[200:203], v[80:95]
    ds_read_b64_tr_b16 a[100:101], v249 offset:64
    ds_read_b64_tr_b16 a[102:103], v249 offset:576
    v_mfma_f32_32x32x16_bf16 v[96:111], a[104:107], v[200:203], v[96:111]
    ds_read_b64_tr_b16 a[104:105], v249 offset:128
    ds_read_b64_tr_b16 a[106:107], v249 offset:640
    v_exp_f32 v128, v128
    v_exp_f32 v129, v129
    v_mfma_f32_32x32x16_bf16 v[112:127], a[108:111], v[200:203], v[112:127]
    ds_read_b64_tr_b16 a[108:109], v249 offset:192
    ds_read_b64_tr_b16 a[110:111], v249 offset:704
    buffer_store_dwordx4 a[188:191], v255, s[96:99], 0 offen offset:2048 sc1
    v_exp_f32 v130, v130
    v_mfma_f32_32x32x16_bf16 v[64:79], a[112:115], v[204:207], v[64:79]
    ds_read_b64_tr_b16 a[112:113], v249 offset:8960
    ds_read_b64_tr_b16 a[114:115], v249 offset:9472
    v_exp_f32 v131, v131
    v_cvt_pk_bf16_f32 v192, v128, v129
    v_add_f32 v208, v208, v128
    v_mfma_f32_32x32x16_bf16 v[80:95], a[116:119], v[204:207], v[80:95]
    ds_read_b64_tr_b16 a[116:117], v249 offset:9024
    ds_read_b64_tr_b16 a[118:119], v249 offset:9536
    v_add_f32 v209, v209, v129
    v_exp_f32 v132, v132
    v_mfma_f32_32x32x16_bf16 v[96:111], a[120:123], v[204:207], v[96:111]
    ds_read_b64_tr_b16 a[120:121], v249 offset:9088
    ds_read_b64_tr_b16 a[122:123], v249 offset:9600
    v_exp_f32 v133, v133
    v_cvt_pk_bf16_f32 v193, v130, v131
    v_add_f32 v208, v208, v130
    v_mfma_f32_32x32x16_bf16 v[112:127], a[124:127], v[204:207], v[112:127]
    ds_read_b64_tr_b16 a[124:125], v249 offset:9152
    ds_read_b64_tr_b16 a[126:127], v249 offset:9664
    v_add_f32 v209, v209, v131
    v_exp_f32 v134, v134
    v_mfma_f32_32x32x16_bf16 v[144:159], a[64:67], a[32:35], v[176:191]
    ds_read_b128 a[64:67], v247 offset:0
    v_exp_f32 v135, v135
    v_cvt_pk_bf16_f32 v194, v132, v133
    v_add_f32 v208, v208, v132
    v_add_f32 v209, v209, v133
    v_mfma_f32_32x32x16_bf16 v[144:159], a[68:71], a[36:39], v[144:159]
    ds_read_b128 a[68:71], v248 offset:0
    v_exp_f32 v136, v136
    v_exp_f32 v137, v137
    v_mfma_f32_32x32x16_bf16 v[144:159], a[72:75], a[40:43], v[144:159]
    ds_read_b128 a[72:75], v247 offset:64
    v_cvt_pk_bf16_f32 v195, v134, v135
    v_add_f32 v208, v208, v134
    v_add_f32 v209, v209, v135
    v_exp_f32 v138, v138
    v_mfma_f32_32x32x16_bf16 v[144:159], a[76:79], a[44:47], v[144:159]
    ds_read_b128 a[76:79], v248 offset:64
    v_exp_f32 v139, v139
    v_cvt_pk_bf16_f32 v196, v136, v137
    v_add_f32 v208, v208, v136
    v_mfma_f32_32x32x16_bf16 v[144:159], a[80:83], a[48:51], v[144:159]
    ds_read_b128 a[80:83], v247 offset:128
    v_add_f32 v209, v209, v137
    v_exp_f32 v140, v140
    v_exp_f32 v141, v141
    v_mfma_f32_32x32x16_bf16 v[144:159], a[84:87], a[52:55], v[144:159]
    ds_read_b128 a[84:87], v248 offset:128
    v_cvt_pk_bf16_f32 v197, v138, v139
    v_add_f32 v208, v208, v138
    v_add_f32 v209, v209, v139
    v_exp_f32 v142, v142
    v_mfma_f32_32x32x16_bf16 v[144:159], a[88:91], a[56:59], v[144:159]
    ds_read_b128 a[88:91], v247 offset:192
    v_exp_f32 v143, v143
    v_cvt_pk_bf16_f32 v198, v140, v141
    v_add_f32 v208, v208, v140
    v_mfma_f32_32x32x16_bf16 v[144:159], a[92:95], a[60:63], v[144:159]
    ds_read_b128 a[92:95], v248 offset:192
    v_add_f32 v209, v209, v141
    v_cvt_pk_bf16_f32 v199, v142, v143
    v_add_f32 v208, v208, v142
    v_add_f32 v209, v209, v143
    s_waitcnt lgkmcnt(8)
    v_mfma_f32_32x32x16_bf16 v[0:15], a[96:99], v[192:195], v[0:15]
    v_mfma_f32_32x32x16_bf16 v[16:31], a[100:103], v[192:195], v[16:31]
    v_mfma_f32_32x32x16_bf16 v[32:47], a[104:107], v[192:195], v[32:47]
    s_nop 2
    v_exp_f32 v144, v144
    v_exp_f32 v145, v145
    v_mfma_f32_32x32x16_bf16 v[48:63], a[108:111], v[192:195], v[48:63]
    v_exp_f32 v146, v146
    v_exp_f32 v147, v147
    v_cvt_pk_bf16_f32 v200, v144, v145
    v_mfma_f32_32x32x16_bf16 v[0:15], a[112:115], v[196:199], v[0:15]
    v_add_f32 v210, v210, v144
    v_add_f32 v211, v211, v145
    v_exp_f32 v148, v148
    v_exp_f32 v149, v149
    v_mfma_f32_32x32x16_bf16 v[16:31], a[116:119], v[196:199], v[16:31]
    v_cvt_pk_bf16_f32 v201, v146, v147
    v_add_f32 v210, v210, v146
    v_add_f32 v211, v211, v147
    v_mfma_f32_32x32x16_bf16 v[32:47], a[120:123], v[196:199], v[32:47]
    v_exp_f32 v150, v150
    v_exp_f32 v151, v151
    v_cvt_pk_bf16_f32 v202, v148, v149
    v_add_f32 v210, v210, v148
    v_mfma_f32_32x32x16_bf16 v[48:63], a[124:127], v[196:199], v[48:63]
    v_add_f32 v211, v211, v149
    v_exp_f32 v152, v152
    v_exp_f32 v153, v153
    s_waitcnt lgkmcnt(0)
    v_mfma_f32_32x32x16_bf16 v[128:143], a[64:67], a[0:3], v[160:175]
    v_add_u32 v249, s42, v245
    s_waitcnt vmcnt(13)
    buffer_store_dwordx4 a[172:175], v255, s[92:95], 0 offen offset:3072 sc1
    v_cvt_pk_bf16_f32 v203, v150, v151
    v_add_f32 v210, v210, v150
    v_mfma_f32_32x32x16_bf16 v[128:143], a[68:71], a[4:7], v[128:143]
    s_add_u32 s42, s42, 17920
    s_cmp_ge_u32 s42, 125440
    v_add_f32 v211, v211, v151
    v_exp_f32 v154, v154
    v_mfma_f32_32x32x16_bf16 v[128:143], a[72:75], a[8:11], v[128:143]
    s_cselect_b32 s38, 125440, 0
    s_sub_u32 s42, s42, s38
    v_exp_f32 v155, v155
    v_mfma_f32_32x32x16_bf16 v[128:143], a[76:79], a[12:15], v[128:143]
    v_add_u32 v247, s42, v243
    v_cvt_pk_bf16_f32 v204, v152, v153
    v_add_f32 v210, v210, v152
    v_add_f32 v211, v211, v153
    v_exp_f32 v156, v156
    v_mfma_f32_32x32x16_bf16 v[128:143], a[80:83], a[16:19], v[128:143]
    v_add_u32 v248, s42, v244
    v_exp_f32 v157, v157
    v_cvt_pk_bf16_f32 v205, v154, v155
    v_mfma_f32_32x32x16_bf16 v[128:143], a[84:87], a[20:23], v[128:143]
    v_add_f32 v210, v210, v154
    v_add_f32 v211, v211, v155
    v_exp_f32 v158, v158
    v_mfma_f32_32x32x16_bf16 v[128:143], a[88:91], a[24:27], v[128:143]
    v_exp_f32 v159, v159
    v_cvt_pk_bf16_f32 v206, v156, v157
    v_add_f32 v210, v210, v156
    v_add_f32 v211, v211, v157
    v_mfma_f32_32x32x16_bf16 v[128:143], a[92:95], a[28:31], v[128:143]
    s_waitcnt vmcnt(9)
    s_barrier
    v_cvt_pk_bf16_f32 v207, v158, v159
    v_add_f32 v210, v210, v158
    v_add_f32 v211, v211, v159
    v_mfma_f32_32x32x16_bf16 v[64:79], a[96:99], v[200:203], v[64:79]
    ds_read_b64_tr_b16 a[96:97], v249 offset:0
    ds_read_b64_tr_b16 a[98:99], v249 offset:512
    v_mfma_f32_32x32x16_bf16 v[80:95], a[100:103], v[200:203], v[80:95]
    ds_read_b64_tr_b16 a[100:101], v249 offset:64
    ds_read_b64_tr_b16 a[102:103], v249 offset:576
    v_mfma_f32_32x32x16_bf16 v[96:111], a[104:107], v[200:203], v[96:111]
    ds_read_b64_tr_b16 a[104:105], v249 offset:128
    ds_read_b64_tr_b16 a[106:107], v249 offset:640
    v_exp_f32 v128, v128
    v_exp_f32 v129, v129
    v_mfma_f32_32x32x16_bf16 v[112:127], a[108:111], v[200:203], v[112:127]
    ds_read_b64_tr_b16 a[108:109], v249 offset:192
    ds_read_b64_tr_b16 a[110:111], v249 offset:704
    buffer_store_dwordx4 a[192:195], v255, s[96:99], 0 offen offset:3072 sc1
    v_exp_f32 v130, v130
    v_mfma_f32_32x32x16_bf16 v[64:79], a[112:115], v[204:207], v[64:79]
    ds_read_b64_tr_b16 a[112:113], v249 offset:8960
    ds_read_b64_tr_b16 a[114:115], v249 offset:9472
    v_exp_f32 v131, v131
    v_cvt_pk_bf16_f32 v192, v128, v129
    v_add_f32 v208, v208, v128
    v_mfma_f32_32x32x16_bf16 v[80:95], a[116:119], v[204:207], v[80:95]
    ds_read_b64_tr_b16 a[116:117], v249 offset:9024
    ds_read_b64_tr_b16 a[118:119], v249 offset:9536
    v_add_f32 v209, v209, v129
    v_exp_f32 v132, v132
    v_mfma_f32_32x32x16_bf16 v[96:111], a[120:123], v[204:207], v[96:111]
    ds_read_b64_tr_b16 a[120:121], v249 offset:9088
    ds_read_b64_tr_b16 a[122:123], v249 offset:9600
    v_exp_f32 v133, v133
    v_cvt_pk_bf16_f32 v193, v130, v131
    v_add_f32 v208, v208, v130
    v_mfma_f32_32x32x16_bf16 v[112:127], a[124:127], v[204:207], v[112:127]
    ds_read_b64_tr_b16 a[124:125], v249 offset:9152
    ds_read_b64_tr_b16 a[126:127], v249 offset:9664
    v_add_f32 v209, v209, v131
    v_exp_f32 v134, v134
    v_mfma_f32_32x32x16_bf16 v[144:159], a[64:67], a[32:35], v[176:191]
    ds_read_b128 a[64:67], v247 offset:0
    v_exp_f32 v135, v135
    v_cvt_pk_bf16_f32 v194, v132, v133
    v_add_f32 v208, v208, v132
    v_add_f32 v209, v209, v133
    v_mfma_f32_32x32x16_bf16 v[144:159], a[68:71], a[36:39], v[144:159]
    ds_read_b128 a[68:71], v248 offset:0
    v_exp_f32 v136, v136
    v_exp_f32 v137, v137
    v_mfma_f32_32x32x16_bf16 v[144:159], a[72:75], a[40:43], v[144:159]
    ds_read_b128 a[72:75], v247 offset:64
    v_cvt_pk_bf16_f32 v195, v134, v135
    v_add_f32 v208, v208, v134
    v_add_f32 v209, v209, v135
    v_exp_f32 v138, v138
    v_mfma_f32_32x32x16_bf16 v[144:159], a[76:79], a[44:47], v[144:159]
    ds_read_b128 a[76:79], v248 offset:64
    v_exp_f32 v139, v139
    v_cvt_pk_bf16_f32 v196, v136, v137
    v_add_f32 v208, v208, v136
    v_mfma_f32_32x32x16_bf16 v[144:159], a[80:83], a[48:51], v[144:159]
    ds_read_b128 a[80:83], v247 offset:128
    v_add_f32 v209, v209, v137
    v_exp_f32 v140, v140
    v_exp_f32 v141, v141
    v_mfma_f32_32x32x16_bf16 v[144:159], a[84:87], a[52:55], v[144:159]
    ds_read_b128 a[84:87], v248 offset:128
    v_cvt_pk_bf16_f32 v197, v138, v139
    v_add_f32 v208, v208, v138
    v_add_f32 v209, v209, v139
    v_exp_f32 v142, v142
    v_mfma_f32_32x32x16_bf16 v[144:159], a[88:91], a[56:59], v[144:159]
    ds_read_b128 a[88:91], v247 offset:192
    v_exp_f32 v143, v143
    v_cvt_pk_bf16_f32 v198, v140, v141
    v_add_f32 v208, v208, v140
    v_mfma_f32_32x32x16_bf16 v[144:159], a[92:95], a[60:63], v[144:159]
    ds_read_b128 a[92:95], v248 offset:192
    v_add_f32 v209, v209, v141
    v_cvt_pk_bf16_f32 v199, v142, v143
    v_add_f32 v208, v208, v142
    v_add_f32 v209, v209, v143
    s_waitcnt lgkmcnt(8)
    v_mfma_f32_32x32x16_bf16 v[0:15], a[96:99], v[192:195], v[0:15]
    v_mfma_f32_32x32x16_bf16 v[16:31], a[100:103], v[192:195], v[16:31]
    v_mfma_f32_32x32x16_bf16 v[32:47], a[104:107], v[192:195], v[32:47]
    s_nop 2
    v_exp_f32 v144, v144
    v_exp_f32 v145, v145
    v_mfma_f32_32x32x16_bf16 v[48:63], a[108:111], v[192:195], v[48:63]
    v_exp_f32 v146, v146
    v_exp_f32 v147, v147
    v_cvt_pk_bf16_f32 v200, v144, v145
    v_mfma_f32_32x32x16_bf16 v[0:15], a[112:115], v[196:199], v[0:15]
    v_add_f32 v210, v210, v144
    v_add_f32 v211, v211, v145
    v_exp_f32 v148, v148
    v_exp_f32 v149, v149
    v_mfma_f32_32x32x16_bf16 v[16:31], a[116:119], v[196:199], v[16:31]
    v_cvt_pk_bf16_f32 v201, v146, v147
    v_add_f32 v210, v210, v146
    v_add_f32 v211, v211, v147
    v_mfma_f32_32x32x16_bf16 v[32:47], a[120:123], v[196:199], v[32:47]
    v_exp_f32 v150, v150
    v_exp_f32 v151, v151
    v_cvt_pk_bf16_f32 v202, v148, v149
    v_add_f32 v210, v210, v148
    v_mfma_f32_32x32x16_bf16 v[48:63], a[124:127], v[196:199], v[48:63]
    v_add_f32 v211, v211, v149
    v_exp_f32 v152, v152
    v_exp_f32 v153, v153
    s_waitcnt lgkmcnt(0)
    v_mfma_f32_32x32x16_bf16 v[128:143], a[64:67], a[0:3], v[160:175]
    v_add_u32 v249, s42, v245
    s_waitcnt vmcnt(9)
    buffer_store_dwordx4 a[176:179], v255, s[92:95], s100 offen offset:0 sc1
    v_cvt_pk_bf16_f32 v203, v150, v151
    v_add_f32 v210, v210, v150
    v_mfma_f32_32x32x16_bf16 v[128:143], a[68:71], a[4:7], v[128:143]
    s_add_u32 s42, s42, 17920
    s_cmp_ge_u32 s42, 125440
    v_add_f32 v211, v211, v151
    v_exp_f32 v154, v154
    v_mfma_f32_32x32x16_bf16 v[128:143], a[72:75], a[8:11], v[128:143]
    s_cselect_b32 s38, 125440, 0
    s_sub_u32 s42, s42, s38
    v_exp_f32 v155, v155
    v_mfma_f32_32x32x16_bf16 v[128:143], a[76:79], a[12:15], v[128:143]
    v_add_u32 v247, s42, v243
    v_cvt_pk_bf16_f32 v204, v152, v153
    v_add_f32 v210, v210, v152
    v_add_f32 v211, v211, v153
    v_exp_f32 v156, v156
    v_mfma_f32_32x32x16_bf16 v[128:143], a[80:83], a[16:19], v[128:143]
    v_add_u32 v248, s42, v244
    v_exp_f32 v157, v157
    v_cvt_pk_bf16_f32 v205, v154, v155
    v_mfma_f32_32x32x16_bf16 v[128:143], a[84:87], a[20:23], v[128:143]
    v_add_f32 v210, v210, v154
    v_add_f32 v211, v211, v155
    v_exp_f32 v158, v158
    v_mfma_f32_32x32x16_bf16 v[128:143], a[88:91], a[24:27], v[128:143]
    v_exp_f32 v159, v159
    v_cvt_pk_bf16_f32 v206, v156, v157
    v_add_f32 v210, v210, v156
    v_add_f32 v211, v211, v157
    v_mfma_f32_32x32x16_bf16 v[128:143], a[92:95], a[28:31], v[128:143]
    s_barrier
    v_cvt_pk_bf16_f32 v207, v158, v159
    v_add_f32 v210, v210, v158
    v_add_f32 v211, v211, v159
    v_mfma_f32_32x32x16_bf16 v[64:79], a[96:99], v[200:203], v[64:79]
    ds_read_b64_tr_b16 a[96:97], v249 offset:0
    ds_read_b64_tr_b16 a[98:99], v249 offset:512
    v_mfma_f32_32x32x16_bf16 v[80:95], a[100:103], v[200:203], v[80:95]
    ds_read_b64_tr_b16 a[100:101], v249 offset:64
    ds_read_b64_tr_b16 a[102:103], v249 offset:576
    v_mfma_f32_32x32x16_bf16 v[96:111], a[104:107], v[200:203], v[96:111]
    ds_read_b64_tr_b16 a[104:105], v249 offset:128
    ds_read_b64_tr_b16 a[106:107], v249 offset:640
    v_exp_f32 v128, v128
    v_exp_f32 v129, v129
    v_mfma_f32_32x32x16_bf16 v[112:127], a[108:111], v[200:203], v[112:127]
    ds_read_b64_tr_b16 a[108:109], v249 offset:192
    ds_read_b64_tr_b16 a[110:111], v249 offset:704
    s_waitcnt vmcnt(9)
    buffer_store_dwordx4 a[196:199], v255, s[96:99], s100 offen offset:0 sc1
    v_exp_f32 v130, v130
    v_mfma_f32_32x32x16_bf16 v[64:79], a[112:115], v[204:207], v[64:79]
    ds_read_b64_tr_b16 a[112:113], v249 offset:8960
    ds_read_b64_tr_b16 a[114:115], v249 offset:9472
    v_exp_f32 v131, v131
    v_cvt_pk_bf16_f32 v192, v128, v129
    v_add_f32 v208, v208, v128
    v_mfma_f32_32x32x16_bf16 v[80:95], a[116:119], v[204:207], v[80:95]
    ds_read_b64_tr_b16 a[116:117], v249 offset:9024
    ds_read_b64_tr_b16 a[118:119], v249 offset:9536
    v_add_f32 v209, v209, v129
    v_exp_f32 v132, v132
    v_mfma_f32_32x32x16_bf16 v[96:111], a[120:123], v[204:207], v[96:111]
    ds_read_b64_tr_b16 a[120:121], v249 offset:9088
    ds_read_b64_tr_b16 a[122:123], v249 offset:9600
    v_exp_f32 v133, v133
    v_cvt_pk_bf16_f32 v193, v130, v131
    v_add_f32 v208, v208, v130
    v_mfma_f32_32x32x16_bf16 v[112:127], a[124:127], v[204:207], v[112:127]
    ds_read_b64_tr_b16 a[124:125], v249 offset:9152
    ds_read_b64_tr_b16 a[126:127], v249 offset:9664
    v_add_f32 v209, v209, v131
    v_exp_f32 v134, v134
    v_mfma_f32_32x32x16_bf16 v[144:159], a[64:67], a[32:35], v[176:191]
    ds_read_b128 a[64:67], v247 offset:0
    v_exp_f32 v135, v135
    v_cvt_pk_bf16_f32 v194, v132, v133
    v_add_f32 v208, v208, v132
    v_add_f32 v209, v209, v133
    v_mfma_f32_32x32x16_bf16 v[144:159], a[68:71], a[36:39], v[144:159]
    ds_read_b128 a[68:71], v248 offset:0
    v_exp_f32 v136, v136
    v_exp_f32 v137, v137
    v_mfma_f32_32x32x16_bf16 v[144:159], a[72:75], a[40:43], v[144:159]
    ds_read_b128 a[72:75], v247 offset:64
    v_cvt_pk_bf16_f32 v195, v134, v135
    v_add_f32 v208, v208, v134
    v_add_f32 v209, v209, v135
    v_exp_f32 v138, v138
    v_mfma_f32_32x32x16_bf16 v[144:159], a[76:79], a[44:47], v[144:159]
    ds_read_b128 a[76:79], v248 offset:64
    v_exp_f32 v139, v139
    v_cvt_pk_bf16_f32 v196, v136, v137
    v_add_f32 v208, v208, v136
    v_mfma_f32_32x32x16_bf16 v[144:159], a[80:83], a[48:51], v[144:159]
    ds_read_b128 a[80:83], v247 offset:128
    v_add_f32 v209, v209, v137
    v_exp_f32 v140, v140
    v_exp_f32 v141, v141
    v_mfma_f32_32x32x16_bf16 v[144:159], a[84:87], a[52:55], v[144:159]
    ds_read_b128 a[84:87], v248 offset:128
    v_cvt_pk_bf16_f32 v197, v138, v139
    v_add_f32 v208, v208, v138
    v_add_f32 v209, v209, v139
    v_exp_f32 v142, v142
    v_mfma_f32_32x32x16_bf16 v[144:159], a[88:91], a[56:59], v[144:159]
    ds_read_b128 a[88:91], v247 offset:192
    v_exp_f32 v143, v143
    v_cvt_pk_bf16_f32 v198, v140, v141
    v_add_f32 v208, v208, v140
    v_mfma_f32_32x32x16_bf16 v[144:159], a[92:95], a[60:63], v[144:159]
    ds_read_b128 a[92:95], v248 offset:192
    v_add_f32 v209, v209, v141
    v_cvt_pk_bf16_f32 v199, v142, v143
    v_add_f32 v208, v208, v142
    v_add_f32 v209, v209, v143
    s_waitcnt lgkmcnt(8)
    v_mfma_f32_32x32x16_bf16 v[0:15], a[96:99], v[192:195], v[0:15]
    s_nop 4
    v_exp_f32 v144, v144
    v_exp_f32 v145, v145
    v_exp_f32 v146, v146
    v_exp_f32 v147, v147
    v_mfma_f32_32x32x16_bf16 v[16:31], a[100:103], v[192:195], v[16:31]
    v_cvt_pk_bf16_f32 v200, v144, v145
    v_add_f32 v210, v210, v144
    v_add_f32 v211, v211, v145
    v_exp_f32 v148, v148
    v_exp_f32 v149, v149
    v_mfma_f32_32x32x16_bf16 v[32:47], a[104:107], v[192:195], v[32:47]
    v_cvt_pk_bf16_f32 v201, v146, v147
    v_add_f32 v210, v210, v146
    v_add_f32 v211, v211, v147
    v_exp_f32 v150, v150
    v_exp_f32 v151, v151
    v_mfma_f32_32x32x16_bf16 v[48:63], a[108:111], v[192:195], v[48:63]
    v_cvt_pk_bf16_f32 v202, v148, v149
    v_add_f32 v210, v210, v148
    v_add_f32 v211, v211, v149
    v_exp_f32 v152, v152
    v_exp_f32 v153, v153
    v_mfma_f32_32x32x16_bf16 v[0:15], a[112:115], v[196:199], v[0:15]
    v_cvt_pk_bf16_f32 v203, v150, v151
    v_add_f32 v210, v210, v150
    v_add_f32 v211, v211, v151
    v_exp_f32 v154, v154
    v_exp_f32 v155, v155
    v_mfma_f32_32x32x16_bf16 v[16:31], a[116:119], v[196:199], v[16:31]
    v_cvt_pk_bf16_f32 v204, v152, v153
    v_add_f32 v210, v210, v152
    v_add_f32 v211, v211, v153
    v_exp_f32 v156, v156
    v_exp_f32 v157, v157
    v_mfma_f32_32x32x16_bf16 v[32:47], a[120:123], v[196:199], v[32:47]
    v_cvt_pk_bf16_f32 v205, v154, v155
    v_add_f32 v210, v210, v154
    v_add_f32 v211, v211, v155
    v_exp_f32 v158, v158
    v_exp_f32 v159, v159
    v_mfma_f32_32x32x16_bf16 v[48:63], a[124:127], v[196:199], v[48:63]
    v_cvt_pk_bf16_f32 v206, v156, v157
    v_add_f32 v210, v210, v156
    v_add_f32 v211, v211, v157
    v_cvt_pk_bf16_f32 v207, v158, v159
    v_add_f32 v210, v210, v158
    v_add_f32 v211, v211, v159
    v_mfma_f32_32x32x16_bf16 v[64:79], a[96:99], v[200:203], v[64:79]
    v_mfma_f32_32x32x16_bf16 v[80:95], a[100:103], v[200:203], v[80:95]
    v_mfma_f32_32x32x16_bf16 v[96:111], a[104:107], v[200:203], v[96:111]
    v_mfma_f32_32x32x16_bf16 v[112:127], a[108:111], v[200:203], v[112:127]
    v_mfma_f32_32x32x16_bf16 v[64:79], a[112:115], v[204:207], v[64:79]
    v_mfma_f32_32x32x16_bf16 v[80:95], a[116:119], v[204:207], v[80:95]
    v_mfma_f32_32x32x16_bf16 v[96:111], a[120:123], v[204:207], v[96:111]
    v_mfma_f32_32x32x16_bf16 v[112:127], a[124:127], v[204:207], v[112:127]
    s_lshl_b32 s37, s34, 14
    v_add_f32 v208, v208, v209
    v_mov_b32 v209, v208
    s_nop 1
    v_permlane32_swap_b32 v208, v209
    v_add_f32 v208, v208, v209
    v_rcp_f32 v224, v208
    v_add_f32 v210, v210, v211
    v_mov_b32 v211, v210
    s_nop 1
    v_permlane32_swap_b32 v210, v211
    v_add_f32 v210, v210, v211
    v_rcp_f32 v226, v210
    v_pk_mul_f32 v[0:1], v[0:1], v[224:225] op_sel_hi:[1,0]
    v_pk_mul_f32 v[2:3], v[2:3], v[224:225] op_sel_hi:[1,0]
    v_pk_mul_f32 v[4:5], v[4:5], v[224:225] op_sel_hi:[1,0]
    v_pk_mul_f32 v[6:7], v[6:7], v[224:225] op_sel_hi:[1,0]
    v_cvt_pk_bf16_f32 v128, v0, v1
    v_cvt_pk_bf16_f32 v129, v2, v3
    v_cvt_pk_bf16_f32 v130, v4, v5
    v_cvt_pk_bf16_f32 v131, v6, v7
    buffer_store_dwordx4 v[128:131], v251, s[20:23], s37 offen offset:0 sc1
    v_pk_mul_f32 v[8:9], v[8:9], v[224:225] op_sel_hi:[1,0]
    v_pk_mul_f32 v[10:11], v[10:11], v[224:225] op_sel_hi:[1,0]
    v_pk_mul_f32 v[12:13], v[12:13], v[224:225] op_sel_hi:[1,0]
    v_pk_mul_f32 v[14:15], v[14:15], v[224:225] op_sel_hi:[1,0]
    v_cvt_pk_bf16_f32 v132, v8, v9
    v_cvt_pk_bf16_f32 v133, v10, v11
    v_cvt_pk_bf16_f32 v134, v12, v13
    v_cvt_pk_bf16_f32 v135, v14, v15
    buffer_store_dwordx4 v[132:135], v251, s[20:23], s37 offen offset:512 sc1
    v_pk_mul_f32 v[64:65], v[64:65], v[226:227] op_sel_hi:[1,0]
    v_pk_mul_f32 v[66:67], v[66:67], v[226:227] op_sel_hi:[1,0]
    v_pk_mul_f32 v[68:69], v[68:69], v[226:227] op_sel_hi:[1,0]
    v_pk_mul_f32 v[70:71], v[70:71], v[226:227] op_sel_hi:[1,0]
    v_cvt_pk_bf16_f32 v136, v64, v65
    v_cvt_pk_bf16_f32 v137, v66, v67
    v_cvt_pk_bf16_f32 v138, v68, v69
    v_cvt_pk_bf16_f32 v139, v70, v71
    buffer_store_dwordx4 v[136:139], v251, s[20:23], s37 offen offset:2048 sc1
    v_pk_mul_f32 v[72:73], v[72:73], v[226:227] op_sel_hi:[1,0]
    v_pk_mul_f32 v[74:75], v[74:75], v[226:227] op_sel_hi:[1,0]
    v_pk_mul_f32 v[76:77], v[76:77], v[226:227] op_sel_hi:[1,0]
    v_pk_mul_f32 v[78:79], v[78:79], v[226:227] op_sel_hi:[1,0]
    v_cvt_pk_bf16_f32 v140, v72, v73
    v_cvt_pk_bf16_f32 v141, v74, v75
    v_cvt_pk_bf16_f32 v142, v76, v77
    v_cvt_pk_bf16_f32 v143, v78, v79
    buffer_store_dwordx4 v[140:143], v251, s[20:23], s37 offen offset:2560 sc1
    s_add_u32 s37, s37, 4096
    v_pk_mul_f32 v[16:17], v[16:17], v[224:225] op_sel_hi:[1,0]
    v_pk_mul_f32 v[18:19], v[18:19], v[224:225] op_sel_hi:[1,0]
    v_pk_mul_f32 v[20:21], v[20:21], v[224:225] op_sel_hi:[1,0]
    v_pk_mul_f32 v[22:23], v[22:23], v[224:225] op_sel_hi:[1,0]
    v_cvt_pk_bf16_f32 v144, v16, v17
    v_cvt_pk_bf16_f32 v145, v18, v19
    v_cvt_pk_bf16_f32 v146, v20, v21
    v_cvt_pk_bf16_f32 v147, v22, v23
    buffer_store_dwordx4 v[144:147], v251, s[20:23], s37 offen offset:0 sc1
    v_pk_mul_f32 v[24:25], v[24:25], v[224:225] op_sel_hi:[1,0]
    v_pk_mul_f32 v[26:27], v[26:27], v[224:225] op_sel_hi:[1,0]
    v_pk_mul_f32 v[28:29], v[28:29], v[224:225] op_sel_hi:[1,0]
    v_pk_mul_f32 v[30:31], v[30:31], v[224:225] op_sel_hi:[1,0]
    v_cvt_pk_bf16_f32 v148, v24, v25
    v_cvt_pk_bf16_f32 v149, v26, v27
    v_cvt_pk_bf16_f32 v150, v28, v29
    v_cvt_pk_bf16_f32 v151, v30, v31
    buffer_store_dwordx4 v[148:151], v251, s[20:23], s37 offen offset:512 sc1
    v_pk_mul_f32 v[80:81], v[80:81], v[226:227] op_sel_hi:[1,0]
    v_pk_mul_f32 v[82:83], v[82:83], v[226:227] op_sel_hi:[1,0]
    v_pk_mul_f32 v[84:85], v[84:85], v[226:227] op_sel_hi:[1,0]
    v_pk_mul_f32 v[86:87], v[86:87], v[226:227] op_sel_hi:[1,0]
    v_cvt_pk_bf16_f32 v152, v80, v81
    v_cvt_pk_bf16_f32 v153, v82, v83
    v_cvt_pk_bf16_f32 v154, v84, v85
    v_cvt_pk_bf16_f32 v155, v86, v87
    buffer_store_dwordx4 v[152:155], v251, s[20:23], s37 offen offset:2048 sc1
    v_pk_mul_f32 v[88:89], v[88:89], v[226:227] op_sel_hi:[1,0]
    v_pk_mul_f32 v[90:91], v[90:91], v[226:227] op_sel_hi:[1,0]
    v_pk_mul_f32 v[92:93], v[92:93], v[226:227] op_sel_hi:[1,0]
    v_pk_mul_f32 v[94:95], v[94:95], v[226:227] op_sel_hi:[1,0]
    v_cvt_pk_bf16_f32 v156, v88, v89
    v_cvt_pk_bf16_f32 v157, v90, v91
    v_cvt_pk_bf16_f32 v158, v92, v93
    v_cvt_pk_bf16_f32 v159, v94, v95
    buffer_store_dwordx4 v[156:159], v251, s[20:23], s37 offen offset:2560 sc1
    s_add_u32 s37, s37, 4096
    v_pk_mul_f32 v[32:33], v[32:33], v[224:225] op_sel_hi:[1,0]
    v_pk_mul_f32 v[34:35], v[34:35], v[224:225] op_sel_hi:[1,0]
    v_pk_mul_f32 v[36:37], v[36:37], v[224:225] op_sel_hi:[1,0]
    v_pk_mul_f32 v[38:39], v[38:39], v[224:225] op_sel_hi:[1,0]
    v_cvt_pk_bf16_f32 v128, v32, v33
    v_cvt_pk_bf16_f32 v129, v34, v35
    v_cvt_pk_bf16_f32 v130, v36, v37
    v_cvt_pk_bf16_f32 v131, v38, v39
    buffer_store_dwordx4 v[128:131], v251, s[20:23], s37 offen offset:0 sc1
    v_pk_mul_f32 v[40:41], v[40:41], v[224:225] op_sel_hi:[1,0]
    v_pk_mul_f32 v[42:43], v[42:43], v[224:225] op_sel_hi:[1,0]
    v_pk_mul_f32 v[44:45], v[44:45], v[224:225] op_sel_hi:[1,0]
    v_pk_mul_f32 v[46:47], v[46:47], v[224:225] op_sel_hi:[1,0]
    v_cvt_pk_bf16_f32 v132, v40, v41
    v_cvt_pk_bf16_f32 v133, v42, v43
    v_cvt_pk_bf16_f32 v134, v44, v45
    v_cvt_pk_bf16_f32 v135, v46, v47
    buffer_store_dwordx4 v[132:135], v251, s[20:23], s37 offen offset:512 sc1
    v_pk_mul_f32 v[96:97], v[96:97], v[226:227] op_sel_hi:[1,0]
    v_pk_mul_f32 v[98:99], v[98:99], v[226:227] op_sel_hi:[1,0]
    v_pk_mul_f32 v[100:101], v[100:101], v[226:227] op_sel_hi:[1,0]
    v_pk_mul_f32 v[102:103], v[102:103], v[226:227] op_sel_hi:[1,0]
    v_cvt_pk_bf16_f32 v136, v96, v97
    v_cvt_pk_bf16_f32 v137, v98, v99
    v_cvt_pk_bf16_f32 v138, v100, v101
    v_cvt_pk_bf16_f32 v139, v102, v103
    buffer_store_dwordx4 v[136:139], v251, s[20:23], s37 offen offset:2048 sc1
    v_pk_mul_f32 v[104:105], v[104:105], v[226:227] op_sel_hi:[1,0]
    v_pk_mul_f32 v[106:107], v[106:107], v[226:227] op_sel_hi:[1,0]
    v_pk_mul_f32 v[108:109], v[108:109], v[226:227] op_sel_hi:[1,0]
    v_pk_mul_f32 v[110:111], v[110:111], v[226:227] op_sel_hi:[1,0]
    v_cvt_pk_bf16_f32 v140, v104, v105
    v_cvt_pk_bf16_f32 v141, v106, v107
    v_cvt_pk_bf16_f32 v142, v108, v109
    v_cvt_pk_bf16_f32 v143, v110, v111
    buffer_store_dwordx4 v[140:143], v251, s[20:23], s37 offen offset:2560 sc1
    s_add_u32 s37, s37, 4096
    v_pk_mul_f32 v[48:49], v[48:49], v[224:225] op_sel_hi:[1,0]
    v_pk_mul_f32 v[50:51], v[50:51], v[224:225] op_sel_hi:[1,0]
    v_pk_mul_f32 v[52:53], v[52:53], v[224:225] op_sel_hi:[1,0]
    v_pk_mul_f32 v[54:55], v[54:55], v[224:225] op_sel_hi:[1,0]
    v_cvt_pk_bf16_f32 v144, v48, v49
    v_cvt_pk_bf16_f32 v145, v50, v51
    v_cvt_pk_bf16_f32 v146, v52, v53
    v_cvt_pk_bf16_f32 v147, v54, v55
    buffer_store_dwordx4 v[144:147], v251, s[20:23], s37 offen offset:0 sc1
    v_pk_mul_f32 v[56:57], v[56:57], v[224:225] op_sel_hi:[1,0]
    v_pk_mul_f32 v[58:59], v[58:59], v[224:225] op_sel_hi:[1,0]
    v_pk_mul_f32 v[60:61], v[60:61], v[224:225] op_sel_hi:[1,0]
    v_pk_mul_f32 v[62:63], v[62:63], v[224:225] op_sel_hi:[1,0]
    v_cvt_pk_bf16_f32 v148, v56, v57
    v_cvt_pk_bf16_f32 v149, v58, v59
    v_cvt_pk_bf16_f32 v150, v60, v61
    v_cvt_pk_bf16_f32 v151, v62, v63
    buffer_store_dwordx4 v[148:151], v251, s[20:23], s37 offen offset:512 sc1
    v_pk_mul_f32 v[112:113], v[112:113], v[226:227] op_sel_hi:[1,0]
    v_pk_mul_f32 v[114:115], v[114:115], v[226:227] op_sel_hi:[1,0]
    v_pk_mul_f32 v[116:117], v[116:117], v[226:227] op_sel_hi:[1,0]
    v_pk_mul_f32 v[118:119], v[118:119], v[226:227] op_sel_hi:[1,0]
    v_cvt_pk_bf16_f32 v152, v112, v113
    v_cvt_pk_bf16_f32 v153, v114, v115
    v_cvt_pk_bf16_f32 v154, v116, v117
    v_cvt_pk_bf16_f32 v155, v118, v119
    buffer_store_dwordx4 v[152:155], v251, s[20:23], s37 offen offset:2048 sc1
    v_pk_mul_f32 v[120:121], v[120:121], v[226:227] op_sel_hi:[1,0]
    v_pk_mul_f32 v[122:123], v[122:123], v[226:227] op_sel_hi:[1,0]
    v_pk_mul_f32 v[124:125], v[124:125], v[226:227] op_sel_hi:[1,0]
    v_pk_mul_f32 v[126:127], v[126:127], v[226:227] op_sel_hi:[1,0]
    v_cvt_pk_bf16_f32 v156, v120, v121
    v_cvt_pk_bf16_f32 v157, v122, v123
    v_cvt_pk_bf16_f32 v158, v124, v125
    v_cvt_pk_bf16_f32 v159, v126, v127
    buffer_store_dwordx4 v[156:159], v251, s[20:23], s37 offen offset:2560 sc1
    s_mov_b32 s38, 0x5f800000
    v_cmp_lt_f32 vcc, v208, s38
    s_nop 1
    v_cndmask_b32 v224, 1, 0, vcc
    v_cmp_lt_f32 vcc, v210, s38
    s_nop 1
    v_cndmask_b32 v224, 1, v224, vcc
    v_cmp_ne_u32 vcc, 0, v224
    s_nop 0
    s_cmp_lg_u64 vcc, 0
    s_cselect_b32 s38, 1, 0
    s_lshl_b32 s37, s28, 2
    s_add_u32 s37, s37, 129536
    v_mov_b32 v224, s37
    v_mov_b32 v225, s38
    ds_write_b32 v224, v225
    v_mov_b32 v226, 129536
    s_waitcnt lgkmcnt(0)
    s_barrier
    ds_read_b128 v[228:231], v226
    s_waitcnt lgkmcnt(0)
    v_or_b32 v224, v228, v229
    v_or3_b32 v224, v224, v230, v231
    s_nop 0
    v_readfirstlane_b32 s38, v224
    s_nop 0
    s_cmp_eq_u32 s38, 0
    s_cbranch_scc1 attn_kernel_end_1
    s_cmp_lg_u32 s36, 0
    s_cbranch_scc1 attn_kernel_end_1
    s_mov_b32 s36, 1
    s_waitcnt vmcnt(0) lgkmcnt(0)
    s_mov_b32 s31, 0
    s_mov_b32 s33, 16
    s_mov_b32 m0, s39
    v_mov_b32 v224, 0xff800000
    v_mov_b32 v226, 0xff800000
    v_mov_b32 v247, v243
    v_mov_b32 v248, v244
attn_kernel_mx_8:
    s_barrier
    buffer_load_dwordx4 v232, s[44:47], s31 offen offset:0 lds
    buffer_load_dwordx4 v233, s[44:47], s31 offen offset:1088 lds
    s_add_u32 s31, s31, 8192
    s_waitcnt vmcnt(0)
    s_barrier
    ds_read_b128 a[64:67], v247 offset:0
    ds_read_b128 a[68:71], v248 offset:0
    ds_read_b128 a[72:75], v247 offset:64
    ds_read_b128 a[76:79], v248 offset:64
    ds_read_b128 a[80:83], v247 offset:128
    ds_read_b128 a[84:87], v248 offset:128
    ds_read_b128 a[88:91], v247 offset:192
    ds_read_b128 a[92:95], v248 offset:192
    s_waitcnt lgkmcnt(0)
    v_mfma_f32_32x32x16_bf16 v[128:143], a[64:67], a[0:3], 0
    v_mfma_f32_32x32x16_bf16 v[128:143], a[68:71], a[4:7], v[128:143]
    v_mfma_f32_32x32x16_bf16 v[128:143], a[72:75], a[8:11], v[128:143]
    v_mfma_f32_32x32x16_bf16 v[128:143], a[76:79], a[12:15], v[128:143]
    v_mfma_f32_32x32x16_bf16 v[128:143], a[80:83], a[16:19], v[128:143]
    v_mfma_f32_32x32x16_bf16 v[128:143], a[84:87], a[20:23], v[128:143]
    v_mfma_f32_32x32x16_bf16 v[128:143], a[88:91], a[24:27], v[128:143]
    v_mfma_f32_32x32x16_bf16 v[128:143], a[92:95], a[28:31], v[128:143]
    v_mfma_f32_32x32x16_bf16 v[144:159], a[64:67], a[32:35], 0
    v_mfma_f32_32x32x16_bf16 v[144:159], a[68:71], a[36:39], v[144:159]
    v_mfma_f32_32x32x16_bf16 v[144:159], a[72:75], a[40:43], v[144:159]
    v_mfma_f32_32x32x16_bf16 v[144:159], a[76:79], a[44:47], v[144:159]
    v_mfma_f32_32x32x16_bf16 v[144:159], a[80:83], a[48:51], v[144:159]
    v_mfma_f32_32x32x16_bf16 v[144:159], a[84:87], a[52:55], v[144:159]
    v_mfma_f32_32x32x16_bf16 v[144:159], a[88:91], a[56:59], v[144:159]
    v_mfma_f32_32x32x16_bf16 v[144:159], a[92:95], a[60:63], v[144:159]
    s_nop 3
    v_max3_f32 v224, v224, v128, v129
    v_max3_f32 v224, v224, v130, v131
    v_max3_f32 v224, v224, v132, v133
    v_max3_f32 v224, v224, v134, v135
    v_max3_f32 v224, v224, v136, v137
    v_max3_f32 v224, v224, v138, v139
    v_max3_f32 v224, v224, v140, v141
    v_max3_f32 v224, v224, v142, v143
    v_max3_f32 v226, v226, v144, v145
    v_max3_f32 v226, v226, v146, v147
    v_max3_f32 v226, v226, v148, v149
    v_max3_f32 v226, v226, v150, v151
    v_max3_f32 v226, v226, v152, v153
    v_max3_f32 v226, v226, v154, v155
    v_max3_f32 v226, v226, v156, v157
    v_max3_f32 v226, v226, v158, v159
    s_sub_u32 s33, s33, 1
    s_cmp_lg_u32 s33, 0
    s_cbranch_scc1 attn_kernel_mx_8
    v_mov_b32 v225, v224
    s_nop 1
    v_permlane32_swap_b32 v224, v225
    v_max_f32 v224, v224, v225
    v_sub_f32 v253, 0, v224
    v_mov_b32 v227, v226
    s_nop 1
    v_permlane32_swap_b32 v226, v227
    v_max_f32 v226, v226, v227
    v_sub_f32 v254, 0, v226
    s_barrier
    s_mov_b32 s31, 0
    s_mov_b32 s29, 0
    s_mov_b32 s30, 0
    s_add_u32 m0, s29, s39
    s_nop 0
    buffer_load_dwordx4 v232, s[44:47], s31 offen offset:0 lds
    buffer_load_dwordx4 v233, s[44:47], s31 offen offset:1088 lds
    buffer_load_dwordx4 v234, s[48:51], s31 offen offset:2176 lds
    buffer_load_dwordx4 v235, s[48:51], s31 offen offset:3264 lds
    s_add_u32 s29, s29, 17920
    s_cmp_ge_u32 s29, 125440
    s_cselect_b32 s37, 125440, 0
    s_sub_u32 s29, s29, s37
    s_add_u32 s31, s31, s40
    s_add_u32 m0, s29, s39
    s_nop 0
    buffer_load_dwordx4 v232, s[44:47], s31 offen offset:0 lds
    buffer_load_dwordx4 v233, s[44:47], s31 offen offset:1088 lds
    buffer_load_dwordx4 v234, s[48:51], s31 offen offset:2176 lds
    buffer_load_dwordx4 v235, s[48:51], s31 offen offset:3264 lds
    s_add_u32 s29, s29, 17920
    s_cmp_ge_u32 s29, 125440
    s_cselect_b32 s37, 125440, 0
    s_sub_u32 s29, s29, s37
    s_add_u32 s31, s31, s40
    s_add_u32 m0, s29, s39
    s_nop 0
    buffer_load_dwordx4 v232, s[44:47], s31 offen offset:0 lds
    buffer_load_dwordx4 v233, s[44:47], s31 offen offset:1088 lds
    buffer_load_dwordx4 v234, s[48:51], s31 offen offset:2176 lds
    buffer_load_dwordx4 v235, s[48:51], s31 offen offset:3264 lds
    s_add_u32 s29, s29, 17920
    s_cmp_ge_u32 s29, 125440
    s_cselect_b32 s37, 125440, 0
    s_sub_u32 s29, s29, s37
    s_add_u32 s31, s31, s40
    s_add_u32 m0, s29, s39
    s_nop 0
    buffer_load_dwordx4 v232, s[44:47], s31 offen offset:0 lds
    buffer_load_dwordx4 v233, s[44:47], s31 offen offset:1088 lds
    buffer_load_dwordx4 v234, s[48:51], s31 offen offset:2176 lds
    buffer_load_dwordx4 v235, s[48:51], s31 offen offset:3264 lds
    s_add_u32 s29, s29, 17920
    s_cmp_ge_u32 s29, 125440
    s_cselect_b32 s37, 125440, 0
    s_sub_u32 s29, s29, s37
    s_add_u32 s31, s31, s40
    s_add_u32 m0, s29, s39
    s_nop 0
    buffer_load_dwordx4 v232, s[44:47], s31 offen offset:0 lds
    buffer_load_dwordx4 v233, s[44:47], s31 offen offset:1088 lds
    buffer_load_dwordx4 v234, s[48:51], s31 offen offset:2176 lds
    buffer_load_dwordx4 v235, s[48:51], s31 offen offset:3264 lds
    s_add_u32 s29, s29, 17920
    s_cmp_ge_u32 s29, 125440
    s_cselect_b32 s37, 125440, 0
    s_sub_u32 s29, s29, s37
    s_add_u32 s31, s31, s40
    s_add_u32 m0, s29, s39
    s_nop 0
    buffer_load_dwordx4 v232, s[44:47], s31 offen offset:0 lds
    buffer_load_dwordx4 v233, s[44:47], s31 offen offset:1088 lds
    buffer_load_dwordx4 v234, s[48:51], s31 offen offset:2176 lds
    buffer_load_dwordx4 v235, s[48:51], s31 offen offset:3264 lds
    s_add_u32 s29, s29, 17920
    s_cmp_ge_u32 s29, 125440
    s_cselect_b32 s37, 125440, 0
    s_sub_u32 s29, s29, s37
    s_add_u32 s31, s31, s40
    s_waitcnt vmcnt(0)
    s_barrier
    v_add_u32 v247, s30, v243
    v_add_u32 v248, s30, v244
    v_add_u32 v249, s30, v245
    ds_read_b128 a[64:67], v247 offset:0
    ds_read_b128 a[68:71], v248 offset:0
    ds_read_b128 a[72:75], v247 offset:64
    ds_read_b128 a[76:79], v248 offset:64
    ds_read_b128 a[80:83], v247 offset:128
    ds_read_b128 a[84:87], v248 offset:128
    ds_read_b128 a[88:91], v247 offset:192
    ds_read_b128 a[92:95], v248 offset:192
    s_mov_b32 s42, s30
    s_add_u32 s42, s42, 17920
    s_cmp_ge_u32 s42, 125440
    s_cselect_b32 s38, 125440, 0
    s_sub_u32 s42, s42, s38
    s_cmp_lg_u32 s36, 0
    s_cselect_b64 s[52:53], -1, 0
    s_waitcnt lgkmcnt(7)
    v_mfma_f32_32x32x16_bf16 v[128:143], a[64:67], a[0:3], 0
    ds_read_b64_tr_b16 a[96:97], v249 offset:0
    ds_read_b64_tr_b16 a[98:99], v249 offset:512
    v_add_u32 v247, s42, v243
    v_add_u32 v248, s42, v244
    s_waitcnt lgkmcnt(8)
    v_mfma_f32_32x32x16_bf16 v[128:143], a[68:71], a[4:7], v[128:143]
    ds_read_b64_tr_b16 a[100:101], v249 offset:64
    ds_read_b64_tr_b16 a[102:103], v249 offset:576
    s_waitcnt lgkmcnt(9)
    v_mfma_f32_32x32x16_bf16 v[128:143], a[72:75], a[8:11], v[128:143]
    ds_read_b64_tr_b16 a[104:105], v249 offset:128
    ds_read_b64_tr_b16 a[106:107], v249 offset:640
    s_waitcnt lgkmcnt(10)
    v_mfma_f32_32x32x16_bf16 v[128:143], a[76:79], a[12:15], v[128:143]
    ds_read_b64_tr_b16 a[108:109], v249 offset:192
    ds_read_b64_tr_b16 a[110:111], v249 offset:704
    s_waitcnt lgkmcnt(11)
    v_mfma_f32_32x32x16_bf16 v[128:143], a[80:83], a[16:19], v[128:143]
    ds_read_b64_tr_b16 a[112:113], v249 offset:8960
    ds_read_b64_tr_b16 a[114:115], v249 offset:9472
    s_waitcnt lgkmcnt(12)
    v_mfma_f32_32x32x16_bf16 v[128:143], a[84:87], a[20:23], v[128:143]
    ds_read_b64_tr_b16 a[116:117], v249 offset:9024
    ds_read_b64_tr_b16 a[118:119], v249 offset:9536
    s_waitcnt lgkmcnt(13)
    v_mfma_f32_32x32x16_bf16 v[128:143], a[88:91], a[24:27], v[128:143]
    ds_read_b64_tr_b16 a[120:121], v249 offset:9088
    ds_read_b64_tr_b16 a[122:123], v249 offset:9600
    s_waitcnt lgkmcnt(14)
    v_mfma_f32_32x32x16_bf16 v[128:143], a[92:95], a[28:31], v[128:143]
    ds_read_b64_tr_b16 a[124:125], v249 offset:9152
    ds_read_b64_tr_b16 a[126:127], v249 offset:9664
    v_mfma_f32_32x32x16_bf16 v[144:159], a[64:67], a[32:35], 0
    ds_read_b128 a[64:67], v247 offset:0
    v_mov_b32 v208, 0
    v_mov_b32 v209, 0
    v_mov_b32 v210, 0
    v_mov_b32 v211, 0
    v_mfma_f32_32x32x16_bf16 v[144:159], a[68:71], a[36:39], v[144:159]
    ds_read_b128 a[68:71], v248 offset:0
    v_mfma_f32_32x32x16_bf16 v[144:159], a[72:75], a[40:43], v[144:159]
    ds_read_b128 a[72:75], v247 offset:64
    v_max3_f32 v228, v128, v129, v130
    v_max3_f32 v229, v131, v132, v133
    v_max3_f32 v228, v228, v134, v135
    v_max3_f32 v229, v229, v136, v137
    v_max3_f32 v228, v228, v138, v139
    v_max3_f32 v229, v229, v140, v141
    v_max3_f32 v228, v228, v142, v143
    v_max_f32 v228, v228, v229
    v_mfma_f32_32x32x16_bf16 v[144:159], a[76:79], a[44:47], v[144:159]
    ds_read_b128 a[76:79], v248 offset:64
    v_mov_b32 v229, v228
    s_nop 1
    v_permlane32_swap_b32 v228, v229
    v_max_f32 v228, v228, v229
    v_sub_f32 v228, 0xc2200000, v228
    v_cndmask_b32 v228, v228, v253, s[52:53]
    v_add_f32 v128, v128, v228
    v_add_f32 v129, v129, v228
    v_mfma_f32_32x32x16_bf16 v[144:159], a[80:83], a[48:51], v[144:159]
    ds_read_b128 a[80:83], v247 offset:128
    v_add_f32 v130, v130, v228
    v_add_f32 v131, v131, v228
    v_add_f32 v132, v132, v228
    v_add_f32 v133, v133, v228
    v_add_f32 v134, v134, v228
    v_add_f32 v135, v135, v228
    v_add_f32 v136, v136, v228
    v_add_f32 v137, v137, v228
    v_mfma_f32_32x32x16_bf16 v[144:159], a[84:87], a[52:55], v[144:159]
    ds_read_b128 a[84:87], v248 offset:128
    v_add_f32 v138, v138, v228
    v_add_f32 v139, v139, v228
    v_add_f32 v140, v140, v228
    v_add_f32 v141, v141, v228
    v_add_f32 v142, v142, v228
    v_add_f32 v143, v143, v228
    v_exp_f32 v128, v128
    v_mfma_f32_32x32x16_bf16 v[144:159], a[88:91], a[56:59], v[144:159]
    ds_read_b128 a[88:91], v247 offset:192
    v_exp_f32 v129, v129
    v_exp_f32 v130, v130
    v_exp_f32 v131, v131
    v_cvt_pk_bf16_f32 v192, v128, v129
    v_mfma_f32_32x32x16_bf16 v[144:159], a[92:95], a[60:63], v[144:159]
    ds_read_b128 a[92:95], v248 offset:192
    v_add_f32 v208, v208, v128
    v_add_f32 v209, v209, v129
    v_exp_f32 v132, v132
    v_exp_f32 v133, v133
    v_cvt_pk_bf16_f32 v193, v130, v131
    v_add_f32 v208, v208, v130
    v_add_f32 v209, v209, v131
    v_exp_f32 v134, v134
    v_exp_f32 v135, v135
    v_cvt_pk_bf16_f32 v194, v132, v133
    v_add_f32 v208, v208, v132
    v_add_f32 v209, v209, v133
    v_exp_f32 v136, v136
    v_exp_f32 v137, v137
    v_cvt_pk_bf16_f32 v195, v134, v135
    v_add_f32 v208, v208, v134
    v_add_f32 v209, v209, v135
    v_exp_f32 v138, v138
    v_exp_f32 v139, v139
    v_cvt_pk_bf16_f32 v196, v136, v137
    v_add_f32 v208, v208, v136
    v_add_f32 v209, v209, v137
    v_exp_f32 v140, v140
    v_exp_f32 v141, v141
    v_cvt_pk_bf16_f32 v197, v138, v139
    v_add_f32 v208, v208, v138
    v_add_f32 v209, v209, v139
    v_exp_f32 v142, v142
    v_exp_f32 v143, v143
    v_cvt_pk_bf16_f32 v198, v140, v141
    v_add_f32 v208, v208, v140
    v_add_f32 v209, v209, v141
    v_cvt_pk_bf16_f32 v199, v142, v143
    v_add_f32 v208, v208, v142
    v_add_f32 v209, v209, v143
    s_mov_b32 s33, 2
    s_waitcnt vmcnt(0) lgkmcnt(0)
    s_branch attn_kernel_ent_5
attn_kernel_redo_20:
    s_mov_b32 s54, 1
    s_mov_b32 s55, -1
    s_waitcnt vmcnt(0) lgkmcnt(0)
    s_barrier
attn_kernel_next_21:
    s_add_u32 s55, s55, 1
    s_mov_b32 s18, s55
    s_lshl_b32 s16, s35, 4
    s_add_u32 s16, s16, s55
    s_sub_u32 s16, s16, 40
    s_cmp_ge_u32 s55, 40
    s_cselect_b32 s17, 1, 0
    s_cmp_lt_u32 s55, 56
    s_cbranch_scc1 attn_kernel_prod_12
    s_mov_b32 s54, 2
    s_branch attn_kernel_post_16
attn_kernel_end_1:
    s_endpgm
.globl oproj_kernel
.p2align 8
.type oproj_kernel,@function
oproj_kernel:
    s_cmp_ge_u32 s2, 256
    s_cbranch_scc1 oproj_kernel_end_1
    s_load_dwordx2 s[4:5], s[0:1], 112
    s_load_dwordx2 s[16:17], s[0:1], 0
    s_load_dwordx2 s[36:37], s[0:1], 48
    v_lshrrev_b32 v120, 6, v0
    v_and_b32 v121, 63, v0
    v_readfirstlane_b32 s44, v120
    s_and_b32 s52, s2, 7
    s_lshr_b32 s53, s2, 3
    s_lshr_b32 s46, s52, 1
    s_lshl_b32 s46, s46, 3
    s_and_b32 s54, s53, 7
    s_add_u32 s46, s46, s54
    s_and_b32 s47, s52, 1
    s_lshl_b32 s47, s47, 2
    s_lshr_b32 s54, s53, 3
    s_add_u32 s47, s47, s54
    s_cmp_lt_u32 s44, 4
    s_cbranch_scc1 oproj_kernel_comp_3
    s_sub_u32 s44, s44, 4
    s_mul_i32 s50, s44, 2560
    v_lshlrev_b32 v11, 4, v121
    v_add_u32 v8, s50, v11
    s_mul_i32 s52, s47, 655360
    s_add_u32 s52, s52, 44040192
    s_mov_b32 s48, 0
    s_waitcnt lgkmcnt(0)
    s_add_u32 s8, s4, s52
    s_addc_u32 s9, s5, 0
    s_mov_b32 s10, 655360
    s_mov_b32 s11, 0x00020000
    s_mov_b32 m0, s50
    s_nop 0
    buffer_load_dwordx4 v8, s[8:11], s48 offen offset:0 lds
    buffer_load_dwordx4 v8, s[8:11], s48 offen offset:1024 lds
    s_mov_b64 exec, 0xffffffff
    buffer_load_dwordx4 v8, s[8:11], s48 offen offset:2048 lds
    s_mov_b64 exec, -1
    s_add_u32 s48, s48, 20480
    s_add_u32 m0, s50, 20480
    s_nop 0
    buffer_load_dwordx4 v8, s[8:11], s48 offen offset:0 lds
    buffer_load_dwordx4 v8, s[8:11], s48 offen offset:1024 lds
    s_mov_b64 exec, 0xffffffff
    buffer_load_dwordx4 v8, s[8:11], s48 offen offset:2048 lds
    s_mov_b64 exec, -1
    s_add_u32 s48, s48, 20480
    s_add_u32 m0, s50, 40960
    s_nop 0
    buffer_load_dwordx4 v8, s[8:11], s48 offen offset:0 lds
    buffer_load_dwordx4 v8, s[8:11], s48 offen offset:1024 lds
    s_mov_b64 exec, 0xffffffff
    buffer_load_dwordx4 v8, s[8:11], s48 offen offset:2048 lds
    s_mov_b64 exec, -1
    s_add_u32 s48, s48, 20480
    s_add_u32 m0, s50, 61440
    s_nop 0
    buffer_load_dwordx4 v8, s[8:11], s48 offen offset:0 lds
    buffer_load_dwordx4 v8, s[8:11], s48 offen offset:1024 lds
    s_mov_b64 exec, 0xffffffff
    buffer_load_dwordx4 v8, s[8:11], s48 offen offset:2048 lds
    s_mov_b64 exec, -1
    s_add_u32 s48, s48, 20480
    v_subrev_u32 v164, 256, v0
    s_mov_b32 s20, s4
    s_mov_b32 s21, s5
    s_mov_b32 s22, 15360
    s_mov_b32 s23, 0x00020000
    s_mul_i32 s53, s47, 320
    s_add_u32 s53, s53, 5120
    s_lshl_b32 s55, s44, 10
    s_mul_i32 s54, s46, 81920
    s_mul_i32 s52, s47, 160
    s_add_u32 s54, s54, s52
    s_add_u32 s16, s16, s54
    s_addc_u32 s17, s17, 0
    s_mov_b32 s18, 80800
    s_mov_b32 s19, 0x00020000
    v_mul_u32_u24 v165, 6554, v164
    v_lshrrev_b32 v165, 16, v165
    v_mul_u32_u24 v165, 1120, v165
    v_lshl_add_u32 v9, v164, 4, v165
    v_add_u32 v166, 512, v164
    v_mul_u32_u24 v165, 6554, v166
    v_lshrrev_b32 v165, 16, v165
    v_mul_u32_u24 v165, 1120, v165
    v_lshl_add_u32 v10, v166, 4, v165
    v_add_u32 v165, 4800, v11
    v_cmp_gt_u32 vcc, 20, v121
    s_nop 1
    v_cndmask_b32 v11, v165, v11, vcc
    s_add_u32 m0, s55, 122880
    s_nop 0
    buffer_load_dwordx4 v9, s[16:19], 0 offen lds
    s_add_u32 m0, s55, 131072
    s_nop 0
    buffer_load_dwordx4 v10, s[16:19], 0 offen lds
    s_mov_b32 m0, 139264
    s_nop 0
    buffer_load_dwordx4 v11, s[20:23], s53 offen lds
    s_lshr_b32 s53, s2, 3
    s_mul_i32 s52, s53, 37
    s_lshr_b32 s52, s52, 8
    s_mul_i32 s54, s52, 7
    s_sub_u32 s53, s53, s54
    s_and_b32 s54, s2, 1
    s_mul_i32 s54, s54, 7
    s_add_u32 s53, s53, s54
    s_and_b32 s54, s2, 6
    s_lshl_b32 s54, s54, 1
    s_add_u32 s52, s52, s54
    s_mul_i32 s54, s52, 40
    s_mul_i32 s55, s44, 5
    s_add_u32 s54, s54, s55
    s_min_u32 s54, s54, 635
    s_lshl_b32 s55, s54, 2
    s_add_u32 s55, s55, 7680
    s_load_dwordx4 s[60:63], s[4:5], s55
    s_load_dword s64, s[4:5], s55 offset:16
    s_load_dwordx4 s[68:71], s[4:5], s55 offset:2560
    s_load_dword s72, s[4:5], s55 offset:2576
    s_cmp_lt_u32 s2, 224
    s_cselect_b32 s38, 2211840, 0
    s_mov_b32 s39, 0x00020000
    s_cselect_b32 s42, 1024, 0
    s_mov_b32 s43, 0x00020000
    s_mul_i32 s52, s52, 14336
    s_lshl_b32 s55, s53, 10
    s_add_u32 s52, s52, s55
    s_add_u32 s52, s52, 34603008
    s_add_u32 s40, s4, s52
    s_addc_u32 s41, s5, 0
    s_mul_i32 s54, s54, 3456
    s_lshl_b32 s53, s53, 8
    s_add_u32 s54, s54, s53
    v_lshlrev_b32 v165, 2, v121
    s_waitcnt vmcnt(12)
    s_barrier
    s_waitcnt vmcnt(9)
    s_barrier
    s_add_u32 m0, s50, 81920
    s_nop 0
    buffer_load_dwordx4 v8, s[8:11], s48 offen offset:0 lds
    buffer_load_dwordx4 v8, s[8:11], s48 offen offset:1024 lds
    s_mov_b64 exec, 0xffffffff
    buffer_load_dwordx4 v8, s[8:11], s48 offen offset:2048 lds
    s_mov_b64 exec, -1
    s_add_u32 s48, s48, 20480
    s_waitcnt vmcnt(9)
    s_barrier
    s_mov_b32 m0, s50
    s_nop 0
    buffer_load_dwordx4 v8, s[8:11], s48 offen offset:0 lds
    buffer_load_dwordx4 v8, s[8:11], s48 offen offset:1024 lds
    s_mov_b64 exec, 0xffffffff
    buffer_load_dwordx4 v8, s[8:11], s48 offen offset:2048 lds
    s_mov_b64 exec, -1
    s_add_u32 s48, s48, 20480
    s_waitcnt vmcnt(9)
    s_barrier
    s_add_u32 m0, s50, 20480
    s_nop 0
    buffer_load_dwordx4 v8, s[8:11], s48 offen offset:0 lds
    buffer_load_dwordx4 v8, s[8:11], s48 offen offset:1024 lds
    s_mov_b64 exec, 0xffffffff
    buffer_load_dwordx4 v8, s[8:11], s48 offen offset:2048 lds
    s_mov_b64 exec, -1
    s_add_u32 s48, s48, 20480
    s_waitcnt vmcnt(6)
    s_barrier
    s_add_u32 m0, s50, 40960
    s_nop 0
    buffer_load_dwordx4 v8, s[8:11], s48 offen offset:0 lds
    buffer_load_dwordx4 v8, s[8:11], s48 offen offset:1024 lds
    s_mov_b64 exec, 0xffffffff
    buffer_load_dwordx4 v8, s[8:11], s48 offen offset:2048 lds
    s_mov_b64 exec, -1
    s_add_u32 s48, s48, 20480
    s_waitcnt vmcnt(6)
    s_barrier
    s_add_u32 m0, s50, 61440
    s_nop 0
    buffer_load_dwordx4 v8, s[8:11], s48 offen offset:0 lds
    buffer_load_dwordx4 v8, s[8:11], s48 offen offset:1024 lds
    s_mov_b64 exec, 0xffffffff
    buffer_load_dwordx4 v8, s[8:11], s48 offen offset:2048 lds
    s_mov_b64 exec, -1
    s_add_u32 s48, s48, 20480
    s_waitcnt vmcnt(6)
    s_barrier
    s_add_u32 m0, s50, 81920
    s_nop 0
    buffer_load_dwordx4 v8, s[8:11], s48 offen offset:0 lds
    buffer_load_dwordx4 v8, s[8:11], s48 offen offset:1024 lds
    s_mov_b64 exec, 0xffffffff
    buffer_load_dwordx4 v8, s[8:11], s48 offen offset:2048 lds
    s_mov_b64 exec, -1
    s_add_u32 s48, s48, 20480
    s_waitcnt vmcnt(6)
    s_barrier
    s_mov_b32 m0, s50
    s_nop 0
    buffer_load_dwordx4 v8, s[8:11], s48 offen offset:0 lds
    buffer_load_dwordx4 v8, s[8:11], s48 offen offset:1024 lds
    s_mov_b64 exec, 0xffffffff
    buffer_load_dwordx4 v8, s[8:11], s48 offen offset:2048 lds
    s_mov_b64 exec, -1
    s_add_u32 s48, s48, 20480
    s_waitcnt vmcnt(6)
    s_barrier
    s_add_u32 m0, s50, 20480
    s_nop 0
    buffer_load_dwordx4 v8, s[8:11], s48 offen offset:0 lds
    buffer_load_dwordx4 v8, s[8:11], s48 offen offset:1024 lds
    s_mov_b64 exec, 0xffffffff
    buffer_load_dwordx4 v8, s[8:11], s48 offen offset:2048 lds
    s_mov_b64 exec, -1
    s_add_u32 s48, s48, 20480
    s_waitcnt vmcnt(6)
    s_barrier
    s_add_u32 m0, s50, 40960
    s_nop 0
    buffer_load_dwordx4 v8, s[8:11], s48 offen offset:0 lds
    buffer_load_dwordx4 v8, s[8:11], s48 offen offset:1024 lds
    s_mov_b64 exec, 0xffffffff
    buffer_load_dwordx4 v8, s[8:11], s48 offen offset:2048 lds
    s_mov_b64 exec, -1
    s_add_u32 s48, s48, 20480
    s_waitcnt vmcnt(6)
    s_barrier
    s_add_u32 m0, s50, 61440
    s_nop 0
    buffer_load_dwordx4 v8, s[8:11], s48 offen offset:0 lds
    buffer_load_dwordx4 v8, s[8:11], s48 offen offset:1024 lds
    s_mov_b64 exec, 0xffffffff
    buffer_load_dwordx4 v8, s[8:11], s48 offen offset:2048 lds
    s_mov_b64 exec, -1
    s_add_u32 s48, s48, 20480
    s_waitcnt vmcnt(6)
    s_barrier
    s_add_u32 m0, s50, 81920
    s_nop 0
    buffer_load_dwordx4 v8, s[8:11], s48 offen offset:0 lds
    buffer_load_dwordx4 v8, s[8:11], s48 offen offset:1024 lds
    s_mov_b64 exec, 0xffffffff
    buffer_load_dwordx4 v8, s[8:11], s48 offen offset:2048 lds
    s_mov_b64 exec, -1
    s_add_u32 s48, s48, 20480
    s_waitcnt vmcnt(6)
    s_barrier
    s_mov_b32 m0, s50
    s_nop 0
    buffer_load_dwordx4 v8, s[8:11], s48 offen offset:0 lds
    buffer_load_dwordx4 v8, s[8:11], s48 offen offset:1024 lds
    s_mov_b64 exec, 0xffffffff
    buffer_load_dwordx4 v8, s[8:11], s48 offen offset:2048 lds
    s_mov_b64 exec, -1
    s_add_u32 s48, s48, 20480
    s_waitcnt vmcnt(6)
    s_barrier
    s_add_u32 m0, s50, 20480
    s_nop 0
    buffer_load_dwordx4 v8, s[8:11], s48 offen offset:0 lds
    buffer_load_dwordx4 v8, s[8:11], s48 offen offset:1024 lds
    s_mov_b64 exec, 0xffffffff
    buffer_load_dwordx4 v8, s[8:11], s48 offen offset:2048 lds
    s_mov_b64 exec, -1
    s_add_u32 s48, s48, 20480
    s_waitcnt vmcnt(6)
    s_barrier
    s_add_u32 m0, s50, 40960
    s_nop 0
    buffer_load_dwordx4 v8, s[8:11], s48 offen offset:0 lds
    buffer_load_dwordx4 v8, s[8:11], s48 offen offset:1024 lds
    s_mov_b64 exec, 0xffffffff
    buffer_load_dwordx4 v8, s[8:11], s48 offen offset:2048 lds
    s_mov_b64 exec, -1
    s_add_u32 s48, s48, 20480
    s_waitcnt vmcnt(6)
    s_barrier
    s_add_u32 m0, s50, 61440
    s_nop 0
    buffer_load_dwordx4 v8, s[8:11], s48 offen offset:0 lds
    buffer_load_dwordx4 v8, s[8:11], s48 offen offset:1024 lds
    s_mov_b64 exec, 0xffffffff
    buffer_load_dwordx4 v8, s[8:11], s48 offen offset:2048 lds
    s_mov_b64 exec, -1
    s_add_u32 s48, s48, 20480
    s_waitcnt vmcnt(6)
    s_barrier
    s_add_u32 m0, s50, 81920
    s_nop 0
    buffer_load_dwordx4 v8, s[8:11], s48 offen offset:0 lds
    buffer_load_dwordx4 v8, s[8:11], s48 offen offset:1024 lds
    s_mov_b64 exec, 0xffffffff
    buffer_load_dwordx4 v8, s[8:11], s48 offen offset:2048 lds
    s_mov_b64 exec, -1
    s_add_u32 s48, s48, 20480
    s_waitcnt vmcnt(6)
    s_barrier
    s_mov_b32 m0, s50
    s_nop 0
    buffer_load_dwordx4 v8, s[8:11], s48 offen offset:0 lds
    buffer_load_dwordx4 v8, s[8:11], s48 offen offset:1024 lds
    s_mov_b64 exec, 0xffffffff
    buffer_load_dwordx4 v8, s[8:11], s48 offen offset:2048 lds
    s_mov_b64 exec, -1
    s_add_u32 s48, s48, 20480
    s_waitcnt vmcnt(6)
    s_barrier
    s_add_u32 m0, s50, 20480
    s_nop 0
    buffer_load_dwordx4 v8, s[8:11], s48 offen offset:0 lds
    buffer_load_dwordx4 v8, s[8:11], s48 offen offset:1024 lds
    s_mov_b64 exec, 0xffffffff
    buffer_load_dwordx4 v8, s[8:11], s48 offen offset:2048 lds
    s_mov_b64 exec, -1
    s_add_u32 s48, s48, 20480
    s_waitcnt vmcnt(6)
    s_barrier
    s_add_u32 m0, s50, 40960
    s_nop 0
    buffer_load_dwordx4 v8, s[8:11], s48 offen offset:0 lds
    buffer_load_dwordx4 v8, s[8:11], s48 offen offset:1024 lds
    s_mov_b64 exec, 0xffffffff
    buffer_load_dwordx4 v8, s[8:11], s48 offen offset:2048 lds
    s_mov_b64 exec, -1
    s_add_u32 s48, s48, 20480
    s_waitcnt vmcnt(6)
    s_barrier
    s_add_u32 m0, s50, 61440
    s_nop 0
    buffer_load_dwordx4 v8, s[8:11], s48 offen offset:0 lds
    buffer_load_dwordx4 v8, s[8:11], s48 offen offset:1024 lds
    s_mov_b64 exec, 0xffffffff
    buffer_load_dwordx4 v8, s[8:11], s48 offen offset:2048 lds
    s_mov_b64 exec, -1
    s_add_u32 s48, s48, 20480
    s_waitcnt vmcnt(6)
    s_barrier
    s_add_u32 m0, s50, 81920
    s_nop 0
    buffer_load_dwordx4 v8, s[8:11], s48 offen offset:0 lds
    buffer_load_dwordx4 v8, s[8:11], s48 offen offset:1024 lds
    s_mov_b64 exec, 0xffffffff
    buffer_load_dwordx4 v8, s[8:11], s48 offen offset:2048 lds
    s_mov_b64 exec, -1
    s_add_u32 s48, s48, 20480
    s_waitcnt vmcnt(6)
    s_barrier
    s_mov_b32 m0, s50
    s_nop 0
    buffer_load_dwordx4 v8, s[8:11], s48 offen offset:0 lds
    buffer_load_dwordx4 v8, s[8:11], s48 offen offset:1024 lds
    s_mov_b64 exec, 0xffffffff
    buffer_load_dwordx4 v8, s[8:11], s48 offen offset:2048 lds
    s_mov_b64 exec, -1
    s_add_u32 s48, s48, 20480
    s_waitcnt vmcnt(6)
    s_barrier
    s_add_u32 m0, s50, 20480
    s_nop 0
    buffer_load_dwordx4 v8, s[8:11], s48 offen offset:0 lds
    buffer_load_dwordx4 v8, s[8:11], s48 offen offset:1024 lds
    s_mov_b64 exec, 0xffffffff
    buffer_load_dwordx4 v8, s[8:11], s48 offen offset:2048 lds
    s_mov_b64 exec, -1
    s_add_u32 s48, s48, 20480
    s_waitcnt vmcnt(6)
    s_barrier
    s_add_u32 m0, s50, 40960
    s_nop 0
    buffer_load_dwordx4 v8, s[8:11], s48 offen offset:0 lds
    buffer_load_dwordx4 v8, s[8:11], s48 offen offset:1024 lds
    s_mov_b64 exec, 0xffffffff
    buffer_load_dwordx4 v8, s[8:11], s48 offen offset:2048 lds
    s_mov_b64 exec, -1
    s_add_u32 s48, s48, 20480
    s_waitcnt vmcnt(6)
    s_barrier
    s_add_u32 m0, s50, 61440
    s_nop 0
    buffer_load_dwordx4 v8, s[8:11], s48 offen offset:0 lds
    buffer_load_dwordx4 v8, s[8:11], s48 offen offset:1024 lds
    s_mov_b64 exec, 0xffffffff
    buffer_load_dwordx4 v8, s[8:11], s48 offen offset:2048 lds
    s_mov_b64 exec, -1
    s_add_u32 s48, s48, 20480
    s_waitcnt vmcnt(6)
    s_barrier
    s_add_u32 m0, s50, 81920
    s_nop 0
    buffer_load_dwordx4 v8, s[8:11], s48 offen offset:0 lds
    buffer_load_dwordx4 v8, s[8:11], s48 offen offset:1024 lds
    s_mov_b64 exec, 0xffffffff
    buffer_load_dwordx4 v8, s[8:11], s48 offen offset:2048 lds
    s_mov_b64 exec, -1
    s_add_u32 s48, s48, 20480
    s_waitcnt vmcnt(6)
    s_barrier
    s_mov_b32 m0, s50
    s_nop 0
    buffer_load_dwordx4 v8, s[8:11], s48 offen offset:0 lds
    buffer_load_dwordx4 v8, s[8:11], s48 offen offset:1024 lds
    s_mov_b64 exec, 0xffffffff
    buffer_load_dwordx4 v8, s[8:11], s48 offen offset:2048 lds
    s_mov_b64 exec, -1
    s_add_u32 s48, s48, 20480
    s_waitcnt vmcnt(6)
    s_barrier
    s_add_u32 m0, s50, 20480
    s_nop 0
    buffer_load_dwordx4 v8, s[8:11], s48 offen offset:0 lds
    buffer_load_dwordx4 v8, s[8:11], s48 offen offset:1024 lds
    s_mov_b64 exec, 0xffffffff
    buffer_load_dwordx4 v8, s[8:11], s48 offen offset:2048 lds
    s_mov_b64 exec, -1
    s_add_u32 s48, s48, 20480
    buffer_load_dword v16, v165, s[36:39], s54 offen
    s_add_u32 s54, s54, 3456
    buffer_load_dword v17, v165, s[36:39], s54 offen
    s_add_u32 s54, s54, 3456
    buffer_load_dword v18, v165, s[36:39], s54 offen
    s_add_u32 s54, s54, 3456
    buffer_load_dword v19, v165, s[36:39], s54 offen
    s_add_u32 s54, s54, 3456
    buffer_load_dword v20, v165, s[36:39], s54 offen
    s_waitcnt vmcnt(11)
    s_barrier
    s_waitcnt vmcnt(8)
    s_barrier
    s_waitcnt vmcnt(4)
    v_lshlrev_b32 v165, 16, v16
    v_and_b32 v166, 0xffff0000, v16
    s_waitcnt lgkmcnt(0)
    v_mul_f32 v60, s68, v165
    v_mul_f32 v61, s60, v165
    v_mul_f32 v62, s68, v166
    v_mul_f32 v63, s60, v166
    s_waitcnt vmcnt(3)
    v_lshlrev_b32 v165, 16, v17
    v_and_b32 v166, 0xffff0000, v17
    v_fmac_f32 v60, s69, v165
    v_fmac_f32 v61, s61, v165
    v_fmac_f32 v62, s69, v166
    v_fmac_f32 v63, s61, v166
    s_waitcnt vmcnt(2)
    v_lshlrev_b32 v165, 16, v18
    v_and_b32 v166, 0xffff0000, v18
    v_fmac_f32 v60, s70, v165
    v_fmac_f32 v61, s62, v165
    v_fmac_f32 v62, s70, v166
    v_fmac_f32 v63, s62, v166
    s_waitcnt vmcnt(1)
    v_lshlrev_b32 v165, 16, v19
    v_and_b32 v166, 0xffff0000, v19
    v_fmac_f32 v60, s71, v165
    v_fmac_f32 v61, s63, v165
    v_fmac_f32 v62, s71, v166
    v_fmac_f32 v63, s63, v166
    s_waitcnt vmcnt(0)
    v_lshlrev_b32 v165, 16, v20
    v_and_b32 v166, 0xffff0000, v20
    v_fmac_f32 v60, s72, v165
    v_fmac_f32 v61, s64, v165
    v_fmac_f32 v62, s72, v166
    v_fmac_f32 v63, s64, v166
    v_lshlrev_b32 v165, 4, v164
    v_add_u32 v165, 141312, v165
    ds_write_b128 v165, v[60:63]
    v_lshlrev_b32 v166, 2, v164
    v_add_u32 v165, 141312, v166
    s_waitcnt lgkmcnt(0)
    s_barrier
    ds_read_b32 v60, v165 offset:0
    ds_read_b32 v61, v165 offset:1024
    ds_read_b32 v62, v165 offset:2048
    ds_read_b32 v63, v165 offset:3072
    ds_read_b32 v64, v165 offset:4096
    ds_read_b32 v65, v165 offset:5120
    ds_read_b32 v66, v165 offset:6144
    ds_read_b32 v67, v165 offset:7168
    s_waitcnt lgkmcnt(3)
    v_add_f32 v60, v60, v64
    s_waitcnt lgkmcnt(2)
    v_add_f32 v61, v61, v65
    s_waitcnt lgkmcnt(1)
    v_add_f32 v62, v62, v66
    s_waitcnt lgkmcnt(0)
    v_add_f32 v63, v63, v67
    v_add_f32 v60, v60, v62
    v_add_f32 v61, v61, v63
    v_add_f32 v60, v60, v61
    buffer_store_dword v60, v166, s[40:43], 0 offen
    s_endpgm
oproj_kernel_comp_3:
    v_mov_b32 v164, v0
    v_lshrrev_b32 v165, 1, v120
    v_and_b32 v166, 1, v120
    v_lshlrev_b32 v165, 11, v165
    v_lshl_add_u32 v165, v121, 4, v165
    v_mul_u32_u24 v167, 9216, v166
    v_add_u32 v160, v165, v167
    v_xor_b32 v161, 1024, v160
    s_mul_i32 s52, s46, 524288
    s_add_u32 s52, s52, 4194304
    s_mov_b32 s49, 0
    s_mov_b32 s45, 4096
    s_waitcnt lgkmcnt(0)
    s_add_u32 s12, s4, s52
    s_addc_u32 s13, s5, 0
    s_mov_b32 s14, 524288
    s_mov_b32 s15, 0x00020000
    buffer_load_dwordx4 v[40:43], v160, s[12:15], s49 offen
    buffer_load_dwordx4 v[44:47], v161, s[12:15], s49 offen
    s_add_u32 s49, s49, 16384
    buffer_load_dwordx4 v[48:51], v160, s[12:15], s45 offen
    buffer_load_dwordx4 v[52:55], v161, s[12:15], s45 offen
    s_add_u32 s45, s45, 16384
    buffer_load_dwordx4 v[56:59], v160, s[12:15], s49 offen
    buffer_load_dwordx4 v[60:63], v161, s[12:15], s49 offen
    s_add_u32 s49, s49, 16384
    buffer_load_dwordx4 v[64:67], v160, s[12:15], s45 offen
    buffer_load_dwordx4 v[68:71], v161, s[12:15], s45 offen
    s_add_u32 s45, s45, 16384
    buffer_load_dwordx4 v[72:75], v160, s[12:15], s49 offen
    buffer_load_dwordx4 v[76:79], v161, s[12:15], s49 offen
    s_add_u32 s49, s49, 16384
    buffer_load_dwordx4 v[80:83], v160, s[12:15], s45 offen
    buffer_load_dwordx4 v[84:87], v161, s[12:15], s45 offen
    s_add_u32 s45, s45, 16384
    buffer_load_dwordx4 v[88:91], v160, s[12:15], s49 offen
    buffer_load_dwordx4 v[92:95], v161, s[12:15], s49 offen
    s_add_u32 s49, s49, 16384
    buffer_load_dwordx4 v[96:99], v160, s[12:15], s45 offen
    buffer_load_dwordx4 v[100:103], v161, s[12:15], s45 offen
    s_add_u32 s45, s45, 16384
    v_lshrrev_b32 v122, 4, v121
    v_bfe_u32 v123, v121, 2, 2
    v_and_b32 v124, 3, v121
    v_lshrrev_b32 v165, 1, v122
    v_lshlrev_b32 v165, 4, v165
    v_and_b32 v167, 1, v122
    v_lshl_add_u32 v165, v167, 2, v165
    v_add_u32 v165, v165, v123
    v_lshl_add_u32 v166, v166, 6, v165
    v_mul_u32_u24 v166, 160, v166
    v_lshl_add_u32 v162, v124, 3, v166
    v_add_u32 v163, 61440, v162
    s_lshl_b32 s52, s46, 3
    s_add_u32 s52, s52, s47
    s_mul_i32 s52, s52, 10240
    s_add_u32 s52, s52, 27262976
    s_add_u32 s28, s4, s52
    s_addc_u32 s29, s5, 0
    s_mov_b32 s30, 10240
    s_mov_b32 s31, 0x00020000
    s_mul_i32 s52, s46, 81920
    s_add_u32 s52, s52, 20971520
    s_add_u32 s24, s4, s52
    s_addc_u32 s25, s5, 0
    s_mov_b32 s26, 81920
    s_mov_b32 s27, 0x00020000
    s_lshl_b32 s52, s47, 14
    s_lshl_b32 s53, s46, 9
    s_add_u32 s52, s52, s53
    s_add_u32 s52, s52, 30408704
    s_add_u32 s32, s4, s52
    s_addc_u32 s33, s5, 0
    s_mov_b32 s34, 512
    s_mov_b32 s35, 0x00020000
    s_mul_i32 s52, s47, 5
    s_add_u32 s53, s52, 0
    s_lshr_b32 s54, s53, 1
    s_lshl_b32 s54, s54, 12
    s_and_b32 s53, s53, 1
    s_lshl_b32 s53, s53, 3
    s_add_u32 s60, s53, s54
    s_add_u32 s53, s52, 1
    s_lshr_b32 s54, s53, 1
    s_lshl_b32 s54, s54, 12
    s_and_b32 s53, s53, 1
    s_lshl_b32 s53, s53, 3
    s_add_u32 s61, s53, s54
    s_add_u32 s53, s52, 2
    s_lshr_b32 s54, s53, 1
    s_lshl_b32 s54, s54, 12
    s_and_b32 s53, s53, 1
    s_lshl_b32 s53, s53, 3
    s_add_u32 s62, s53, s54
    s_add_u32 s53, s52, 3
    s_lshr_b32 s54, s53, 1
    s_lshl_b32 s54, s54, 12
    s_and_b32 s53, s53, 1
    s_lshl_b32 s53, s53, 3
    s_add_u32 s63, s53, s54
    s_add_u32 s53, s52, 4
    s_lshr_b32 s54, s53, 1
    s_lshl_b32 s54, s54, 12
    s_and_b32 s53, s53, 1
    s_lshl_b32 s53, s53, 3
    s_add_u32 s64, s53, s54
    s_barrier
    ds_read_b64_tr_b16 v[120:121], v162 offset:0
    ds_read_b64_tr_b16 v[122:123], v162 offset:1280
    ds_read_b64_tr_b16 v[124:125], v162 offset:32
    ds_read_b64_tr_b16 v[126:127], v162 offset:1312
    ds_read_b64_tr_b16 v[128:129], v162 offset:64
    ds_read_b64_tr_b16 v[130:131], v162 offset:1344
    ds_read_b64_tr_b16 v[132:133], v162 offset:96
    ds_read_b64_tr_b16 v[134:135], v162 offset:1376
    ds_read_b64_tr_b16 v[136:137], v162 offset:128
    ds_read_b64_tr_b16 v[138:139], v162 offset:1408
    ds_read_b64_tr_b16 v[140:141], v162 offset:5120
    ds_read_b64_tr_b16 v[142:143], v162 offset:6400
    ds_read_b64_tr_b16 v[144:145], v162 offset:5152
    ds_read_b64_tr_b16 v[146:147], v162 offset:6432
    ds_read_b64_tr_b16 v[148:149], v162 offset:5184
    ds_read_b64_tr_b16 v[150:151], v162 offset:6464
    ds_read_b64_tr_b16 v[152:153], v162 offset:5216
    ds_read_b64_tr_b16 v[154:155], v162 offset:6496
    ds_read_b64_tr_b16 v[156:157], v162 offset:5248
    ds_read_b64_tr_b16 v[158:159], v162 offset:6528
    s_barrier
    s_waitcnt vmcnt(15) lgkmcnt(14)
    v_mfma_f32_16x16x32_bf16 v[0:3], v[120:123], v[40:43], 0
    buffer_load_dwordx4 v[104:107], v160, s[12:15], s49 offen
    s_waitcnt vmcnt(15)
    v_mfma_f32_16x16x32_bf16 v[20:23], v[120:123], v[44:47], 0
    ds_read_b64_tr_b16 v[120:121], v162 offset:20480
    ds_read_b64_tr_b16 v[122:123], v162 offset:21760
    s_waitcnt lgkmcnt(14)
    v_mfma_f32_16x16x32_bf16 v[4:7], v[124:127], v[40:43], 0
    buffer_load_dwordx4 v[108:111], v161, s[12:15], s49 offen
    v_mfma_f32_16x16x32_bf16 v[24:27], v[124:127], v[44:47], 0
    ds_read_b64_tr_b16 v[124:125], v162 offset:20512
    ds_read_b64_tr_b16 v[126:127], v162 offset:21792
    s_waitcnt lgkmcnt(14)
    v_mfma_f32_16x16x32_bf16 v[8:11], v[128:131], v[40:43], 0
    s_add_u32 s49, s49, 16384
    v_mfma_f32_16x16x32_bf16 v[28:31], v[128:131], v[44:47], 0
    ds_read_b64_tr_b16 v[128:129], v162 offset:20544
    ds_read_b64_tr_b16 v[130:131], v162 offset:21824
    s_waitcnt lgkmcnt(14)
    v_mfma_f32_16x16x32_bf16 v[12:15], v[132:135], v[40:43], 0
    v_mfma_f32_16x16x32_bf16 v[32:35], v[132:135], v[44:47], 0
    ds_read_b64_tr_b16 v[132:133], v162 offset:20576
    ds_read_b64_tr_b16 v[134:135], v162 offset:21856
    s_waitcnt lgkmcnt(14)
    v_mfma_f32_16x16x32_bf16 v[16:19], v[136:139], v[40:43], 0
    buffer_load_dwordx4 v[112:115], v160, s[12:15], s45 offen
    v_mfma_f32_16x16x32_bf16 v[36:39], v[136:139], v[44:47], 0
    ds_read_b64_tr_b16 v[136:137], v162 offset:20608
    ds_read_b64_tr_b16 v[138:139], v162 offset:21888
    s_waitcnt vmcnt(16) lgkmcnt(14)
    v_mfma_f32_16x16x32_bf16 v[0:3], v[140:143], v[48:51], v[0:3]
    buffer_load_dwordx4 v[116:119], v161, s[12:15], s45 offen
    s_waitcnt vmcnt(16)
    v_mfma_f32_16x16x32_bf16 v[20:23], v[140:143], v[52:55], v[20:23]
    ds_read_b64_tr_b16 v[140:141], v162 offset:25600
    ds_read_b64_tr_b16 v[142:143], v162 offset:26880
    s_waitcnt lgkmcnt(14)
    v_mfma_f32_16x16x32_bf16 v[4:7], v[144:147], v[48:51], v[4:7]
    v_mfma_f32_16x16x32_bf16 v[24:27], v[144:147], v[52:55], v[24:27]
    ds_read_b64_tr_b16 v[144:145], v162 offset:25632
    ds_read_b64_tr_b16 v[146:147], v162 offset:26912
    s_waitcnt lgkmcnt(14)
    v_mfma_f32_16x16x32_bf16 v[8:11], v[148:151], v[48:51], v[8:11]
    s_add_u32 s45, s45, 16384
    v_mfma_f32_16x16x32_bf16 v[28:31], v[148:151], v[52:55], v[28:31]
    ds_read_b64_tr_b16 v[148:149], v162 offset:25664
    ds_read_b64_tr_b16 v[150:151], v162 offset:26944
    s_waitcnt lgkmcnt(14)
    v_mfma_f32_16x16x32_bf16 v[12:15], v[152:155], v[48:51], v[12:15]
    s_mov_b32 s51, 5
    v_mfma_f32_16x16x32_bf16 v[32:35], v[152:155], v[52:55], v[32:35]
    ds_read_b64_tr_b16 v[152:153], v162 offset:25696
    ds_read_b64_tr_b16 v[154:155], v162 offset:26976
    s_waitcnt lgkmcnt(14)
    v_mfma_f32_16x16x32_bf16 v[16:19], v[156:159], v[48:51], v[16:19]
    v_mfma_f32_16x16x32_bf16 v[36:39], v[156:159], v[52:55], v[36:39]
    ds_read_b64_tr_b16 v[156:157], v162 offset:25728
    ds_read_b64_tr_b16 v[158:159], v162 offset:27008
    s_barrier
    s_waitcnt vmcnt(15) lgkmcnt(14)
    v_mfma_f32_16x16x32_bf16 v[0:3], v[120:123], v[56:59], v[0:3]
    buffer_load_dwordx4 v[40:43], v160, s[12:15], s49 offen
    s_waitcnt vmcnt(15)
    v_mfma_f32_16x16x32_bf16 v[20:23], v[120:123], v[60:63], v[20:23]
    ds_read_b64_tr_b16 v[120:121], v162 offset:40960
    ds_read_b64_tr_b16 v[122:123], v162 offset:42240
    s_waitcnt lgkmcnt(14)
    v_mfma_f32_16x16x32_bf16 v[4:7], v[124:127], v[56:59], v[4:7]
    buffer_load_dwordx4 v[44:47], v161, s[12:15], s49 offen
    v_mfma_f32_16x16x32_bf16 v[24:27], v[124:127], v[60:63], v[24:27]
    ds_read_b64_tr_b16 v[124:125], v162 offset:40992
    ds_read_b64_tr_b16 v[126:127], v162 offset:42272
    s_waitcnt lgkmcnt(14)
    v_mfma_f32_16x16x32_bf16 v[8:11], v[128:131], v[56:59], v[8:11]
    v_mfma_f32_16x16x32_bf16 v[28:31], v[128:131], v[60:63], v[28:31]
    ds_read_b64_tr_b16 v[128:129], v162 offset:41024
    ds_read_b64_tr_b16 v[130:131], v162 offset:42304
    s_waitcnt lgkmcnt(14)
    v_mfma_f32_16x16x32_bf16 v[12:15], v[132:135], v[56:59], v[12:15]
    s_add_u32 s49, s49, 16384
    v_mfma_f32_16x16x32_bf16 v[32:35], v[132:135], v[60:63], v[32:35]
    ds_read_b64_tr_b16 v[132:133], v162 offset:41056
    ds_read_b64_tr_b16 v[134:135], v162 offset:42336
    s_waitcnt lgkmcnt(14)
    v_mfma_f32_16x16x32_bf16 v[16:19], v[136:139], v[56:59], v[16:19]
    v_mfma_f32_16x16x32_bf16 v[36:39], v[136:139], v[60:63], v[36:39]
    ds_read_b64_tr_b16 v[136:137], v162 offset:41088
    ds_read_b64_tr_b16 v[138:139], v162 offset:42368
    s_waitcnt vmcnt(15) lgkmcnt(14)
    v_mfma_f32_16x16x32_bf16 v[0:3], v[140:143], v[64:67], v[0:3]
    buffer_load_dwordx4 v[48:51], v160, s[12:15], s45 offen
    s_waitcnt vmcnt(15)
    v_mfma_f32_16x16x32_bf16 v[20:23], v[140:143], v[68:71], v[20:23]
    ds_read_b64_tr_b16 v[140:141], v162 offset:46080
    ds_read_b64_tr_b16 v[142:143], v162 offset:47360
    s_waitcnt lgkmcnt(14)
    v_mfma_f32_16x16x32_bf16 v[4:7], v[144:147], v[64:67], v[4:7]
    buffer_load_dwordx4 v[52:55], v161, s[12:15], s45 offen
    v_mfma_f32_16x16x32_bf16 v[24:27], v[144:147], v[68:71], v[24:27]
    ds_read_b64_tr_b16 v[144:145], v162 offset:46112
    ds_read_b64_tr_b16 v[146:147], v162 offset:47392
    s_waitcnt lgkmcnt(14)
    v_mfma_f32_16x16x32_bf16 v[8:11], v[148:151], v[64:67], v[8:11]
    v_mfma_f32_16x16x32_bf16 v[28:31], v[148:151], v[68:71], v[28:31]
    ds_read_b64_tr_b16 v[148:149], v162 offset:46144
    ds_read_b64_tr_b16 v[150:151], v162 offset:47424
    s_waitcnt lgkmcnt(14)
    v_mfma_f32_16x16x32_bf16 v[12:15], v[152:155], v[64:67], v[12:15]
    s_add_u32 s45, s45, 16384
    v_mfma_f32_16x16x32_bf16 v[32:35], v[152:155], v[68:71], v[32:35]
    ds_read_b64_tr_b16 v[152:153], v162 offset:46176
    ds_read_b64_tr_b16 v[154:155], v162 offset:47456
    s_waitcnt lgkmcnt(14)
    v_mfma_f32_16x16x32_bf16 v[16:19], v[156:159], v[64:67], v[16:19]
    v_mfma_f32_16x16x32_bf16 v[36:39], v[156:159], v[68:71], v[36:39]
    ds_read_b64_tr_b16 v[156:157], v162 offset:46208
    ds_read_b64_tr_b16 v[158:159], v162 offset:47488
    s_barrier
    s_waitcnt vmcnt(15) lgkmcnt(14)
    v_mfma_f32_16x16x32_bf16 v[0:3], v[120:123], v[72:75], v[0:3]
    buffer_load_dwordx4 v[56:59], v160, s[12:15], s49 offen
    s_waitcnt vmcnt(15)
    v_mfma_f32_16x16x32_bf16 v[20:23], v[120:123], v[76:79], v[20:23]
    ds_read_b64_tr_b16 v[120:121], v163 offset:0
    ds_read_b64_tr_b16 v[122:123], v163 offset:1280
    s_waitcnt lgkmcnt(14)
    v_mfma_f32_16x16x32_bf16 v[4:7], v[124:127], v[72:75], v[4:7]
    buffer_load_dwordx4 v[60:63], v161, s[12:15], s49 offen
    v_mfma_f32_16x16x32_bf16 v[24:27], v[124:127], v[76:79], v[24:27]
    ds_read_b64_tr_b16 v[124:125], v163 offset:32
    ds_read_b64_tr_b16 v[126:127], v163 offset:1312
    s_waitcnt lgkmcnt(14)
    v_mfma_f32_16x16x32_bf16 v[8:11], v[128:131], v[72:75], v[8:11]
    v_mfma_f32_16x16x32_bf16 v[28:31], v[128:131], v[76:79], v[28:31]
    ds_read_b64_tr_b16 v[128:129], v163 offset:64
    ds_read_b64_tr_b16 v[130:131], v163 offset:1344
    s_waitcnt lgkmcnt(14)
    v_mfma_f32_16x16x32_bf16 v[12:15], v[132:135], v[72:75], v[12:15]
    s_add_u32 s49, s49, 16384
    v_mfma_f32_16x16x32_bf16 v[32:35], v[132:135], v[76:79], v[32:35]
    ds_read_b64_tr_b16 v[132:133], v163 offset:96
    ds_read_b64_tr_b16 v[134:135], v163 offset:1376
    s_waitcnt lgkmcnt(14)
    v_mfma_f32_16x16x32_bf16 v[16:19], v[136:139], v[72:75], v[16:19]
    v_mfma_f32_16x16x32_bf16 v[36:39], v[136:139], v[76:79], v[36:39]
    ds_read_b64_tr_b16 v[136:137], v163 offset:128
    ds_read_b64_tr_b16 v[138:139], v163 offset:1408
    s_waitcnt vmcnt(15) lgkmcnt(14)
    v_mfma_f32_16x16x32_bf16 v[0:3], v[140:143], v[80:83], v[0:3]
    buffer_load_dwordx4 v[64:67], v160, s[12:15], s45 offen
    s_waitcnt vmcnt(15)
    v_mfma_f32_16x16x32_bf16 v[20:23], v[140:143], v[84:87], v[20:23]
    ds_read_b64_tr_b16 v[140:141], v163 offset:5120
    ds_read_b64_tr_b16 v[142:143], v163 offset:6400
    s_waitcnt lgkmcnt(14)
    v_mfma_f32_16x16x32_bf16 v[4:7], v[144:147], v[80:83], v[4:7]
    buffer_load_dwordx4 v[68:71], v161, s[12:15], s45 offen
    v_mfma_f32_16x16x32_bf16 v[24:27], v[144:147], v[84:87], v[24:27]
    ds_read_b64_tr_b16 v[144:145], v163 offset:5152
    ds_read_b64_tr_b16 v[146:147], v163 offset:6432
    s_waitcnt lgkmcnt(14)
    v_mfma_f32_16x16x32_bf16 v[8:11], v[148:151], v[80:83], v[8:11]
    v_mfma_f32_16x16x32_bf16 v[28:31], v[148:151], v[84:87], v[28:31]
    ds_read_b64_tr_b16 v[148:149], v163 offset:5184
    ds_read_b64_tr_b16 v[150:151], v163 offset:6464
    s_waitcnt lgkmcnt(14)
    v_mfma_f32_16x16x32_bf16 v[12:15], v[152:155], v[80:83], v[12:15]
    s_add_u32 s45, s45, 16384
    v_mfma_f32_16x16x32_bf16 v[32:35], v[152:155], v[84:87], v[32:35]
    ds_read_b64_tr_b16 v[152:153], v163 offset:5216
    ds_read_b64_tr_b16 v[154:155], v163 offset:6496
    s_waitcnt lgkmcnt(14)
    v_mfma_f32_16x16x32_bf16 v[16:19], v[156:159], v[80:83], v[16:19]
    v_mfma_f32_16x16x32_bf16 v[36:39], v[156:159], v[84:87], v[36:39]
    ds_read_b64_tr_b16 v[156:157], v163 offset:5248
    ds_read_b64_tr_b16 v[158:159], v163 offset:6528
oproj_kernel_loop_2:
    s_barrier
    s_waitcnt vmcnt(15) lgkmcnt(14)
    v_mfma_f32_16x16x32_bf16 v[0:3], v[120:123], v[88:91], v[0:3]
    buffer_load_dwordx4 v[72:75], v160, s[12:15], s49 offen
    s_waitcnt vmcnt(15)
    v_mfma_f32_16x16x32_bf16 v[20:23], v[120:123], v[92:95], v[20:23]
    ds_read_b64_tr_b16 v[120:121], v163 offset:20480
    ds_read_b64_tr_b16 v[122:123], v163 offset:21760
    s_waitcnt lgkmcnt(14)
    v_mfma_f32_16x16x32_bf16 v[4:7], v[124:127], v[88:91], v[4:7]
    buffer_load_dwordx4 v[76:79], v161, s[12:15], s49 offen
    v_mfma_f32_16x16x32_bf16 v[24:27], v[124:127], v[92:95], v[24:27]
    ds_read_b64_tr_b16 v[124:125], v163 offset:20512
    ds_read_b64_tr_b16 v[126:127], v163 offset:21792
    s_waitcnt lgkmcnt(14)
    v_mfma_f32_16x16x32_bf16 v[8:11], v[128:131], v[88:91], v[8:11]
    v_mfma_f32_16x16x32_bf16 v[28:31], v[128:131], v[92:95], v[28:31]
    ds_read_b64_tr_b16 v[128:129], v163 offset:20544
    ds_read_b64_tr_b16 v[130:131], v163 offset:21824
    s_waitcnt lgkmcnt(14)
    v_mfma_f32_16x16x32_bf16 v[12:15], v[132:135], v[88:91], v[12:15]
    s_add_u32 s49, s49, 16384
    v_mfma_f32_16x16x32_bf16 v[32:35], v[132:135], v[92:95], v[32:35]
    ds_read_b64_tr_b16 v[132:133], v163 offset:20576
    ds_read_b64_tr_b16 v[134:135], v163 offset:21856
    s_waitcnt lgkmcnt(14)
    v_mfma_f32_16x16x32_bf16 v[16:19], v[136:139], v[88:91], v[16:19]
    v_mfma_f32_16x16x32_bf16 v[36:39], v[136:139], v[92:95], v[36:39]
    ds_read_b64_tr_b16 v[136:137], v163 offset:20608
    ds_read_b64_tr_b16 v[138:139], v163 offset:21888
    s_waitcnt vmcnt(15) lgkmcnt(14)
    v_mfma_f32_16x16x32_bf16 v[0:3], v[140:143], v[96:99], v[0:3]
    buffer_load_dwordx4 v[80:83], v160, s[12:15], s45 offen
    s_waitcnt vmcnt(15)
    v_mfma_f32_16x16x32_bf16 v[20:23], v[140:143], v[100:103], v[20:23]
    ds_read_b64_tr_b16 v[140:141], v163 offset:25600
    ds_read_b64_tr_b16 v[142:143], v163 offset:26880
    s_waitcnt lgkmcnt(14)
    v_mfma_f32_16x16x32_bf16 v[4:7], v[144:147], v[96:99], v[4:7]
    buffer_load_dwordx4 v[84:87], v161, s[12:15], s45 offen
    v_mfma_f32_16x16x32_bf16 v[24:27], v[144:147], v[100:103], v[24:27]
    ds_read_b64_tr_b16 v[144:145], v163 offset:25632
    ds_read_b64_tr_b16 v[146:147], v163 offset:26912
    s_waitcnt lgkmcnt(14)
    v_mfma_f32_16x16x32_bf16 v[8:11], v[148:151], v[96:99], v[8:11]
    v_mfma_f32_16x16x32_bf16 v[28:31], v[148:151], v[100:103], v[28:31]
    ds_read_b64_tr_b16 v[148:149], v163 offset:25664
    ds_read_b64_tr_b16 v[150:151], v163 offset:26944
    s_waitcnt lgkmcnt(14)
    v_mfma_f32_16x16x32_bf16 v[12:15], v[152:155], v[96:99], v[12:15]
    s_add_u32 s45, s45, 16384
    v_mfma_f32_16x16x32_bf16 v[32:35], v[152:155], v[100:103], v[32:35]
    ds_read_b64_tr_b16 v[152:153], v163 offset:25696
    ds_read_b64_tr_b16 v[154:155], v163 offset:26976
    s_waitcnt lgkmcnt(14)
    v_mfma_f32_16x16x32_bf16 v[16:19], v[156:159], v[96:99], v[16:19]
    v_mfma_f32_16x16x32_bf16 v[36:39], v[156:159], v[100:103], v[36:39]
    ds_read_b64_tr_b16 v[156:157], v163 offset:25728
    ds_read_b64_tr_b16 v[158:159], v163 offset:27008
    s_barrier
    s_waitcnt vmcnt(15) lgkmcnt(14)
    v_mfma_f32_16x16x32_bf16 v[0:3], v[120:123], v[104:107], v[0:3]
    buffer_load_dwordx4 v[88:91], v160, s[12:15], s49 offen
    s_waitcnt vmcnt(15)
    v_mfma_f32_16x16x32_bf16 v[20:23], v[120:123], v[108:111], v[20:23]
    ds_read_b64_tr_b16 v[120:121], v162 offset:0
    ds_read_b64_tr_b16 v[122:123], v162 offset:1280
    s_waitcnt lgkmcnt(14)
    v_mfma_f32_16x16x32_bf16 v[4:7], v[124:127], v[104:107], v[4:7]
    buffer_load_dwordx4 v[92:95], v161, s[12:15], s49 offen
    v_mfma_f32_16x16x32_bf16 v[24:27], v[124:127], v[108:111], v[24:27]
    ds_read_b64_tr_b16 v[124:125], v162 offset:32
    ds_read_b64_tr_b16 v[126:127], v162 offset:1312
    s_waitcnt lgkmcnt(14)
    v_mfma_f32_16x16x32_bf16 v[8:11], v[128:131], v[104:107], v[8:11]
    v_mfma_f32_16x16x32_bf16 v[28:31], v[128:131], v[108:111], v[28:31]
    ds_read_b64_tr_b16 v[128:129], v162 offset:64
    ds_read_b64_tr_b16 v[130:131], v162 offset:1344
    s_waitcnt lgkmcnt(14)
    v_mfma_f32_16x16x32_bf16 v[12:15], v[132:135], v[104:107], v[12:15]
    s_add_u32 s49, s49, 16384
    v_mfma_f32_16x16x32_bf16 v[32:35], v[132:135], v[108:111], v[32:35]
    ds_read_b64_tr_b16 v[132:133], v162 offset:96
    ds_read_b64_tr_b16 v[134:135], v162 offset:1376
    s_waitcnt lgkmcnt(14)
    v_mfma_f32_16x16x32_bf16 v[16:19], v[136:139], v[104:107], v[16:19]
    v_mfma_f32_16x16x32_bf16 v[36:39], v[136:139], v[108:111], v[36:39]
    ds_read_b64_tr_b16 v[136:137], v162 offset:128
    ds_read_b64_tr_b16 v[138:139], v162 offset:1408
    s_waitcnt vmcnt(15) lgkmcnt(14)
    v_mfma_f32_16x16x32_bf16 v[0:3], v[140:143], v[112:115], v[0:3]
    buffer_load_dwordx4 v[96:99], v160, s[12:15], s45 offen
    s_waitcnt vmcnt(15)
    v_mfma_f32_16x16x32_bf16 v[20:23], v[140:143], v[116:119], v[20:23]
    ds_read_b64_tr_b16 v[140:141], v162 offset:5120
    ds_read_b64_tr_b16 v[142:143], v162 offset:6400
    s_waitcnt lgkmcnt(14)
    v_mfma_f32_16x16x32_bf16 v[4:7], v[144:147], v[112:115], v[4:7]
    buffer_load_dwordx4 v[100:103], v161, s[12:15], s45 offen
    v_mfma_f32_16x16x32_bf16 v[24:27], v[144:147], v[116:119], v[24:27]
    ds_read_b64_tr_b16 v[144:145], v162 offset:5152
    ds_read_b64_tr_b16 v[146:147], v162 offset:6432
    s_waitcnt lgkmcnt(14)
    v_mfma_f32_16x16x32_bf16 v[8:11], v[148:151], v[112:115], v[8:11]
    v_mfma_f32_16x16x32_bf16 v[28:31], v[148:151], v[116:119], v[28:31]
    ds_read_b64_tr_b16 v[148:149], v162 offset:5184
    ds_read_b64_tr_b16 v[150:151], v162 offset:6464
    s_waitcnt lgkmcnt(14)
    v_mfma_f32_16x16x32_bf16 v[12:15], v[152:155], v[112:115], v[12:15]
    s_add_u32 s45, s45, 16384
    v_mfma_f32_16x16x32_bf16 v[32:35], v[152:155], v[116:119], v[32:35]
    ds_read_b64_tr_b16 v[152:153], v162 offset:5216
    ds_read_b64_tr_b16 v[154:155], v162 offset:6496
    s_waitcnt lgkmcnt(14)
    v_mfma_f32_16x16x32_bf16 v[16:19], v[156:159], v[112:115], v[16:19]
    v_mfma_f32_16x16x32_bf16 v[36:39], v[156:159], v[116:119], v[36:39]
    ds_read_b64_tr_b16 v[156:157], v162 offset:5248
    ds_read_b64_tr_b16 v[158:159], v162 offset:6528
    s_barrier
    s_waitcnt vmcnt(15) lgkmcnt(14)
    v_mfma_f32_16x16x32_bf16 v[0:3], v[120:123], v[40:43], v[0:3]
    buffer_load_dwordx4 v[104:107], v160, s[12:15], s49 offen
    s_waitcnt vmcnt(15)
    v_mfma_f32_16x16x32_bf16 v[20:23], v[120:123], v[44:47], v[20:23]
    ds_read_b64_tr_b16 v[120:121], v162 offset:20480
    ds_read_b64_tr_b16 v[122:123], v162 offset:21760
    s_waitcnt lgkmcnt(14)
    v_mfma_f32_16x16x32_bf16 v[4:7], v[124:127], v[40:43], v[4:7]
    buffer_load_dwordx4 v[108:111], v161, s[12:15], s49 offen
    v_mfma_f32_16x16x32_bf16 v[24:27], v[124:127], v[44:47], v[24:27]
    ds_read_b64_tr_b16 v[124:125], v162 offset:20512
    ds_read_b64_tr_b16 v[126:127], v162 offset:21792
    s_waitcnt lgkmcnt(14)
    v_mfma_f32_16x16x32_bf16 v[8:11], v[128:131], v[40:43], v[8:11]
    v_mfma_f32_16x16x32_bf16 v[28:31], v[128:131], v[44:47], v[28:31]
    ds_read_b64_tr_b16 v[128:129], v162 offset:20544
    ds_read_b64_tr_b16 v[130:131], v162 offset:21824
    s_waitcnt lgkmcnt(14)
    v_mfma_f32_16x16x32_bf16 v[12:15], v[132:135], v[40:43], v[12:15]
    s_add_u32 s49, s49, 16384
    v_mfma_f32_16x16x32_bf16 v[32:35], v[132:135], v[44:47], v[32:35]
    ds_read_b64_tr_b16 v[132:133], v162 offset:20576
    ds_read_b64_tr_b16 v[134:135], v162 offset:21856
    s_waitcnt lgkmcnt(14)
    v_mfma_f32_16x16x32_bf16 v[16:19], v[136:139], v[40:43], v[16:19]
    v_mfma_f32_16x16x32_bf16 v[36:39], v[136:139], v[44:47], v[36:39]
    ds_read_b64_tr_b16 v[136:137], v162 offset:20608
    ds_read_b64_tr_b16 v[138:139], v162 offset:21888
    s_waitcnt vmcnt(15) lgkmcnt(14)
    v_mfma_f32_16x16x32_bf16 v[0:3], v[140:143], v[48:51], v[0:3]
    buffer_load_dwordx4 v[112:115], v160, s[12:15], s45 offen
    s_waitcnt vmcnt(15)
    v_mfma_f32_16x16x32_bf16 v[20:23], v[140:143], v[52:55], v[20:23]
    ds_read_b64_tr_b16 v[140:141], v162 offset:25600
    ds_read_b64_tr_b16 v[142:143], v162 offset:26880
    s_waitcnt lgkmcnt(14)
    v_mfma_f32_16x16x32_bf16 v[4:7], v[144:147], v[48:51], v[4:7]
    buffer_load_dwordx4 v[116:119], v161, s[12:15], s45 offen
    v_mfma_f32_16x16x32_bf16 v[24:27], v[144:147], v[52:55], v[24:27]
    ds_read_b64_tr_b16 v[144:145], v162 offset:25632
    ds_read_b64_tr_b16 v[146:147], v162 offset:26912
    s_waitcnt lgkmcnt(14)
    v_mfma_f32_16x16x32_bf16 v[8:11], v[148:151], v[48:51], v[8:11]
    v_mfma_f32_16x16x32_bf16 v[28:31], v[148:151], v[52:55], v[28:31]
    ds_read_b64_tr_b16 v[148:149], v162 offset:25664
    ds_read_b64_tr_b16 v[150:151], v162 offset:26944
    s_waitcnt lgkmcnt(14)
    v_mfma_f32_16x16x32_bf16 v[12:15], v[152:155], v[48:51], v[12:15]
    s_add_u32 s45, s45, 16384
    v_mfma_f32_16x16x32_bf16 v[32:35], v[152:155], v[52:55], v[32:35]
    ds_read_b64_tr_b16 v[152:153], v162 offset:25696
    ds_read_b64_tr_b16 v[154:155], v162 offset:26976
    s_waitcnt lgkmcnt(14)
    v_mfma_f32_16x16x32_bf16 v[16:19], v[156:159], v[48:51], v[16:19]
    v_mfma_f32_16x16x32_bf16 v[36:39], v[156:159], v[52:55], v[36:39]
    ds_read_b64_tr_b16 v[156:157], v162 offset:25728
    ds_read_b64_tr_b16 v[158:159], v162 offset:27008
    s_barrier
    s_waitcnt vmcnt(15) lgkmcnt(14)
    v_mfma_f32_16x16x32_bf16 v[0:3], v[120:123], v[56:59], v[0:3]
    buffer_load_dwordx4 v[40:43], v160, s[12:15], s49 offen
    s_waitcnt vmcnt(15)
    v_mfma_f32_16x16x32_bf16 v[20:23], v[120:123], v[60:63], v[20:23]
    ds_read_b64_tr_b16 v[120:121], v162 offset:40960
    ds_read_b64_tr_b16 v[122:123], v162 offset:42240
    s_waitcnt lgkmcnt(14)
    v_mfma_f32_16x16x32_bf16 v[4:7], v[124:127], v[56:59], v[4:7]
    buffer_load_dwordx4 v[44:47], v161, s[12:15], s49 offen
    v_mfma_f32_16x16x32_bf16 v[24:27], v[124:127], v[60:63], v[24:27]
    ds_read_b64_tr_b16 v[124:125], v162 offset:40992
    ds_read_b64_tr_b16 v[126:127], v162 offset:42272
    s_waitcnt lgkmcnt(14)
    v_mfma_f32_16x16x32_bf16 v[8:11], v[128:131], v[56:59], v[8:11]
    v_mfma_f32_16x16x32_bf16 v[28:31], v[128:131], v[60:63], v[28:31]
    ds_read_b64_tr_b16 v[128:129], v162 offset:41024
    ds_read_b64_tr_b16 v[130:131], v162 offset:42304
    s_waitcnt lgkmcnt(14)
    v_mfma_f32_16x16x32_bf16 v[12:15], v[132:135], v[56:59], v[12:15]
    s_add_u32 s49, s49, 16384
    v_mfma_f32_16x16x32_bf16 v[32:35], v[132:135], v[60:63], v[32:35]
    ds_read_b64_tr_b16 v[132:133], v162 offset:41056
    ds_read_b64_tr_b16 v[134:135], v162 offset:42336
    s_waitcnt lgkmcnt(14)
    v_mfma_f32_16x16x32_bf16 v[16:19], v[136:139], v[56:59], v[16:19]
    v_mfma_f32_16x16x32_bf16 v[36:39], v[136:139], v[60:63], v[36:39]
    ds_read_b64_tr_b16 v[136:137], v162 offset:41088
    ds_read_b64_tr_b16 v[138:139], v162 offset:42368
    s_waitcnt vmcnt(15) lgkmcnt(14)
    v_mfma_f32_16x16x32_bf16 v[0:3], v[140:143], v[64:67], v[0:3]
    buffer_load_dwordx4 v[48:51], v160, s[12:15], s45 offen
    s_waitcnt vmcnt(15)
    v_mfma_f32_16x16x32_bf16 v[20:23], v[140:143], v[68:71], v[20:23]
    ds_read_b64_tr_b16 v[140:141], v162 offset:46080
    ds_read_b64_tr_b16 v[142:143], v162 offset:47360
    s_waitcnt lgkmcnt(14)
    v_mfma_f32_16x16x32_bf16 v[4:7], v[144:147], v[64:67], v[4:7]
    buffer_load_dwordx4 v[52:55], v161, s[12:15], s45 offen
    v_mfma_f32_16x16x32_bf16 v[24:27], v[144:147], v[68:71], v[24:27]
    ds_read_b64_tr_b16 v[144:145], v162 offset:46112
    ds_read_b64_tr_b16 v[146:147], v162 offset:47392
    s_waitcnt lgkmcnt(14)
    v_mfma_f32_16x16x32_bf16 v[8:11], v[148:151], v[64:67], v[8:11]
    v_mfma_f32_16x16x32_bf16 v[28:31], v[148:151], v[68:71], v[28:31]
    ds_read_b64_tr_b16 v[148:149], v162 offset:46144
    ds_read_b64_tr_b16 v[150:151], v162 offset:47424
    s_waitcnt lgkmcnt(14)
    v_mfma_f32_16x16x32_bf16 v[12:15], v[152:155], v[64:67], v[12:15]
    s_add_u32 s45, s45, 16384
    v_mfma_f32_16x16x32_bf16 v[32:35], v[152:155], v[68:71], v[32:35]
    ds_read_b64_tr_b16 v[152:153], v162 offset:46176
    ds_read_b64_tr_b16 v[154:155], v162 offset:47456
    s_waitcnt lgkmcnt(14)
    v_mfma_f32_16x16x32_bf16 v[16:19], v[156:159], v[64:67], v[16:19]
    v_mfma_f32_16x16x32_bf16 v[36:39], v[156:159], v[68:71], v[36:39]
    ds_read_b64_tr_b16 v[156:157], v162 offset:46208
    ds_read_b64_tr_b16 v[158:159], v162 offset:47488
    s_barrier
    s_waitcnt vmcnt(15) lgkmcnt(14)
    v_mfma_f32_16x16x32_bf16 v[0:3], v[120:123], v[72:75], v[0:3]
    buffer_load_dwordx4 v[56:59], v160, s[12:15], s49 offen
    s_waitcnt vmcnt(15)
    v_mfma_f32_16x16x32_bf16 v[20:23], v[120:123], v[76:79], v[20:23]
    ds_read_b64_tr_b16 v[120:121], v163 offset:0
    ds_read_b64_tr_b16 v[122:123], v163 offset:1280
    s_waitcnt lgkmcnt(14)
    v_mfma_f32_16x16x32_bf16 v[4:7], v[124:127], v[72:75], v[4:7]
    buffer_load_dwordx4 v[60:63], v161, s[12:15], s49 offen
    v_mfma_f32_16x16x32_bf16 v[24:27], v[124:127], v[76:79], v[24:27]
    ds_read_b64_tr_b16 v[124:125], v163 offset:32
    ds_read_b64_tr_b16 v[126:127], v163 offset:1312
    s_waitcnt lgkmcnt(14)
    v_mfma_f32_16x16x32_bf16 v[8:11], v[128:131], v[72:75], v[8:11]
    s_add_u32 s49, s49, 16384
    v_mfma_f32_16x16x32_bf16 v[28:31], v[128:131], v[76:79], v[28:31]
    ds_read_b64_tr_b16 v[128:129], v163 offset:64
    ds_read_b64_tr_b16 v[130:131], v163 offset:1344
    s_waitcnt lgkmcnt(14)
    v_mfma_f32_16x16x32_bf16 v[12:15], v[132:135], v[72:75], v[12:15]
    v_mfma_f32_16x16x32_bf16 v[32:35], v[132:135], v[76:79], v[32:35]
    ds_read_b64_tr_b16 v[132:133], v163 offset:96
    ds_read_b64_tr_b16 v[134:135], v163 offset:1376
    s_waitcnt lgkmcnt(14)
    v_mfma_f32_16x16x32_bf16 v[16:19], v[136:139], v[72:75], v[16:19]
    buffer_load_dwordx4 v[64:67], v160, s[12:15], s45 offen
    v_mfma_f32_16x16x32_bf16 v[36:39], v[136:139], v[76:79], v[36:39]
    ds_read_b64_tr_b16 v[136:137], v163 offset:128
    ds_read_b64_tr_b16 v[138:139], v163 offset:1408
    s_waitcnt vmcnt(16) lgkmcnt(14)
    v_mfma_f32_16x16x32_bf16 v[0:3], v[140:143], v[80:83], v[0:3]
    buffer_load_dwordx4 v[68:71], v161, s[12:15], s45 offen
    s_waitcnt vmcnt(16)
    v_mfma_f32_16x16x32_bf16 v[20:23], v[140:143], v[84:87], v[20:23]
    ds_read_b64_tr_b16 v[140:141], v163 offset:5120
    ds_read_b64_tr_b16 v[142:143], v163 offset:6400
    s_waitcnt lgkmcnt(14)
    v_mfma_f32_16x16x32_bf16 v[4:7], v[144:147], v[80:83], v[4:7]
    v_mfma_f32_16x16x32_bf16 v[24:27], v[144:147], v[84:87], v[24:27]
    ds_read_b64_tr_b16 v[144:145], v163 offset:5152
    ds_read_b64_tr_b16 v[146:147], v163 offset:6432
    s_waitcnt lgkmcnt(14)
    v_mfma_f32_16x16x32_bf16 v[8:11], v[148:151], v[80:83], v[8:11]
    s_add_u32 s45, s45, 16384
    v_mfma_f32_16x16x32_bf16 v[28:31], v[148:151], v[84:87], v[28:31]
    ds_read_b64_tr_b16 v[148:149], v163 offset:5184
    ds_read_b64_tr_b16 v[150:151], v163 offset:6464
    s_waitcnt lgkmcnt(14)
    v_mfma_f32_16x16x32_bf16 v[12:15], v[152:155], v[80:83], v[12:15]
    s_sub_u32 s51, s51, 1
    v_mfma_f32_16x16x32_bf16 v[32:35], v[152:155], v[84:87], v[32:35]
    ds_read_b64_tr_b16 v[152:153], v163 offset:5216
    ds_read_b64_tr_b16 v[154:155], v163 offset:6496
    s_waitcnt lgkmcnt(14)
    v_mfma_f32_16x16x32_bf16 v[16:19], v[156:159], v[80:83], v[16:19]
    v_mfma_f32_16x16x32_bf16 v[36:39], v[156:159], v[84:87], v[36:39]
    ds_read_b64_tr_b16 v[156:157], v163 offset:5248
    ds_read_b64_tr_b16 v[158:159], v163 offset:6528
    s_cmp_lg_u32 s51, 0
    s_cbranch_scc1 oproj_kernel_loop_2
    s_barrier
    s_waitcnt vmcnt(15) lgkmcnt(14)
    v_mfma_f32_16x16x32_bf16 v[0:3], v[120:123], v[88:91], v[0:3]
    s_waitcnt vmcnt(14)
    v_mfma_f32_16x16x32_bf16 v[20:23], v[120:123], v[92:95], v[20:23]
    ds_read_b64_tr_b16 v[120:121], v163 offset:20480
    ds_read_b64_tr_b16 v[122:123], v163 offset:21760
    s_waitcnt lgkmcnt(14)
    v_mfma_f32_16x16x32_bf16 v[4:7], v[124:127], v[88:91], v[4:7]
    v_mfma_f32_16x16x32_bf16 v[24:27], v[124:127], v[92:95], v[24:27]
    ds_read_b64_tr_b16 v[124:125], v163 offset:20512
    ds_read_b64_tr_b16 v[126:127], v163 offset:21792
    s_waitcnt lgkmcnt(14)
    v_mfma_f32_16x16x32_bf16 v[8:11], v[128:131], v[88:91], v[8:11]
    v_mfma_f32_16x16x32_bf16 v[28:31], v[128:131], v[92:95], v[28:31]
    ds_read_b64_tr_b16 v[128:129], v163 offset:20544
    ds_read_b64_tr_b16 v[130:131], v163 offset:21824
    s_waitcnt lgkmcnt(14)
    v_mfma_f32_16x16x32_bf16 v[12:15], v[132:135], v[88:91], v[12:15]
    v_mfma_f32_16x16x32_bf16 v[32:35], v[132:135], v[92:95], v[32:35]
    ds_read_b64_tr_b16 v[132:133], v163 offset:20576
    ds_read_b64_tr_b16 v[134:135], v163 offset:21856
    s_waitcnt lgkmcnt(14)
    v_mfma_f32_16x16x32_bf16 v[16:19], v[136:139], v[88:91], v[16:19]
    v_mfma_f32_16x16x32_bf16 v[36:39], v[136:139], v[92:95], v[36:39]
    ds_read_b64_tr_b16 v[136:137], v163 offset:20608
    ds_read_b64_tr_b16 v[138:139], v163 offset:21888
    s_waitcnt vmcnt(13) lgkmcnt(14)
    v_mfma_f32_16x16x32_bf16 v[0:3], v[140:143], v[96:99], v[0:3]
    s_waitcnt vmcnt(12)
    v_mfma_f32_16x16x32_bf16 v[20:23], v[140:143], v[100:103], v[20:23]
    ds_read_b64_tr_b16 v[140:141], v163 offset:25600
    ds_read_b64_tr_b16 v[142:143], v163 offset:26880
    s_waitcnt lgkmcnt(14)
    v_mfma_f32_16x16x32_bf16 v[4:7], v[144:147], v[96:99], v[4:7]
    v_mfma_f32_16x16x32_bf16 v[24:27], v[144:147], v[100:103], v[24:27]
    ds_read_b64_tr_b16 v[144:145], v163 offset:25632
    ds_read_b64_tr_b16 v[146:147], v163 offset:26912
    s_waitcnt lgkmcnt(14)
    v_mfma_f32_16x16x32_bf16 v[8:11], v[148:151], v[96:99], v[8:11]
    v_mfma_f32_16x16x32_bf16 v[28:31], v[148:151], v[100:103], v[28:31]
    ds_read_b64_tr_b16 v[148:149], v163 offset:25664
    ds_read_b64_tr_b16 v[150:151], v163 offset:26944
    s_waitcnt lgkmcnt(14)
    v_mfma_f32_16x16x32_bf16 v[12:15], v[152:155], v[96:99], v[12:15]
    v_mfma_f32_16x16x32_bf16 v[32:35], v[152:155], v[100:103], v[32:35]
    ds_read_b64_tr_b16 v[152:153], v163 offset:25696
    ds_read_b64_tr_b16 v[154:155], v163 offset:26976
    s_waitcnt lgkmcnt(14)
    v_mfma_f32_16x16x32_bf16 v[16:19], v[156:159], v[96:99], v[16:19]
    v_mfma_f32_16x16x32_bf16 v[36:39], v[156:159], v[100:103], v[36:39]
    ds_read_b64_tr_b16 v[156:157], v163 offset:25728
    ds_read_b64_tr_b16 v[158:159], v163 offset:27008
    s_barrier
    s_waitcnt vmcnt(11) lgkmcnt(14)
    v_mfma_f32_16x16x32_bf16 v[0:3], v[120:123], v[104:107], v[0:3]
    s_waitcnt vmcnt(10)
    v_mfma_f32_16x16x32_bf16 v[20:23], v[120:123], v[108:111], v[20:23]
    ds_read_b64_tr_b16 v[120:121], v162 offset:0
    ds_read_b64_tr_b16 v[122:123], v162 offset:1280
    s_waitcnt lgkmcnt(14)
    v_mfma_f32_16x16x32_bf16 v[4:7], v[124:127], v[104:107], v[4:7]
    v_mfma_f32_16x16x32_bf16 v[24:27], v[124:127], v[108:111], v[24:27]
    ds_read_b64_tr_b16 v[124:125], v162 offset:32
    ds_read_b64_tr_b16 v[126:127], v162 offset:1312
    s_waitcnt lgkmcnt(14)
    v_mfma_f32_16x16x32_bf16 v[8:11], v[128:131], v[104:107], v[8:11]
    v_mfma_f32_16x16x32_bf16 v[28:31], v[128:131], v[108:111], v[28:31]
    ds_read_b64_tr_b16 v[128:129], v162 offset:64
    ds_read_b64_tr_b16 v[130:131], v162 offset:1344
    s_waitcnt lgkmcnt(14)
    v_mfma_f32_16x16x32_bf16 v[12:15], v[132:135], v[104:107], v[12:15]
    v_mfma_f32_16x16x32_bf16 v[32:35], v[132:135], v[108:111], v[32:35]
    ds_read_b64_tr_b16 v[132:133], v162 offset:96
    ds_read_b64_tr_b16 v[134:135], v162 offset:1376
    s_waitcnt lgkmcnt(14)
    v_mfma_f32_16x16x32_bf16 v[16:19], v[136:139], v[104:107], v[16:19]
    v_mfma_f32_16x16x32_bf16 v[36:39], v[136:139], v[108:111], v[36:39]
    ds_read_b64_tr_b16 v[136:137], v162 offset:128
    ds_read_b64_tr_b16 v[138:139], v162 offset:1408
    s_waitcnt vmcnt(9) lgkmcnt(14)
    v_mfma_f32_16x16x32_bf16 v[0:3], v[140:143], v[112:115], v[0:3]
    s_waitcnt vmcnt(8)
    v_mfma_f32_16x16x32_bf16 v[20:23], v[140:143], v[116:119], v[20:23]
    ds_read_b64_tr_b16 v[140:141], v162 offset:5120
    ds_read_b64_tr_b16 v[142:143], v162 offset:6400
    s_waitcnt lgkmcnt(14)
    v_mfma_f32_16x16x32_bf16 v[4:7], v[144:147], v[112:115], v[4:7]
    v_mfma_f32_16x16x32_bf16 v[24:27], v[144:147], v[116:119], v[24:27]
    ds_read_b64_tr_b16 v[144:145], v162 offset:5152
    ds_read_b64_tr_b16 v[146:147], v162 offset:6432
    s_waitcnt lgkmcnt(14)
    v_mfma_f32_16x16x32_bf16 v[8:11], v[148:151], v[112:115], v[8:11]
    v_mfma_f32_16x16x32_bf16 v[28:31], v[148:151], v[116:119], v[28:31]
    ds_read_b64_tr_b16 v[148:149], v162 offset:5184
    ds_read_b64_tr_b16 v[150:151], v162 offset:6464
    s_waitcnt lgkmcnt(14)
    v_mfma_f32_16x16x32_bf16 v[12:15], v[152:155], v[112:115], v[12:15]
    v_mfma_f32_16x16x32_bf16 v[32:35], v[152:155], v[116:119], v[32:35]
    ds_read_b64_tr_b16 v[152:153], v162 offset:5216
    ds_read_b64_tr_b16 v[154:155], v162 offset:6496
    s_waitcnt lgkmcnt(14)
    v_mfma_f32_16x16x32_bf16 v[16:19], v[156:159], v[112:115], v[16:19]
    v_mfma_f32_16x16x32_bf16 v[36:39], v[156:159], v[116:119], v[36:39]
    ds_read_b64_tr_b16 v[156:157], v162 offset:5248
    ds_read_b64_tr_b16 v[158:159], v162 offset:6528
    s_barrier
    s_waitcnt vmcnt(7) lgkmcnt(14)
    v_mfma_f32_16x16x32_bf16 v[0:3], v[120:123], v[40:43], v[0:3]
    s_waitcnt vmcnt(6)
    v_mfma_f32_16x16x32_bf16 v[20:23], v[120:123], v[44:47], v[20:23]
    ds_read_b64_tr_b16 v[120:121], v162 offset:20480
    ds_read_b64_tr_b16 v[122:123], v162 offset:21760
    s_waitcnt lgkmcnt(14)
    v_mfma_f32_16x16x32_bf16 v[4:7], v[124:127], v[40:43], v[4:7]
    v_mfma_f32_16x16x32_bf16 v[24:27], v[124:127], v[44:47], v[24:27]
    ds_read_b64_tr_b16 v[124:125], v162 offset:20512
    ds_read_b64_tr_b16 v[126:127], v162 offset:21792
    s_waitcnt lgkmcnt(14)
    v_mfma_f32_16x16x32_bf16 v[8:11], v[128:131], v[40:43], v[8:11]
    v_mfma_f32_16x16x32_bf16 v[28:31], v[128:131], v[44:47], v[28:31]
    ds_read_b64_tr_b16 v[128:129], v162 offset:20544
    ds_read_b64_tr_b16 v[130:131], v162 offset:21824
    s_waitcnt lgkmcnt(14)
    v_mfma_f32_16x16x32_bf16 v[12:15], v[132:135], v[40:43], v[12:15]
    v_mfma_f32_16x16x32_bf16 v[32:35], v[132:135], v[44:47], v[32:35]
    ds_read_b64_tr_b16 v[132:133], v162 offset:20576
    ds_read_b64_tr_b16 v[134:135], v162 offset:21856
    s_waitcnt lgkmcnt(14)
    v_mfma_f32_16x16x32_bf16 v[16:19], v[136:139], v[40:43], v[16:19]
    v_mfma_f32_16x16x32_bf16 v[36:39], v[136:139], v[44:47], v[36:39]
    ds_read_b64_tr_b16 v[136:137], v162 offset:20608
    ds_read_b64_tr_b16 v[138:139], v162 offset:21888
    s_waitcnt vmcnt(5) lgkmcnt(14)
    v_mfma_f32_16x16x32_bf16 v[0:3], v[140:143], v[48:51], v[0:3]
    s_waitcnt vmcnt(4)
    v_mfma_f32_16x16x32_bf16 v[20:23], v[140:143], v[52:55], v[20:23]
    ds_read_b64_tr_b16 v[140:141], v162 offset:25600
    ds_read_b64_tr_b16 v[142:143], v162 offset:26880
    s_waitcnt lgkmcnt(14)
    v_mfma_f32_16x16x32_bf16 v[4:7], v[144:147], v[48:51], v[4:7]
    v_mfma_f32_16x16x32_bf16 v[24:27], v[144:147], v[52:55], v[24:27]
    ds_read_b64_tr_b16 v[144:145], v162 offset:25632
    ds_read_b64_tr_b16 v[146:147], v162 offset:26912
    s_waitcnt lgkmcnt(14)
    v_mfma_f32_16x16x32_bf16 v[8:11], v[148:151], v[48:51], v[8:11]
    v_mfma_f32_16x16x32_bf16 v[28:31], v[148:151], v[52:55], v[28:31]
    ds_read_b64_tr_b16 v[148:149], v162 offset:25664
    ds_read_b64_tr_b16 v[150:151], v162 offset:26944
    s_waitcnt lgkmcnt(14)
    v_mfma_f32_16x16x32_bf16 v[12:15], v[152:155], v[48:51], v[12:15]
    v_mfma_f32_16x16x32_bf16 v[32:35], v[152:155], v[52:55], v[32:35]
    ds_read_b64_tr_b16 v[152:153], v162 offset:25696
    ds_read_b64_tr_b16 v[154:155], v162 offset:26976
    s_waitcnt lgkmcnt(14)
    v_mfma_f32_16x16x32_bf16 v[16:19], v[156:159], v[48:51], v[16:19]
    v_mfma_f32_16x16x32_bf16 v[36:39], v[156:159], v[52:55], v[36:39]
    ds_read_b64_tr_b16 v[156:157], v162 offset:25728
    ds_read_b64_tr_b16 v[158:159], v162 offset:27008
    s_waitcnt vmcnt(3) lgkmcnt(14)
    v_mfma_f32_16x16x32_bf16 v[0:3], v[120:123], v[56:59], v[0:3]
    v_lshrrev_b32 v112, 6, v164
    v_and_b32 v113, 63, v164
    s_waitcnt vmcnt(2)
    v_mfma_f32_16x16x32_bf16 v[20:23], v[120:123], v[60:63], v[20:23]
    v_bfe_u32 v114, v164, 4, 2
    v_and_b32 v115, 15, v164
    s_waitcnt lgkmcnt(14)
    v_mfma_f32_16x16x32_bf16 v[4:7], v[124:127], v[56:59], v[4:7]
    v_lshlrev_b32 v165, 4, v114
    v_add_u32 v165, 139264, v165
    v_mfma_f32_16x16x32_bf16 v[24:27], v[124:127], v[60:63], v[24:27]
    ds_read_b128 v[72:75], v165 offset:0
    ds_read_b128 v[76:79], v165 offset:64
    s_waitcnt lgkmcnt(14)
    v_mfma_f32_16x16x32_bf16 v[8:11], v[128:131], v[56:59], v[8:11]
    ds_read_b128 v[80:83], v165 offset:128
    ds_read_b128 v[84:87], v165 offset:192
    v_mfma_f32_16x16x32_bf16 v[28:31], v[128:131], v[60:63], v[28:31]
    ds_read_b128 v[88:91], v165 offset:256
    v_lshl_add_u32 v167, v112, 4, v115
    s_waitcnt lgkmcnt(14)
    v_mfma_f32_16x16x32_bf16 v[12:15], v[132:135], v[56:59], v[12:15]
    ds_read_b128 v[92:95], v165 offset:320
    ds_read_b128 v[96:99], v165 offset:384
    v_mfma_f32_16x16x32_bf16 v[32:35], v[132:135], v[60:63], v[32:35]
    ds_read_b128 v[100:103], v165 offset:448
    ds_read_b128 v[104:107], v165 offset:512
    s_waitcnt lgkmcnt(14)
    v_mfma_f32_16x16x32_bf16 v[16:19], v[136:139], v[56:59], v[16:19]
    ds_read_b128 v[108:111], v165 offset:576
    v_mul_u32_u24 v166, 160, v167
    v_mfma_f32_16x16x32_bf16 v[36:39], v[136:139], v[60:63], v[36:39]
    v_lshl_add_u32 v166, v114, 3, v166
    s_waitcnt vmcnt(1) lgkmcnt(14)
    v_mfma_f32_16x16x32_bf16 v[0:3], v[140:143], v[64:67], v[0:3]
    v_add_u32 v166, 122880, v166
    ds_read_b64 v[40:41], v166 offset:0
    s_waitcnt vmcnt(0)
    v_mfma_f32_16x16x32_bf16 v[20:23], v[140:143], v[68:71], v[20:23]
    ds_read_b64 v[42:43], v166 offset:32
    ds_read_b64 v[44:45], v166 offset:64
    s_waitcnt lgkmcnt(14)
    v_mfma_f32_16x16x32_bf16 v[4:7], v[144:147], v[64:67], v[4:7]
    ds_read_b64 v[46:47], v166 offset:96
    ds_read_b64 v[48:49], v166 offset:128
    v_mfma_f32_16x16x32_bf16 v[24:27], v[144:147], v[68:71], v[24:27]
    v_mul_u32_u24 v166, 2560, v112
    v_lshl_add_u32 v50, v113, 4, v166
    s_waitcnt lgkmcnt(14)
    v_mfma_f32_16x16x32_bf16 v[8:11], v[148:151], v[64:67], v[8:11]
    v_lshl_add_u32 v51, v113, 3, v166
    v_lshlrev_b32 v118, 4, v164
    v_mfma_f32_16x16x32_bf16 v[28:31], v[148:151], v[68:71], v[28:31]
    v_lshlrev_b32 v119, 3, v167
    v_lshl_add_u32 v119, v114, 12, v119
    s_waitcnt lgkmcnt(14)
    v_mfma_f32_16x16x32_bf16 v[12:15], v[152:155], v[64:67], v[12:15]
    v_mul_u32_u24 v166, 5120, v112
    v_lshl_add_u32 v166, v113, 4, v166
    v_mfma_f32_16x16x32_bf16 v[32:35], v[152:155], v[68:71], v[32:35]
    v_add_u32 v116, 102400, v166
    v_xor_b32 v166, 1, v112
    s_waitcnt lgkmcnt(14)
    v_mfma_f32_16x16x32_bf16 v[16:19], v[156:159], v[64:67], v[16:19]
    v_mul_u32_u24 v166, 5120, v166
    v_lshl_add_u32 v166, v113, 4, v166
    v_mfma_f32_16x16x32_bf16 v[36:39], v[156:159], v[68:71], v[36:39]
    v_add_u32 v117, 102400, v166
    ds_write_b128 v116, v[20:23] offset:0
    ds_write_b128 v116, v[24:27] offset:1024
    ds_write_b128 v116, v[28:31] offset:2048
    ds_write_b128 v116, v[32:35] offset:3072
    s_nop 2
    ds_write_b128 v116, v[36:39] offset:4096
    s_waitcnt lgkmcnt(9)
    v_lshlrev_b32 v120, 16, v40
    v_and_b32 v121, 0xffff0000, v40
    v_lshlrev_b32 v122, 16, v41
    v_and_b32 v123, 0xffff0000, v41
    s_waitcnt lgkmcnt(8)
    v_lshlrev_b32 v124, 16, v42
    v_and_b32 v125, 0xffff0000, v42
    v_lshlrev_b32 v126, 16, v43
    v_and_b32 v127, 0xffff0000, v43
    s_waitcnt lgkmcnt(7)
    v_lshlrev_b32 v128, 16, v44
    v_and_b32 v129, 0xffff0000, v44
    v_lshlrev_b32 v130, 16, v45
    v_and_b32 v131, 0xffff0000, v45
    s_waitcnt lgkmcnt(6)
    v_lshlrev_b32 v132, 16, v46
    v_and_b32 v133, 0xffff0000, v46
    v_lshlrev_b32 v134, 16, v47
    v_and_b32 v135, 0xffff0000, v47
    s_waitcnt lgkmcnt(5)
    v_lshlrev_b32 v136, 16, v48
    v_and_b32 v137, 0xffff0000, v48
    v_lshlrev_b32 v138, 16, v49
    v_and_b32 v139, 0xffff0000, v49
    v_pk_fma_f32 v[120:121], v[0:1], v[72:73], v[120:121]
    v_pk_fma_f32 v[122:123], v[2:3], v[74:75], v[122:123]
    v_pk_fma_f32 v[124:125], v[4:5], v[76:77], v[124:125]
    v_pk_fma_f32 v[126:127], v[6:7], v[78:79], v[126:127]
    v_pk_fma_f32 v[128:129], v[8:9], v[80:81], v[128:129]
    v_pk_fma_f32 v[130:131], v[10:11], v[82:83], v[130:131]
    v_pk_fma_f32 v[132:133], v[12:13], v[84:85], v[132:133]
    v_pk_fma_f32 v[134:135], v[14:15], v[86:87], v[134:135]
    v_pk_fma_f32 v[136:137], v[16:17], v[88:89], v[136:137]
    v_pk_fma_f32 v[138:139], v[18:19], v[90:91], v[138:139]
    s_waitcnt lgkmcnt(0)
    s_barrier
    ds_read_b128 v[20:23], v117 offset:0
    ds_read_b128 v[24:27], v117 offset:1024
    ds_read_b128 v[28:31], v117 offset:2048
    ds_read_b128 v[32:35], v117 offset:3072
    ds_read_b128 v[36:39], v117 offset:4096
    s_waitcnt lgkmcnt(4)
    v_pk_fma_f32 v[0:1], v[20:21], v[72:73], v[120:121]
    v_pk_fma_f32 v[2:3], v[22:23], v[74:75], v[122:123]
    v_cvt_pk_bf16_f32 v40, v0, v1
    v_cvt_pk_bf16_f32 v41, v2, v3
    v_lshlrev_b32 v0, 16, v40
    v_and_b32 v1, 0xffff0000, v40
    v_lshlrev_b32 v2, 16, v41
    v_and_b32 v3, 0xffff0000, v41
    v_pk_mul_f32 v[20:21], v[0:1], v[92:93]
    v_pk_mul_f32 v[22:23], v[2:3], v[94:95]
    v_cvt_pk_bf16_f32 v20, v20, v21
    v_cvt_pk_bf16_f32 v21, v22, v23
    buffer_store_dwordx2 v[20:21], v118, s[24:27], s60 offen
    s_waitcnt lgkmcnt(3)
    v_pk_fma_f32 v[4:5], v[24:25], v[76:77], v[124:125]
    v_pk_fma_f32 v[6:7], v[26:27], v[78:79], v[126:127]
    v_cvt_pk_bf16_f32 v42, v4, v5
    v_cvt_pk_bf16_f32 v43, v6, v7
    v_lshlrev_b32 v4, 16, v42
    v_and_b32 v5, 0xffff0000, v42
    v_lshlrev_b32 v6, 16, v43
    v_and_b32 v7, 0xffff0000, v43
    v_pk_mul_f32 v[24:25], v[4:5], v[96:97]
    v_pk_mul_f32 v[26:27], v[6:7], v[98:99]
    v_cvt_pk_bf16_f32 v24, v24, v25
    v_cvt_pk_bf16_f32 v25, v26, v27
    buffer_store_dwordx2 v[24:25], v118, s[24:27], s61 offen
    buffer_store_dwordx4 v[40:43], v50, s[28:31], 0 offen
    s_waitcnt lgkmcnt(2)
    v_pk_fma_f32 v[8:9], v[28:29], v[80:81], v[128:129]
    v_pk_fma_f32 v[10:11], v[30:31], v[82:83], v[130:131]
    v_cvt_pk_bf16_f32 v44, v8, v9
    v_cvt_pk_bf16_f32 v45, v10, v11
    v_lshlrev_b32 v8, 16, v44
    v_and_b32 v9, 0xffff0000, v44
    v_lshlrev_b32 v10, 16, v45
    v_and_b32 v11, 0xffff0000, v45
    v_pk_mul_f32 v[28:29], v[8:9], v[100:101]
    v_pk_mul_f32 v[30:31], v[10:11], v[102:103]
    v_cvt_pk_bf16_f32 v28, v28, v29
    v_cvt_pk_bf16_f32 v29, v30, v31
    buffer_store_dwordx2 v[28:29], v118, s[24:27], s62 offen
    s_waitcnt lgkmcnt(1)
    v_pk_fma_f32 v[12:13], v[32:33], v[84:85], v[132:133]
    v_pk_fma_f32 v[14:15], v[34:35], v[86:87], v[134:135]
    v_cvt_pk_bf16_f32 v46, v12, v13
    v_cvt_pk_bf16_f32 v47, v14, v15
    v_lshlrev_b32 v12, 16, v46
    v_and_b32 v13, 0xffff0000, v46
    v_lshlrev_b32 v14, 16, v47
    v_and_b32 v15, 0xffff0000, v47
    v_pk_mul_f32 v[32:33], v[12:13], v[104:105]
    v_pk_mul_f32 v[34:35], v[14:15], v[106:107]
    v_cvt_pk_bf16_f32 v32, v32, v33
    v_cvt_pk_bf16_f32 v33, v34, v35
    buffer_store_dwordx2 v[32:33], v118, s[24:27], s63 offen
    buffer_store_dwordx4 v[44:47], v50, s[28:31], 0 offen offset:1024
    s_waitcnt lgkmcnt(0)
    v_pk_fma_f32 v[16:17], v[36:37], v[88:89], v[136:137]
    v_pk_fma_f32 v[18:19], v[38:39], v[90:91], v[138:139]
    v_cvt_pk_bf16_f32 v48, v16, v17
    v_cvt_pk_bf16_f32 v49, v18, v19
    v_lshlrev_b32 v16, 16, v48
    v_and_b32 v17, 0xffff0000, v48
    v_lshlrev_b32 v18, 16, v49
    v_and_b32 v19, 0xffff0000, v49
    v_pk_mul_f32 v[36:37], v[16:17], v[108:109]
    v_pk_mul_f32 v[38:39], v[18:19], v[110:111]
    v_cvt_pk_bf16_f32 v36, v36, v37
    v_cvt_pk_bf16_f32 v37, v38, v39
    buffer_store_dwordx2 v[36:37], v118, s[24:27], s64 offen
    buffer_store_dwordx2 v[48:49], v51, s[28:31], 0 offen offset:2048
    v_pk_mul_f32 v[142:143], v[0:1], v[0:1]
    v_pk_fma_f32 v[142:143], v[2:3], v[2:3], v[142:143]
    v_pk_add_f32 v[140:141], v[0:1], v[2:3]
    v_pk_fma_f32 v[142:143], v[4:5], v[4:5], v[142:143]
    v_pk_add_f32 v[140:141], v[140:141], v[4:5]
    v_pk_fma_f32 v[142:143], v[6:7], v[6:7], v[142:143]
    v_pk_add_f32 v[140:141], v[140:141], v[6:7]
    v_pk_fma_f32 v[142:143], v[8:9], v[8:9], v[142:143]
    v_pk_add_f32 v[140:141], v[140:141], v[8:9]
    v_pk_fma_f32 v[142:143], v[10:11], v[10:11], v[142:143]
    v_pk_add_f32 v[140:141], v[140:141], v[10:11]
    v_pk_fma_f32 v[142:143], v[12:13], v[12:13], v[142:143]
    v_pk_add_f32 v[140:141], v[140:141], v[12:13]
    v_pk_fma_f32 v[142:143], v[14:15], v[14:15], v[142:143]
    v_pk_add_f32 v[140:141], v[140:141], v[14:15]
    v_pk_fma_f32 v[142:143], v[16:17], v[16:17], v[142:143]
    v_pk_add_f32 v[140:141], v[140:141], v[16:17]
    v_pk_fma_f32 v[142:143], v[18:19], v[18:19], v[142:143]
    v_pk_add_f32 v[140:141], v[140:141], v[18:19]
    v_add_f32 v140, v140, v141
    v_add_f32 v141, v142, v143
    v_mov_b32 v142, v140
    v_mov_b32 v143, v141
    s_nop 0
    v_permlane32_swap_b32 v140, v142
    v_permlane32_swap_b32 v141, v143
    v_pk_add_f32 v[140:141], v[140:141], v[142:143]
    v_mov_b32 v142, v140
    v_mov_b32 v143, v141
    s_nop 0
    v_permlane16_swap_b32 v140, v142
    v_permlane16_swap_b32 v141, v143
    v_pk_add_f32 v[140:141], v[140:141], v[142:143]
    buffer_store_dwordx2 v[140:141], v119, s[32:35], 0 offen
oproj_kernel_end_1:
    s_endpgm
.globl mlp1_kernel
.p2align 8
.type mlp1_kernel,@function
mlp1_kernel:
    s_cmp_ge_u32 s2, 224
    s_cbranch_scc1 mlp1_kernel_end_1
    s_load_dwordx2 s[4:5], s[0:1], 112
    s_load_dwordx4 s[8:11], s[0:1], 48
    v_lshrrev_b32 v234, 6, v0
    v_and_b32 v235, 63, v0
    v_and_b32 v241, 255, v0
    v_readfirstlane_b32 s44, v234
    v_and_b32 v234, 3, v234
    s_and_b32 s53, s2, 7
    s_lshr_b32 s54, s2, 3
    s_mul_i32 s55, s54, 37
    s_lshr_b32 s55, s55, 8
    s_lshr_b32 s47, s53, 1
    s_lshl_b32 s47, s47, 2
    s_add_u32 s47, s47, s55
    s_mul_i32 s55, s55, 7
    s_sub_u32 s48, s54, s55
    s_and_b32 s55, s53, 1
    s_mul_i32 s55, s55, 7
    s_add_u32 s48, s48, s55
    s_cmp_ge_u32 s44, 4
    s_cbranch_scc1 mlp1_kernel_ld_3
    s_lshr_b32 s45, s44, 1
    v_lshrrev_b32 v238, 1, v234
    v_and_b32 v239, 1, v234
    v_mul_u32_u24 v238, 81920, v238
    v_lshl_add_u32 v238, v235, 4, v238
    v_lshl_add_u32 v238, v239, 12, v238
    v_lshl_add_u32 v224, v239, 11, v238
    v_xor_b32 v225, 2048, v224
    s_mul_i32 s53, s47, 163840
    s_add_u32 s53, s53, 20971520
    s_mov_b32 s50, 0
    s_waitcnt lgkmcnt(0)
    s_add_u32 s12, s4, s53
    s_addc_u32 s13, s5, 0
    s_mov_b32 s14, 163840
    s_mov_b32 s15, 0x00020000
    buffer_load_dwordx4 v[128:131], v224, s[12:15], s50 offen offset:0
    buffer_load_dwordx4 v[132:135], v224, s[12:15], s50 offen offset:1024
    buffer_load_dwordx4 v[136:139], v225, s[12:15], s50 offen offset:0
    buffer_load_dwordx4 v[140:143], v225, s[12:15], s50 offen offset:1024
    s_add_u32 s50, s50, 8192
    buffer_load_dwordx4 v[144:147], v224, s[12:15], s50 offen offset:0
    buffer_load_dwordx4 v[148:151], v224, s[12:15], s50 offen offset:1024
    buffer_load_dwordx4 v[152:155], v225, s[12:15], s50 offen offset:0
    buffer_load_dwordx4 v[156:159], v225, s[12:15], s50 offen offset:1024
    s_add_u32 s50, s50, 8192
    buffer_load_dwordx4 v[160:163], v224, s[12:15], s50 offen offset:0
    buffer_load_dwordx4 v[164:167], v224, s[12:15], s50 offen offset:1024
    buffer_load_dwordx4 v[168:171], v225, s[12:15], s50 offen offset:0
    buffer_load_dwordx4 v[172:175], v225, s[12:15], s50 offen offset:1024
    s_add_u32 s50, s50, 8192
    v_lshrrev_b32 v236, 4, v235
    v_bfe_u32 v192, v235, 2, 2
    v_and_b32 v193, 3, v235
    v_and_b32 v237, 15, v235
    v_and_b32 v239, 1, v234
    v_lshlrev_b32 v238, 2, v236
    v_add_u32 v238, v238, v192
    v_mul_u32_u24 v239, 32, v239
    v_add_u32 v239, v239, v238
    v_mul_u32_u24 v239, 256, v239
    v_lshl_add_u32 v239, v193, 3, v239
    v_and_b32 v238, 7, v238
    v_xor_b32 v240, 0, v238
    v_lshl_add_u32 v226, v240, 5, v239
    v_xor_b32 v240, 1, v238
    v_lshl_add_u32 v227, v240, 5, v239
    v_xor_b32 v240, 2, v238
    v_lshl_add_u32 v228, v240, 5, v239
    v_xor_b32 v240, 3, v238
    v_lshl_add_u32 v229, v240, 5, v239
    v_xor_b32 v240, 4, v238
    v_lshl_add_u32 v230, v240, 5, v239
    v_xor_b32 v240, 5, v238
    v_lshl_add_u32 v231, v240, 5, v239
    v_xor_b32 v240, 6, v238
    v_lshl_add_u32 v232, v240, 5, v239
    v_xor_b32 v240, 7, v238
    v_lshl_add_u32 v233, v240, 5, v239
    s_lshl_b32 s53, s47, 1
    s_add_u32 s53, s53, s45
    s_mul_i32 s53, s53, 221184
    s_add_u32 s53, s53, 35651584
    s_add_u32 s24, s4, s53
    s_addc_u32 s25, s5, 0
    s_mov_b32 s26, 221184
    s_mov_b32 s27, 0x00020000
    s_barrier
    ds_read_b64_tr_b16 v[192:193], v226 offset:0
    ds_read_b64_tr_b16 v[194:195], v226 offset:4096
    ds_read_b64_tr_b16 v[196:197], v227 offset:0
    ds_read_b64_tr_b16 v[198:199], v227 offset:4096
    ds_read_b64_tr_b16 v[200:201], v228 offset:0
    ds_read_b64_tr_b16 v[202:203], v228 offset:4096
    ds_read_b64_tr_b16 v[204:205], v229 offset:0
    ds_read_b64_tr_b16 v[206:207], v229 offset:4096
    ds_read_b64_tr_b16 v[208:209], v230 offset:0
    ds_read_b64_tr_b16 v[210:211], v230 offset:4096
    ds_read_b64_tr_b16 v[212:213], v231 offset:0
    ds_read_b64_tr_b16 v[214:215], v231 offset:4096
    ds_read_b64_tr_b16 v[216:217], v232 offset:0
    ds_read_b64_tr_b16 v[218:219], v232 offset:4096
    ds_read_b64_tr_b16 v[220:221], v233 offset:0
    ds_read_b64_tr_b16 v[222:223], v233 offset:4096
    s_barrier
    s_waitcnt vmcnt(11) lgkmcnt(14)
    v_mfma_f32_16x16x32_bf16 v[0:3], v[192:195], v[128:131], 0
    buffer_load_dwordx4 v[176:179], v224, s[12:15], s50 offen offset:0
    s_waitcnt vmcnt(11)
    v_mfma_f32_16x16x32_bf16 v[32:35], v[192:195], v[132:135], 0
    s_waitcnt vmcnt(10)
    v_mfma_f32_16x16x32_bf16 v[64:67], v[192:195], v[136:139], 0
    s_waitcnt vmcnt(9)
    v_mfma_f32_16x16x32_bf16 v[96:99], v[192:195], v[140:143], 0
    ds_read_b64_tr_b16 v[192:193], v226 offset:16384
    ds_read_b64_tr_b16 v[194:195], v226 offset:20480
    s_waitcnt lgkmcnt(14)
    v_mfma_f32_16x16x32_bf16 v[4:7], v[196:199], v[128:131], 0
    v_mfma_f32_16x16x32_bf16 v[36:39], v[196:199], v[132:135], 0
    buffer_load_dwordx4 v[180:183], v224, s[12:15], s50 offen offset:1024
    v_mfma_f32_16x16x32_bf16 v[68:71], v[196:199], v[136:139], 0
    v_mfma_f32_16x16x32_bf16 v[100:103], v[196:199], v[140:143], 0
    ds_read_b64_tr_b16 v[196:197], v227 offset:16384
    ds_read_b64_tr_b16 v[198:199], v227 offset:20480
    s_waitcnt lgkmcnt(14)
    v_mfma_f32_16x16x32_bf16 v[8:11], v[200:203], v[128:131], 0
    v_mfma_f32_16x16x32_bf16 v[40:43], v[200:203], v[132:135], 0
    v_mfma_f32_16x16x32_bf16 v[72:75], v[200:203], v[136:139], 0
    v_mfma_f32_16x16x32_bf16 v[104:107], v[200:203], v[140:143], 0
    ds_read_b64_tr_b16 v[200:201], v228 offset:16384
    ds_read_b64_tr_b16 v[202:203], v228 offset:20480
    s_waitcnt lgkmcnt(14)
    v_mfma_f32_16x16x32_bf16 v[12:15], v[204:207], v[128:131], 0
    buffer_load_dwordx4 v[184:187], v225, s[12:15], s50 offen offset:0
    v_mfma_f32_16x16x32_bf16 v[44:47], v[204:207], v[132:135], 0
    v_mfma_f32_16x16x32_bf16 v[76:79], v[204:207], v[136:139], 0
    v_mfma_f32_16x16x32_bf16 v[108:111], v[204:207], v[140:143], 0
    ds_read_b64_tr_b16 v[204:205], v229 offset:16384
    ds_read_b64_tr_b16 v[206:207], v229 offset:20480
    s_waitcnt lgkmcnt(14)
    v_mfma_f32_16x16x32_bf16 v[16:19], v[208:211], v[128:131], 0
    v_mfma_f32_16x16x32_bf16 v[48:51], v[208:211], v[132:135], 0
    v_mfma_f32_16x16x32_bf16 v[80:83], v[208:211], v[136:139], 0
    buffer_load_dwordx4 v[188:191], v225, s[12:15], s50 offen offset:1024
    v_mfma_f32_16x16x32_bf16 v[112:115], v[208:211], v[140:143], 0
    ds_read_b64_tr_b16 v[208:209], v230 offset:16384
    ds_read_b64_tr_b16 v[210:211], v230 offset:20480
    s_waitcnt lgkmcnt(14)
    v_mfma_f32_16x16x32_bf16 v[20:23], v[212:215], v[128:131], 0
    v_mfma_f32_16x16x32_bf16 v[52:55], v[212:215], v[132:135], 0
    v_mfma_f32_16x16x32_bf16 v[84:87], v[212:215], v[136:139], 0
    v_mfma_f32_16x16x32_bf16 v[116:119], v[212:215], v[140:143], 0
    ds_read_b64_tr_b16 v[212:213], v231 offset:16384
    ds_read_b64_tr_b16 v[214:215], v231 offset:20480
    s_waitcnt lgkmcnt(14)
    v_mfma_f32_16x16x32_bf16 v[24:27], v[216:219], v[128:131], 0
    v_mfma_f32_16x16x32_bf16 v[56:59], v[216:219], v[132:135], 0
    s_add_u32 s50, s50, 8192
    v_mfma_f32_16x16x32_bf16 v[88:91], v[216:219], v[136:139], 0
    v_mfma_f32_16x16x32_bf16 v[120:123], v[216:219], v[140:143], 0
    ds_read_b64_tr_b16 v[216:217], v232 offset:16384
    ds_read_b64_tr_b16 v[218:219], v232 offset:20480
    s_waitcnt lgkmcnt(14)
    v_mfma_f32_16x16x32_bf16 v[28:31], v[220:223], v[128:131], 0
    v_mfma_f32_16x16x32_bf16 v[60:63], v[220:223], v[132:135], 0
    v_mfma_f32_16x16x32_bf16 v[92:95], v[220:223], v[136:139], 0
    v_mfma_f32_16x16x32_bf16 v[124:127], v[220:223], v[140:143], 0
    ds_read_b64_tr_b16 v[220:221], v233 offset:16384
    ds_read_b64_tr_b16 v[222:223], v233 offset:20480
    s_barrier
    s_waitcnt vmcnt(11) lgkmcnt(14)
    v_mfma_f32_16x16x32_bf16 v[0:3], v[192:195], v[144:147], v[0:3]
    buffer_load_dwordx4 v[128:131], v224, s[12:15], s50 offen offset:0
    s_waitcnt vmcnt(11)
    v_mfma_f32_16x16x32_bf16 v[32:35], v[192:195], v[148:151], v[32:35]
    s_waitcnt vmcnt(10)
    v_mfma_f32_16x16x32_bf16 v[64:67], v[192:195], v[152:155], v[64:67]
    s_waitcnt vmcnt(9)
    v_mfma_f32_16x16x32_bf16 v[96:99], v[192:195], v[156:159], v[96:99]
    ds_read_b64_tr_b16 v[192:193], v226 offset:32768
    ds_read_b64_tr_b16 v[194:195], v226 offset:36864
    s_waitcnt lgkmcnt(14)
    v_mfma_f32_16x16x32_bf16 v[4:7], v[196:199], v[144:147], v[4:7]
    v_mfma_f32_16x16x32_bf16 v[36:39], v[196:199], v[148:151], v[36:39]
    buffer_load_dwordx4 v[132:135], v224, s[12:15], s50 offen offset:1024
    v_mfma_f32_16x16x32_bf16 v[68:71], v[196:199], v[152:155], v[68:71]
    v_mfma_f32_16x16x32_bf16 v[100:103], v[196:199], v[156:159], v[100:103]
    ds_read_b64_tr_b16 v[196:197], v227 offset:32768
    ds_read_b64_tr_b16 v[198:199], v227 offset:36864
    s_waitcnt lgkmcnt(14)
    v_mfma_f32_16x16x32_bf16 v[8:11], v[200:203], v[144:147], v[8:11]
    v_mfma_f32_16x16x32_bf16 v[40:43], v[200:203], v[148:151], v[40:43]
    v_mfma_f32_16x16x32_bf16 v[72:75], v[200:203], v[152:155], v[72:75]
    v_mfma_f32_16x16x32_bf16 v[104:107], v[200:203], v[156:159], v[104:107]
    ds_read_b64_tr_b16 v[200:201], v228 offset:32768
    ds_read_b64_tr_b16 v[202:203], v228 offset:36864
    s_waitcnt lgkmcnt(14)
    v_mfma_f32_16x16x32_bf16 v[12:15], v[204:207], v[144:147], v[12:15]
    buffer_load_dwordx4 v[136:139], v225, s[12:15], s50 offen offset:0
    v_mfma_f32_16x16x32_bf16 v[44:47], v[204:207], v[148:151], v[44:47]
    v_mfma_f32_16x16x32_bf16 v[76:79], v[204:207], v[152:155], v[76:79]
    v_mfma_f32_16x16x32_bf16 v[108:111], v[204:207], v[156:159], v[108:111]
    ds_read_b64_tr_b16 v[204:205], v229 offset:32768
    ds_read_b64_tr_b16 v[206:207], v229 offset:36864
    s_waitcnt lgkmcnt(14)
    v_mfma_f32_16x16x32_bf16 v[16:19], v[208:211], v[144:147], v[16:19]
    v_mfma_f32_16x16x32_bf16 v[48:51], v[208:211], v[148:151], v[48:51]
    v_mfma_f32_16x16x32_bf16 v[80:83], v[208:211], v[152:155], v[80:83]
    buffer_load_dwordx4 v[140:143], v225, s[12:15], s50 offen offset:1024
    v_mfma_f32_16x16x32_bf16 v[112:115], v[208:211], v[156:159], v[112:115]
    ds_read_b64_tr_b16 v[208:209], v230 offset:32768
    ds_read_b64_tr_b16 v[210:211], v230 offset:36864
    s_waitcnt lgkmcnt(14)
    v_mfma_f32_16x16x32_bf16 v[20:23], v[212:215], v[144:147], v[20:23]
    v_mfma_f32_16x16x32_bf16 v[52:55], v[212:215], v[148:151], v[52:55]
    v_mfma_f32_16x16x32_bf16 v[84:87], v[212:215], v[152:155], v[84:87]
    v_mfma_f32_16x16x32_bf16 v[116:119], v[212:215], v[156:159], v[116:119]
    ds_read_b64_tr_b16 v[212:213], v231 offset:32768
    ds_read_b64_tr_b16 v[214:215], v231 offset:36864
    s_waitcnt lgkmcnt(14)
    v_mfma_f32_16x16x32_bf16 v[24:27], v[216:219], v[144:147], v[24:27]
    v_mfma_f32_16x16x32_bf16 v[56:59], v[216:219], v[148:151], v[56:59]
    s_add_u32 s50, s50, 8192
    v_mfma_f32_16x16x32_bf16 v[88:91], v[216:219], v[152:155], v[88:91]
    v_mfma_f32_16x16x32_bf16 v[120:123], v[216:219], v[156:159], v[120:123]
    ds_read_b64_tr_b16 v[216:217], v232 offset:32768
    ds_read_b64_tr_b16 v[218:219], v232 offset:36864
    s_waitcnt lgkmcnt(14)
    v_mfma_f32_16x16x32_bf16 v[28:31], v[220:223], v[144:147], v[28:31]
    v_mfma_f32_16x16x32_bf16 v[60:63], v[220:223], v[148:151], v[60:63]
    v_mfma_f32_16x16x32_bf16 v[92:95], v[220:223], v[152:155], v[92:95]
    v_mfma_f32_16x16x32_bf16 v[124:127], v[220:223], v[156:159], v[124:127]
    ds_read_b64_tr_b16 v[220:221], v233 offset:32768
    ds_read_b64_tr_b16 v[222:223], v233 offset:36864
    s_barrier
    s_waitcnt vmcnt(11) lgkmcnt(14)
    v_mfma_f32_16x16x32_bf16 v[0:3], v[192:195], v[160:163], v[0:3]
    buffer_load_dwordx4 v[144:147], v224, s[12:15], s50 offen offset:0
    s_waitcnt vmcnt(11)
    v_mfma_f32_16x16x32_bf16 v[32:35], v[192:195], v[164:167], v[32:35]
    s_waitcnt vmcnt(10)
    v_mfma_f32_16x16x32_bf16 v[64:67], v[192:195], v[168:171], v[64:67]
    s_waitcnt vmcnt(9)
    v_mfma_f32_16x16x32_bf16 v[96:99], v[192:195], v[172:175], v[96:99]
    ds_read_b64_tr_b16 v[192:193], v226 offset:49152
    ds_read_b64_tr_b16 v[194:195], v226 offset:53248
    s_waitcnt lgkmcnt(14)
    v_mfma_f32_16x16x32_bf16 v[4:7], v[196:199], v[160:163], v[4:7]
    v_mfma_f32_16x16x32_bf16 v[36:39], v[196:199], v[164:167], v[36:39]
    buffer_load_dwordx4 v[148:151], v224, s[12:15], s50 offen offset:1024
    v_mfma_f32_16x16x32_bf16 v[68:71], v[196:199], v[168:171], v[68:71]
    v_mfma_f32_16x16x32_bf16 v[100:103], v[196:199], v[172:175], v[100:103]
    ds_read_b64_tr_b16 v[196:197], v227 offset:49152
    ds_read_b64_tr_b16 v[198:199], v227 offset:53248
    s_waitcnt lgkmcnt(14)
    v_mfma_f32_16x16x32_bf16 v[8:11], v[200:203], v[160:163], v[8:11]
    v_mfma_f32_16x16x32_bf16 v[40:43], v[200:203], v[164:167], v[40:43]
    v_mfma_f32_16x16x32_bf16 v[72:75], v[200:203], v[168:171], v[72:75]
    v_mfma_f32_16x16x32_bf16 v[104:107], v[200:203], v[172:175], v[104:107]
    ds_read_b64_tr_b16 v[200:201], v228 offset:49152
    ds_read_b64_tr_b16 v[202:203], v228 offset:53248
    s_waitcnt lgkmcnt(14)
    v_mfma_f32_16x16x32_bf16 v[12:15], v[204:207], v[160:163], v[12:15]
    buffer_load_dwordx4 v[152:155], v225, s[12:15], s50 offen offset:0
    v_mfma_f32_16x16x32_bf16 v[44:47], v[204:207], v[164:167], v[44:47]
    v_mfma_f32_16x16x32_bf16 v[76:79], v[204:207], v[168:171], v[76:79]
    v_mfma_f32_16x16x32_bf16 v[108:111], v[204:207], v[172:175], v[108:111]
    ds_read_b64_tr_b16 v[204:205], v229 offset:49152
    ds_read_b64_tr_b16 v[206:207], v229 offset:53248
    s_waitcnt lgkmcnt(14)
    v_mfma_f32_16x16x32_bf16 v[16:19], v[208:211], v[160:163], v[16:19]
    v_mfma_f32_16x16x32_bf16 v[48:51], v[208:211], v[164:167], v[48:51]
    v_mfma_f32_16x16x32_bf16 v[80:83], v[208:211], v[168:171], v[80:83]
    buffer_load_dwordx4 v[156:159], v225, s[12:15], s50 offen offset:1024
    v_mfma_f32_16x16x32_bf16 v[112:115], v[208:211], v[172:175], v[112:115]
    ds_read_b64_tr_b16 v[208:209], v230 offset:49152
    ds_read_b64_tr_b16 v[210:211], v230 offset:53248
    s_waitcnt lgkmcnt(14)
    v_mfma_f32_16x16x32_bf16 v[20:23], v[212:215], v[160:163], v[20:23]
    v_mfma_f32_16x16x32_bf16 v[52:55], v[212:215], v[164:167], v[52:55]
    v_mfma_f32_16x16x32_bf16 v[84:87], v[212:215], v[168:171], v[84:87]
    v_mfma_f32_16x16x32_bf16 v[116:119], v[212:215], v[172:175], v[116:119]
    ds_read_b64_tr_b16 v[212:213], v231 offset:49152
    ds_read_b64_tr_b16 v[214:215], v231 offset:53248
    s_waitcnt lgkmcnt(14)
    v_mfma_f32_16x16x32_bf16 v[24:27], v[216:219], v[160:163], v[24:27]
    v_mfma_f32_16x16x32_bf16 v[56:59], v[216:219], v[164:167], v[56:59]
    s_add_u32 s50, s50, 8192
    v_mfma_f32_16x16x32_bf16 v[88:91], v[216:219], v[168:171], v[88:91]
    v_mfma_f32_16x16x32_bf16 v[120:123], v[216:219], v[172:175], v[120:123]
    ds_read_b64_tr_b16 v[216:217], v232 offset:49152
    ds_read_b64_tr_b16 v[218:219], v232 offset:53248
    s_waitcnt lgkmcnt(14)
    v_mfma_f32_16x16x32_bf16 v[28:31], v[220:223], v[160:163], v[28:31]
    v_mfma_f32_16x16x32_bf16 v[60:63], v[220:223], v[164:167], v[60:63]
    v_mfma_f32_16x16x32_bf16 v[92:95], v[220:223], v[168:171], v[92:95]
    v_mfma_f32_16x16x32_bf16 v[124:127], v[220:223], v[172:175], v[124:127]
    ds_read_b64_tr_b16 v[220:221], v233 offset:49152
    ds_read_b64_tr_b16 v[222:223], v233 offset:53248
    s_barrier
    s_waitcnt vmcnt(11) lgkmcnt(14)
    v_mfma_f32_16x16x32_bf16 v[0:3], v[192:195], v[176:179], v[0:3]
    buffer_load_dwordx4 v[160:163], v224, s[12:15], s50 offen offset:0
    s_waitcnt vmcnt(11)
    v_mfma_f32_16x16x32_bf16 v[32:35], v[192:195], v[180:183], v[32:35]
    s_waitcnt vmcnt(10)
    v_mfma_f32_16x16x32_bf16 v[64:67], v[192:195], v[184:187], v[64:67]
    s_waitcnt vmcnt(9)
    v_mfma_f32_16x16x32_bf16 v[96:99], v[192:195], v[188:191], v[96:99]
    v_add_u32 v226, 65536, v226
    ds_read_b64_tr_b16 v[192:193], v226 offset:0
    ds_read_b64_tr_b16 v[194:195], v226 offset:4096
    s_waitcnt lgkmcnt(14)
    v_mfma_f32_16x16x32_bf16 v[4:7], v[196:199], v[176:179], v[4:7]
    v_mfma_f32_16x16x32_bf16 v[36:39], v[196:199], v[180:183], v[36:39]
    buffer_load_dwordx4 v[164:167], v224, s[12:15], s50 offen offset:1024
    v_mfma_f32_16x16x32_bf16 v[68:71], v[196:199], v[184:187], v[68:71]
    v_mfma_f32_16x16x32_bf16 v[100:103], v[196:199], v[188:191], v[100:103]
    v_add_u32 v227, 65536, v227
    ds_read_b64_tr_b16 v[196:197], v227 offset:0
    ds_read_b64_tr_b16 v[198:199], v227 offset:4096
    s_waitcnt lgkmcnt(14)
    v_mfma_f32_16x16x32_bf16 v[8:11], v[200:203], v[176:179], v[8:11]
    v_mfma_f32_16x16x32_bf16 v[40:43], v[200:203], v[180:183], v[40:43]
    v_mfma_f32_16x16x32_bf16 v[72:75], v[200:203], v[184:187], v[72:75]
    v_mfma_f32_16x16x32_bf16 v[104:107], v[200:203], v[188:191], v[104:107]
    v_add_u32 v228, 65536, v228
    ds_read_b64_tr_b16 v[200:201], v228 offset:0
    ds_read_b64_tr_b16 v[202:203], v228 offset:4096
    s_waitcnt lgkmcnt(14)
    v_mfma_f32_16x16x32_bf16 v[12:15], v[204:207], v[176:179], v[12:15]
    buffer_load_dwordx4 v[168:171], v225, s[12:15], s50 offen offset:0
    v_mfma_f32_16x16x32_bf16 v[44:47], v[204:207], v[180:183], v[44:47]
    v_mfma_f32_16x16x32_bf16 v[76:79], v[204:207], v[184:187], v[76:79]
    v_mfma_f32_16x16x32_bf16 v[108:111], v[204:207], v[188:191], v[108:111]
    v_add_u32 v229, 65536, v229
    ds_read_b64_tr_b16 v[204:205], v229 offset:0
    ds_read_b64_tr_b16 v[206:207], v229 offset:4096
    s_waitcnt lgkmcnt(14)
    v_mfma_f32_16x16x32_bf16 v[16:19], v[208:211], v[176:179], v[16:19]
    v_mfma_f32_16x16x32_bf16 v[48:51], v[208:211], v[180:183], v[48:51]
    v_mfma_f32_16x16x32_bf16 v[80:83], v[208:211], v[184:187], v[80:83]
    buffer_load_dwordx4 v[172:175], v225, s[12:15], s50 offen offset:1024
    v_mfma_f32_16x16x32_bf16 v[112:115], v[208:211], v[188:191], v[112:115]
    v_add_u32 v230, 65536, v230
    ds_read_b64_tr_b16 v[208:209], v230 offset:0
    ds_read_b64_tr_b16 v[210:211], v230 offset:4096
    s_waitcnt lgkmcnt(14)
    v_mfma_f32_16x16x32_bf16 v[20:23], v[212:215], v[176:179], v[20:23]
    v_mfma_f32_16x16x32_bf16 v[52:55], v[212:215], v[180:183], v[52:55]
    v_mfma_f32_16x16x32_bf16 v[84:87], v[212:215], v[184:187], v[84:87]
    v_mfma_f32_16x16x32_bf16 v[116:119], v[212:215], v[188:191], v[116:119]
    v_add_u32 v231, 65536, v231
    ds_read_b64_tr_b16 v[212:213], v231 offset:0
    ds_read_b64_tr_b16 v[214:215], v231 offset:4096
    s_waitcnt lgkmcnt(14)
    v_mfma_f32_16x16x32_bf16 v[24:27], v[216:219], v[176:179], v[24:27]
    v_mfma_f32_16x16x32_bf16 v[56:59], v[216:219], v[180:183], v[56:59]
    s_add_u32 s50, s50, 8192
    v_mfma_f32_16x16x32_bf16 v[88:91], v[216:219], v[184:187], v[88:91]
    v_mfma_f32_16x16x32_bf16 v[120:123], v[216:219], v[188:191], v[120:123]
    v_add_u32 v232, 65536, v232
    ds_read_b64_tr_b16 v[216:217], v232 offset:0
    ds_read_b64_tr_b16 v[218:219], v232 offset:4096
    s_waitcnt lgkmcnt(14)
    v_mfma_f32_16x16x32_bf16 v[28:31], v[220:223], v[176:179], v[28:31]
    v_mfma_f32_16x16x32_bf16 v[60:63], v[220:223], v[180:183], v[60:63]
    v_mfma_f32_16x16x32_bf16 v[92:95], v[220:223], v[184:187], v[92:95]
    v_mfma_f32_16x16x32_bf16 v[124:127], v[220:223], v[188:191], v[124:127]
    v_add_u32 v233, 65536, v233
    ds_read_b64_tr_b16 v[220:221], v233 offset:0
    ds_read_b64_tr_b16 v[222:223], v233 offset:4096
    s_barrier
    s_waitcnt vmcnt(11) lgkmcnt(14)
    v_mfma_f32_16x16x32_bf16 v[0:3], v[192:195], v[128:131], v[0:3]
    buffer_load_dwordx4 v[176:179], v224, s[12:15], s50 offen offset:0
    s_waitcnt vmcnt(11)
    v_mfma_f32_16x16x32_bf16 v[32:35], v[192:195], v[132:135], v[32:35]
    s_waitcnt vmcnt(10)
    v_mfma_f32_16x16x32_bf16 v[64:67], v[192:195], v[136:139], v[64:67]
    s_waitcnt vmcnt(9)
    v_mfma_f32_16x16x32_bf16 v[96:99], v[192:195], v[140:143], v[96:99]
    ds_read_b64_tr_b16 v[192:193], v226 offset:16384
    ds_read_b64_tr_b16 v[194:195], v226 offset:20480
    s_waitcnt lgkmcnt(14)
    v_mfma_f32_16x16x32_bf16 v[4:7], v[196:199], v[128:131], v[4:7]
    v_mfma_f32_16x16x32_bf16 v[36:39], v[196:199], v[132:135], v[36:39]
    buffer_load_dwordx4 v[180:183], v224, s[12:15], s50 offen offset:1024
    v_mfma_f32_16x16x32_bf16 v[68:71], v[196:199], v[136:139], v[68:71]
    v_mfma_f32_16x16x32_bf16 v[100:103], v[196:199], v[140:143], v[100:103]
    ds_read_b64_tr_b16 v[196:197], v227 offset:16384
    ds_read_b64_tr_b16 v[198:199], v227 offset:20480
    s_waitcnt lgkmcnt(14)
    v_mfma_f32_16x16x32_bf16 v[8:11], v[200:203], v[128:131], v[8:11]
    v_mfma_f32_16x16x32_bf16 v[40:43], v[200:203], v[132:135], v[40:43]
    v_mfma_f32_16x16x32_bf16 v[72:75], v[200:203], v[136:139], v[72:75]
    v_mfma_f32_16x16x32_bf16 v[104:107], v[200:203], v[140:143], v[104:107]
    ds_read_b64_tr_b16 v[200:201], v228 offset:16384
    ds_read_b64_tr_b16 v[202:203], v228 offset:20480
    s_waitcnt lgkmcnt(14)
    v_mfma_f32_16x16x32_bf16 v[12:15], v[204:207], v[128:131], v[12:15]
    buffer_load_dwordx4 v[184:187], v225, s[12:15], s50 offen offset:0
    v_mfma_f32_16x16x32_bf16 v[44:47], v[204:207], v[132:135], v[44:47]
    v_mfma_f32_16x16x32_bf16 v[76:79], v[204:207], v[136:139], v[76:79]
    v_mfma_f32_16x16x32_bf16 v[108:111], v[204:207], v[140:143], v[108:111]
    ds_read_b64_tr_b16 v[204:205], v229 offset:16384
    ds_read_b64_tr_b16 v[206:207], v229 offset:20480
    s_waitcnt lgkmcnt(14)
    v_mfma_f32_16x16x32_bf16 v[16:19], v[208:211], v[128:131], v[16:19]
    v_mfma_f32_16x16x32_bf16 v[48:51], v[208:211], v[132:135], v[48:51]
    v_mfma_f32_16x16x32_bf16 v[80:83], v[208:211], v[136:139], v[80:83]
    buffer_load_dwordx4 v[188:191], v225, s[12:15], s50 offen offset:1024
    v_mfma_f32_16x16x32_bf16 v[112:115], v[208:211], v[140:143], v[112:115]
    ds_read_b64_tr_b16 v[208:209], v230 offset:16384
    ds_read_b64_tr_b16 v[210:211], v230 offset:20480
    s_waitcnt lgkmcnt(14)
    v_mfma_f32_16x16x32_bf16 v[20:23], v[212:215], v[128:131], v[20:23]
    v_mfma_f32_16x16x32_bf16 v[52:55], v[212:215], v[132:135], v[52:55]
    v_mfma_f32_16x16x32_bf16 v[84:87], v[212:215], v[136:139], v[84:87]
    v_mfma_f32_16x16x32_bf16 v[116:119], v[212:215], v[140:143], v[116:119]
    ds_read_b64_tr_b16 v[212:213], v231 offset:16384
    ds_read_b64_tr_b16 v[214:215], v231 offset:20480
    s_waitcnt lgkmcnt(14)
    v_mfma_f32_16x16x32_bf16 v[24:27], v[216:219], v[128:131], v[24:27]
    v_mfma_f32_16x16x32_bf16 v[56:59], v[216:219], v[132:135], v[56:59]
    s_add_u32 s50, s50, 8192
    v_mfma_f32_16x16x32_bf16 v[88:91], v[216:219], v[136:139], v[88:91]
    v_mfma_f32_16x16x32_bf16 v[120:123], v[216:219], v[140:143], v[120:123]
    ds_read_b64_tr_b16 v[216:217], v232 offset:16384
    ds_read_b64_tr_b16 v[218:219], v232 offset:20480
    s_waitcnt lgkmcnt(14)
    v_mfma_f32_16x16x32_bf16 v[28:31], v[220:223], v[128:131], v[28:31]
    v_mfma_f32_16x16x32_bf16 v[60:63], v[220:223], v[132:135], v[60:63]
    v_mfma_f32_16x16x32_bf16 v[92:95], v[220:223], v[136:139], v[92:95]
    v_mfma_f32_16x16x32_bf16 v[124:127], v[220:223], v[140:143], v[124:127]
    ds_read_b64_tr_b16 v[220:221], v233 offset:16384
    ds_read_b64_tr_b16 v[222:223], v233 offset:20480
    s_barrier
    s_waitcnt vmcnt(11) lgkmcnt(14)
    v_mfma_f32_16x16x32_bf16 v[0:3], v[192:195], v[144:147], v[0:3]
    buffer_load_dwordx4 v[128:131], v224, s[12:15], s50 offen offset:0
    s_waitcnt vmcnt(11)
    v_mfma_f32_16x16x32_bf16 v[32:35], v[192:195], v[148:151], v[32:35]
    s_waitcnt vmcnt(10)
    v_mfma_f32_16x16x32_bf16 v[64:67], v[192:195], v[152:155], v[64:67]
    s_waitcnt vmcnt(9)
    v_mfma_f32_16x16x32_bf16 v[96:99], v[192:195], v[156:159], v[96:99]
    v_subrev_u32 v226, 65536, v226
    ds_read_b64_tr_b16 v[192:193], v226 offset:0
    ds_read_b64_tr_b16 v[194:195], v226 offset:4096
    s_waitcnt lgkmcnt(14)
    v_mfma_f32_16x16x32_bf16 v[4:7], v[196:199], v[144:147], v[4:7]
    v_mfma_f32_16x16x32_bf16 v[36:39], v[196:199], v[148:151], v[36:39]
    buffer_load_dwordx4 v[132:135], v224, s[12:15], s50 offen offset:1024
    v_mfma_f32_16x16x32_bf16 v[68:71], v[196:199], v[152:155], v[68:71]
    v_mfma_f32_16x16x32_bf16 v[100:103], v[196:199], v[156:159], v[100:103]
    v_subrev_u32 v227, 65536, v227
    ds_read_b64_tr_b16 v[196:197], v227 offset:0
    ds_read_b64_tr_b16 v[198:199], v227 offset:4096
    s_waitcnt lgkmcnt(14)
    v_mfma_f32_16x16x32_bf16 v[8:11], v[200:203], v[144:147], v[8:11]
    v_mfma_f32_16x16x32_bf16 v[40:43], v[200:203], v[148:151], v[40:43]
    v_mfma_f32_16x16x32_bf16 v[72:75], v[200:203], v[152:155], v[72:75]
    v_mfma_f32_16x16x32_bf16 v[104:107], v[200:203], v[156:159], v[104:107]
    v_subrev_u32 v228, 65536, v228
    ds_read_b64_tr_b16 v[200:201], v228 offset:0
    ds_read_b64_tr_b16 v[202:203], v228 offset:4096
    s_waitcnt lgkmcnt(14)
    v_mfma_f32_16x16x32_bf16 v[12:15], v[204:207], v[144:147], v[12:15]
    buffer_load_dwordx4 v[136:139], v225, s[12:15], s50 offen offset:0
    v_mfma_f32_16x16x32_bf16 v[44:47], v[204:207], v[148:151], v[44:47]
    v_mfma_f32_16x16x32_bf16 v[76:79], v[204:207], v[152:155], v[76:79]
    v_mfma_f32_16x16x32_bf16 v[108:111], v[204:207], v[156:159], v[108:111]
    v_subrev_u32 v229, 65536, v229
    ds_read_b64_tr_b16 v[204:205], v229 offset:0
    ds_read_b64_tr_b16 v[206:207], v229 offset:4096
    s_waitcnt lgkmcnt(14)
    v_mfma_f32_16x16x32_bf16 v[16:19], v[208:211], v[144:147], v[16:19]
    v_mfma_f32_16x16x32_bf16 v[48:51], v[208:211], v[148:151], v[48:51]
    v_mfma_f32_16x16x32_bf16 v[80:83], v[208:211], v[152:155], v[80:83]
    buffer_load_dwordx4 v[140:143], v225, s[12:15], s50 offen offset:1024
    v_mfma_f32_16x16x32_bf16 v[112:115], v[208:211], v[156:159], v[112:115]
    v_subrev_u32 v230, 65536, v230
    ds_read_b64_tr_b16 v[208:209], v230 offset:0
    ds_read_b64_tr_b16 v[210:211], v230 offset:4096
    s_waitcnt lgkmcnt(14)
    v_mfma_f32_16x16x32_bf16 v[20:23], v[212:215], v[144:147], v[20:23]
    v_mfma_f32_16x16x32_bf16 v[52:55], v[212:215], v[148:151], v[52:55]
    v_mfma_f32_16x16x32_bf16 v[84:87], v[212:215], v[152:155], v[84:87]
    v_mfma_f32_16x16x32_bf16 v[116:119], v[212:215], v[156:159], v[116:119]
    v_subrev_u32 v231, 65536, v231
    ds_read_b64_tr_b16 v[212:213], v231 offset:0
    ds_read_b64_tr_b16 v[214:215], v231 offset:4096
    s_waitcnt lgkmcnt(14)
    v_mfma_f32_16x16x32_bf16 v[24:27], v[216:219], v[144:147], v[24:27]
    v_mfma_f32_16x16x32_bf16 v[56:59], v[216:219], v[148:151], v[56:59]
    s_add_u32 s50, s50, 8192
    v_mfma_f32_16x16x32_bf16 v[88:91], v[216:219], v[152:155], v[88:91]
    v_mfma_f32_16x16x32_bf16 v[120:123], v[216:219], v[156:159], v[120:123]
    v_subrev_u32 v232, 65536, v232
    ds_read_b64_tr_b16 v[216:217], v232 offset:0
    ds_read_b64_tr_b16 v[218:219], v232 offset:4096
    s_waitcnt lgkmcnt(14)
    v_mfma_f32_16x16x32_bf16 v[28:31], v[220:223], v[144:147], v[28:31]
    v_mfma_f32_16x16x32_bf16 v[60:63], v[220:223], v[148:151], v[60:63]
    v_mfma_f32_16x16x32_bf16 v[92:95], v[220:223], v[152:155], v[92:95]
    v_mfma_f32_16x16x32_bf16 v[124:127], v[220:223], v[156:159], v[124:127]
    v_subrev_u32 v233, 65536, v233
    ds_read_b64_tr_b16 v[220:221], v233 offset:0
    ds_read_b64_tr_b16 v[222:223], v233 offset:4096
    s_barrier
    s_waitcnt vmcnt(11) lgkmcnt(14)
    v_mfma_f32_16x16x32_bf16 v[0:3], v[192:195], v[160:163], v[0:3]
    buffer_load_dwordx4 v[144:147], v224, s[12:15], s50 offen offset:0
    s_waitcnt vmcnt(11)
    v_mfma_f32_16x16x32_bf16 v[32:35], v[192:195], v[164:167], v[32:35]
    s_waitcnt vmcnt(10)
    v_mfma_f32_16x16x32_bf16 v[64:67], v[192:195], v[168:171], v[64:67]
    s_waitcnt vmcnt(9)
    v_mfma_f32_16x16x32_bf16 v[96:99], v[192:195], v[172:175], v[96:99]
    ds_read_b64_tr_b16 v[192:193], v226 offset:16384
    ds_read_b64_tr_b16 v[194:195], v226 offset:20480
    s_waitcnt lgkmcnt(14)
    v_mfma_f32_16x16x32_bf16 v[4:7], v[196:199], v[160:163], v[4:7]
    v_mfma_f32_16x16x32_bf16 v[36:39], v[196:199], v[164:167], v[36:39]
    buffer_load_dwordx4 v[148:151], v224, s[12:15], s50 offen offset:1024
    v_mfma_f32_16x16x32_bf16 v[68:71], v[196:199], v[168:171], v[68:71]
    v_mfma_f32_16x16x32_bf16 v[100:103], v[196:199], v[172:175], v[100:103]
    ds_read_b64_tr_b16 v[196:197], v227 offset:16384
    ds_read_b64_tr_b16 v[198:199], v227 offset:20480
    s_waitcnt lgkmcnt(14)
    v_mfma_f32_16x16x32_bf16 v[8:11], v[200:203], v[160:163], v[8:11]
    v_mfma_f32_16x16x32_bf16 v[40:43], v[200:203], v[164:167], v[40:43]
    v_mfma_f32_16x16x32_bf16 v[72:75], v[200:203], v[168:171], v[72:75]
    v_mfma_f32_16x16x32_bf16 v[104:107], v[200:203], v[172:175], v[104:107]
    ds_read_b64_tr_b16 v[200:201], v228 offset:16384
    ds_read_b64_tr_b16 v[202:203], v228 offset:20480
    s_waitcnt lgkmcnt(14)
    v_mfma_f32_16x16x32_bf16 v[12:15], v[204:207], v[160:163], v[12:15]
    buffer_load_dwordx4 v[152:155], v225, s[12:15], s50 offen offset:0
    v_mfma_f32_16x16x32_bf16 v[44:47], v[204:207], v[164:167], v[44:47]
    v_mfma_f32_16x16x32_bf16 v[76:79], v[204:207], v[168:171], v[76:79]
    v_mfma_f32_16x16x32_bf16 v[108:111], v[204:207], v[172:175], v[108:111]
    ds_read_b64_tr_b16 v[204:205], v229 offset:16384
    ds_read_b64_tr_b16 v[206:207], v229 offset:20480
    s_waitcnt lgkmcnt(14)
    v_mfma_f32_16x16x32_bf16 v[16:19], v[208:211], v[160:163], v[16:19]
    v_mfma_f32_16x16x32_bf16 v[48:51], v[208:211], v[164:167], v[48:51]
    v_mfma_f32_16x16x32_bf16 v[80:83], v[208:211], v[168:171], v[80:83]
    buffer_load_dwordx4 v[156:159], v225, s[12:15], s50 offen offset:1024
    v_mfma_f32_16x16x32_bf16 v[112:115], v[208:211], v[172:175], v[112:115]
    ds_read_b64_tr_b16 v[208:209], v230 offset:16384
    ds_read_b64_tr_b16 v[210:211], v230 offset:20480
    s_waitcnt lgkmcnt(14)
    v_mfma_f32_16x16x32_bf16 v[20:23], v[212:215], v[160:163], v[20:23]
    v_mfma_f32_16x16x32_bf16 v[52:55], v[212:215], v[164:167], v[52:55]
    v_mfma_f32_16x16x32_bf16 v[84:87], v[212:215], v[168:171], v[84:87]
    v_mfma_f32_16x16x32_bf16 v[116:119], v[212:215], v[172:175], v[116:119]
    ds_read_b64_tr_b16 v[212:213], v231 offset:16384
    ds_read_b64_tr_b16 v[214:215], v231 offset:20480
    s_waitcnt lgkmcnt(14)
    v_mfma_f32_16x16x32_bf16 v[24:27], v[216:219], v[160:163], v[24:27]
    v_mfma_f32_16x16x32_bf16 v[56:59], v[216:219], v[164:167], v[56:59]
    s_add_u32 s50, s50, 8192
    v_mfma_f32_16x16x32_bf16 v[88:91], v[216:219], v[168:171], v[88:91]
    v_mfma_f32_16x16x32_bf16 v[120:123], v[216:219], v[172:175], v[120:123]
    ds_read_b64_tr_b16 v[216:217], v232 offset:16384
    ds_read_b64_tr_b16 v[218:219], v232 offset:20480
    s_waitcnt lgkmcnt(14)
    v_mfma_f32_16x16x32_bf16 v[28:31], v[220:223], v[160:163], v[28:31]
    v_mfma_f32_16x16x32_bf16 v[60:63], v[220:223], v[164:167], v[60:63]
    v_mfma_f32_16x16x32_bf16 v[92:95], v[220:223], v[168:171], v[92:95]
    v_mfma_f32_16x16x32_bf16 v[124:127], v[220:223], v[172:175], v[124:127]
    ds_read_b64_tr_b16 v[220:221], v233 offset:16384
    ds_read_b64_tr_b16 v[222:223], v233 offset:20480
    s_barrier
    s_waitcnt vmcnt(11) lgkmcnt(14)
    v_mfma_f32_16x16x32_bf16 v[0:3], v[192:195], v[176:179], v[0:3]
    s_waitcnt vmcnt(10)
    v_mfma_f32_16x16x32_bf16 v[32:35], v[192:195], v[180:183], v[32:35]
    s_waitcnt vmcnt(9)
    v_mfma_f32_16x16x32_bf16 v[64:67], v[192:195], v[184:187], v[64:67]
    s_waitcnt vmcnt(8)
    v_mfma_f32_16x16x32_bf16 v[96:99], v[192:195], v[188:191], v[96:99]
    ds_read_b64_tr_b16 v[192:193], v226 offset:32768
    ds_read_b64_tr_b16 v[194:195], v226 offset:36864
    s_waitcnt lgkmcnt(14)
    v_mfma_f32_16x16x32_bf16 v[4:7], v[196:199], v[176:179], v[4:7]
    v_mfma_f32_16x16x32_bf16 v[36:39], v[196:199], v[180:183], v[36:39]
    v_mfma_f32_16x16x32_bf16 v[68:71], v[196:199], v[184:187], v[68:71]
    v_mfma_f32_16x16x32_bf16 v[100:103], v[196:199], v[188:191], v[100:103]
    ds_read_b64_tr_b16 v[196:197], v227 offset:32768
    ds_read_b64_tr_b16 v[198:199], v227 offset:36864
    s_waitcnt lgkmcnt(14)
    v_mfma_f32_16x16x32_bf16 v[8:11], v[200:203], v[176:179], v[8:11]
    v_mfma_f32_16x16x32_bf16 v[40:43], v[200:203], v[180:183], v[40:43]
    v_mfma_f32_16x16x32_bf16 v[72:75], v[200:203], v[184:187], v[72:75]
    v_mfma_f32_16x16x32_bf16 v[104:107], v[200:203], v[188:191], v[104:107]
    ds_read_b64_tr_b16 v[200:201], v228 offset:32768
    ds_read_b64_tr_b16 v[202:203], v228 offset:36864
    s_waitcnt lgkmcnt(14)
    v_mfma_f32_16x16x32_bf16 v[12:15], v[204:207], v[176:179], v[12:15]
    v_mfma_f32_16x16x32_bf16 v[44:47], v[204:207], v[180:183], v[44:47]
    v_mfma_f32_16x16x32_bf16 v[76:79], v[204:207], v[184:187], v[76:79]
    v_mfma_f32_16x16x32_bf16 v[108:111], v[204:207], v[188:191], v[108:111]
    ds_read_b64_tr_b16 v[204:205], v229 offset:32768
    ds_read_b64_tr_b16 v[206:207], v229 offset:36864
    s_waitcnt lgkmcnt(14)
    v_mfma_f32_16x16x32_bf16 v[16:19], v[208:211], v[176:179], v[16:19]
    v_mfma_f32_16x16x32_bf16 v[48:51], v[208:211], v[180:183], v[48:51]
    v_mfma_f32_16x16x32_bf16 v[80:83], v[208:211], v[184:187], v[80:83]
    v_mfma_f32_16x16x32_bf16 v[112:115], v[208:211], v[188:191], v[112:115]
    ds_read_b64_tr_b16 v[208:209], v230 offset:32768
    ds_read_b64_tr_b16 v[210:211], v230 offset:36864
    s_waitcnt lgkmcnt(14)
    v_mfma_f32_16x16x32_bf16 v[20:23], v[212:215], v[176:179], v[20:23]
    v_mfma_f32_16x16x32_bf16 v[52:55], v[212:215], v[180:183], v[52:55]
    v_mfma_f32_16x16x32_bf16 v[84:87], v[212:215], v[184:187], v[84:87]
    v_mfma_f32_16x16x32_bf16 v[116:119], v[212:215], v[188:191], v[116:119]
    ds_read_b64_tr_b16 v[212:213], v231 offset:32768
    ds_read_b64_tr_b16 v[214:215], v231 offset:36864
    s_waitcnt lgkmcnt(14)
    v_mfma_f32_16x16x32_bf16 v[24:27], v[216:219], v[176:179], v[24:27]
    v_mfma_f32_16x16x32_bf16 v[56:59], v[216:219], v[180:183], v[56:59]
    v_mfma_f32_16x16x32_bf16 v[88:91], v[216:219], v[184:187], v[88:91]
    v_mfma_f32_16x16x32_bf16 v[120:123], v[216:219], v[188:191], v[120:123]
    ds_read_b64_tr_b16 v[216:217], v232 offset:32768
    ds_read_b64_tr_b16 v[218:219], v232 offset:36864
    s_waitcnt lgkmcnt(14)
    v_mfma_f32_16x16x32_bf16 v[28:31], v[220:223], v[176:179], v[28:31]
    v_mfma_f32_16x16x32_bf16 v[60:63], v[220:223], v[180:183], v[60:63]
    v_mfma_f32_16x16x32_bf16 v[92:95], v[220:223], v[184:187], v[92:95]
    v_mfma_f32_16x16x32_bf16 v[124:127], v[220:223], v[188:191], v[124:127]
    ds_read_b64_tr_b16 v[220:221], v233 offset:32768
    ds_read_b64_tr_b16 v[222:223], v233 offset:36864
    s_barrier
    s_waitcnt vmcnt(7) lgkmcnt(14)
    v_mfma_f32_16x16x32_bf16 v[0:3], v[192:195], v[128:131], v[0:3]
    s_waitcnt vmcnt(6)
    v_mfma_f32_16x16x32_bf16 v[32:35], v[192:195], v[132:135], v[32:35]
    s_waitcnt vmcnt(5)
    v_mfma_f32_16x16x32_bf16 v[64:67], v[192:195], v[136:139], v[64:67]
    s_waitcnt vmcnt(4)
    v_mfma_f32_16x16x32_bf16 v[96:99], v[192:195], v[140:143], v[96:99]
    ds_read_b64_tr_b16 v[192:193], v226 offset:49152
    ds_read_b64_tr_b16 v[194:195], v226 offset:53248
    s_waitcnt lgkmcnt(14)
    v_mfma_f32_16x16x32_bf16 v[4:7], v[196:199], v[128:131], v[4:7]
    v_mfma_f32_16x16x32_bf16 v[36:39], v[196:199], v[132:135], v[36:39]
    v_mfma_f32_16x16x32_bf16 v[68:71], v[196:199], v[136:139], v[68:71]
    v_mfma_f32_16x16x32_bf16 v[100:103], v[196:199], v[140:143], v[100:103]
    ds_read_b64_tr_b16 v[196:197], v227 offset:49152
    ds_read_b64_tr_b16 v[198:199], v227 offset:53248
    s_waitcnt lgkmcnt(14)
    v_mfma_f32_16x16x32_bf16 v[8:11], v[200:203], v[128:131], v[8:11]
    v_mfma_f32_16x16x32_bf16 v[40:43], v[200:203], v[132:135], v[40:43]
    v_mfma_f32_16x16x32_bf16 v[72:75], v[200:203], v[136:139], v[72:75]
    v_mfma_f32_16x16x32_bf16 v[104:107], v[200:203], v[140:143], v[104:107]
    ds_read_b64_tr_b16 v[200:201], v228 offset:49152
    ds_read_b64_tr_b16 v[202:203], v228 offset:53248
    s_waitcnt lgkmcnt(14)
    v_mfma_f32_16x16x32_bf16 v[12:15], v[204:207], v[128:131], v[12:15]
    v_mfma_f32_16x16x32_bf16 v[44:47], v[204:207], v[132:135], v[44:47]
    v_mfma_f32_16x16x32_bf16 v[76:79], v[204:207], v[136:139], v[76:79]
    v_mfma_f32_16x16x32_bf16 v[108:111], v[204:207], v[140:143], v[108:111]
    ds_read_b64_tr_b16 v[204:205], v229 offset:49152
    ds_read_b64_tr_b16 v[206:207], v229 offset:53248
    s_waitcnt lgkmcnt(14)
    v_mfma_f32_16x16x32_bf16 v[16:19], v[208:211], v[128:131], v[16:19]
    v_mfma_f32_16x16x32_bf16 v[48:51], v[208:211], v[132:135], v[48:51]
    v_mfma_f32_16x16x32_bf16 v[80:83], v[208:211], v[136:139], v[80:83]
    v_mfma_f32_16x16x32_bf16 v[112:115], v[208:211], v[140:143], v[112:115]
    ds_read_b64_tr_b16 v[208:209], v230 offset:49152
    ds_read_b64_tr_b16 v[210:211], v230 offset:53248
    s_waitcnt lgkmcnt(14)
    v_mfma_f32_16x16x32_bf16 v[20:23], v[212:215], v[128:131], v[20:23]
    v_mfma_f32_16x16x32_bf16 v[52:55], v[212:215], v[132:135], v[52:55]
    v_mfma_f32_16x16x32_bf16 v[84:87], v[212:215], v[136:139], v[84:87]
    v_mfma_f32_16x16x32_bf16 v[116:119], v[212:215], v[140:143], v[116:119]
    ds_read_b64_tr_b16 v[212:213], v231 offset:49152
    ds_read_b64_tr_b16 v[214:215], v231 offset:53248
    s_waitcnt lgkmcnt(14)
    v_mfma_f32_16x16x32_bf16 v[24:27], v[216:219], v[128:131], v[24:27]
    v_mfma_f32_16x16x32_bf16 v[56:59], v[216:219], v[132:135], v[56:59]
    v_mfma_f32_16x16x32_bf16 v[88:91], v[216:219], v[136:139], v[88:91]
    v_mfma_f32_16x16x32_bf16 v[120:123], v[216:219], v[140:143], v[120:123]
    ds_read_b64_tr_b16 v[216:217], v232 offset:49152
    ds_read_b64_tr_b16 v[218:219], v232 offset:53248
    s_waitcnt lgkmcnt(14)
    v_mfma_f32_16x16x32_bf16 v[28:31], v[220:223], v[128:131], v[28:31]
    v_mfma_f32_16x16x32_bf16 v[60:63], v[220:223], v[132:135], v[60:63]
    v_mfma_f32_16x16x32_bf16 v[92:95], v[220:223], v[136:139], v[92:95]
    v_mfma_f32_16x16x32_bf16 v[124:127], v[220:223], v[140:143], v[124:127]
    ds_read_b64_tr_b16 v[220:221], v233 offset:49152
    ds_read_b64_tr_b16 v[222:223], v233 offset:53248
    s_waitcnt vmcnt(3) lgkmcnt(14)
    v_mfma_f32_16x16x32_bf16 v[0:3], v[192:195], v[144:147], v[0:3]
    s_waitcnt vmcnt(2)
    v_mfma_f32_16x16x32_bf16 v[32:35], v[192:195], v[148:151], v[32:35]
    s_waitcnt vmcnt(1)
    v_mfma_f32_16x16x32_bf16 v[64:67], v[192:195], v[152:155], v[64:67]
    s_waitcnt vmcnt(0)
    v_mfma_f32_16x16x32_bf16 v[96:99], v[192:195], v[156:159], v[96:99]
    s_waitcnt lgkmcnt(12)
    v_mfma_f32_16x16x32_bf16 v[4:7], v[196:199], v[144:147], v[4:7]
    v_mfma_f32_16x16x32_bf16 v[36:39], v[196:199], v[148:151], v[36:39]
    v_mfma_f32_16x16x32_bf16 v[68:71], v[196:199], v[152:155], v[68:71]
    v_mfma_f32_16x16x32_bf16 v[100:103], v[196:199], v[156:159], v[100:103]
    s_waitcnt lgkmcnt(10)
    v_mfma_f32_16x16x32_bf16 v[8:11], v[200:203], v[144:147], v[8:11]
    v_mfma_f32_16x16x32_bf16 v[40:43], v[200:203], v[148:151], v[40:43]
    v_mfma_f32_16x16x32_bf16 v[72:75], v[200:203], v[152:155], v[72:75]
    v_mfma_f32_16x16x32_bf16 v[104:107], v[200:203], v[156:159], v[104:107]
    s_waitcnt lgkmcnt(8)
    v_mfma_f32_16x16x32_bf16 v[12:15], v[204:207], v[144:147], v[12:15]
    v_mfma_f32_16x16x32_bf16 v[44:47], v[204:207], v[148:151], v[44:47]
    v_mfma_f32_16x16x32_bf16 v[76:79], v[204:207], v[152:155], v[76:79]
    v_mfma_f32_16x16x32_bf16 v[108:111], v[204:207], v[156:159], v[108:111]
    s_waitcnt lgkmcnt(6)
    v_mfma_f32_16x16x32_bf16 v[16:19], v[208:211], v[144:147], v[16:19]
    v_mfma_f32_16x16x32_bf16 v[48:51], v[208:211], v[148:151], v[48:51]
    v_mfma_f32_16x16x32_bf16 v[80:83], v[208:211], v[152:155], v[80:83]
    v_mfma_f32_16x16x32_bf16 v[112:115], v[208:211], v[156:159], v[112:115]
    s_waitcnt lgkmcnt(4)
    v_mfma_f32_16x16x32_bf16 v[20:23], v[212:215], v[144:147], v[20:23]
    v_mfma_f32_16x16x32_bf16 v[52:55], v[212:215], v[148:151], v[52:55]
    v_mfma_f32_16x16x32_bf16 v[84:87], v[212:215], v[152:155], v[84:87]
    v_mfma_f32_16x16x32_bf16 v[116:119], v[212:215], v[156:159], v[116:119]
    s_waitcnt lgkmcnt(2)
    v_mfma_f32_16x16x32_bf16 v[24:27], v[216:219], v[144:147], v[24:27]
    v_mfma_f32_16x16x32_bf16 v[56:59], v[216:219], v[148:151], v[56:59]
    v_mfma_f32_16x16x32_bf16 v[88:91], v[216:219], v[152:155], v[88:91]
    v_mfma_f32_16x16x32_bf16 v[120:123], v[216:219], v[156:159], v[120:123]
    s_waitcnt lgkmcnt(0)
    v_mfma_f32_16x16x32_bf16 v[28:31], v[220:223], v[144:147], v[28:31]
    v_mfma_f32_16x16x32_bf16 v[60:63], v[220:223], v[148:151], v[60:63]
    v_mfma_f32_16x16x32_bf16 v[92:95], v[220:223], v[152:155], v[92:95]
    v_mfma_f32_16x16x32_bf16 v[124:127], v[220:223], v[156:159], v[124:127]
    v_add_u32 v238, 4, v234
    v_subrev_u32 v239, 6, v238
    v_min_u32 v238, v238, v239
    v_xor_b32 v239, 1, v238
    v_mul_u32_u24 v238, 16384, v238
    v_lshl_add_u32 v238, v235, 4, v238
    v_mul_u32_u24 v239, 16384, v239
    v_lshl_add_u32 v239, v235, 4, v239
    ds_write_b128 v238, v[64:67] offset:0
    ds_write_b128 v238, v[68:71] offset:1024
    ds_write_b128 v238, v[72:75] offset:2048
    ds_write_b128 v238, v[76:79] offset:3072
    ds_write_b128 v238, v[80:83] offset:4096
    ds_write_b128 v238, v[84:87] offset:5120
    ds_write_b128 v238, v[88:91] offset:6144
    ds_write_b128 v238, v[92:95] offset:7168
    ds_write_b128 v238, v[96:99] offset:8192
    ds_write_b128 v238, v[100:103] offset:9216
    ds_write_b128 v238, v[104:107] offset:10240
    ds_write_b128 v238, v[108:111] offset:11264
    ds_write_b128 v238, v[112:115] offset:12288
    ds_write_b128 v238, v[116:119] offset:13312
    ds_write_b128 v238, v[120:123] offset:14336
    ds_write_b128 v238, v[124:127] offset:15360
    v_lshl_add_u32 v238, v234, 5, v237
    v_lshlrev_b32 v238, 3, v238
    v_add_u32 v238, 98304, v238
    ds_read_b64 v[192:193], v238
    ds_read_b64 v[194:195], v238 offset:128
    v_lshlrev_b32 v238, 4, v236
    v_add_u32 v238, 99328, v238
    ds_read_b128 v[128:131], v238 offset:0
    ds_read_b128 v[132:135], v238 offset:512
    ds_read_b128 v[136:139], v238 offset:64
    ds_read_b128 v[140:143], v238 offset:576
    ds_read_b128 v[144:147], v238 offset:128
    ds_read_b128 v[148:151], v238 offset:640
    ds_read_b128 v[152:155], v238 offset:192
    ds_read_b128 v[156:159], v238 offset:704
    ds_read_b128 v[160:163], v238 offset:256
    ds_read_b128 v[164:167], v238 offset:768
    ds_read_b128 v[168:171], v238 offset:320
    ds_read_b128 v[172:175], v238 offset:832
    ds_read_b128 v[176:179], v238 offset:384
    ds_read_b128 v[180:183], v238 offset:896
    ds_read_b128 v[184:187], v238 offset:448
    ds_read_b128 v[188:191], v238 offset:960
    s_waitcnt lgkmcnt(0)
    s_barrier
    ds_read_b128 v[64:67], v239 offset:0
    ds_read_b128 v[68:71], v239 offset:1024
    ds_read_b128 v[72:75], v239 offset:2048
    ds_read_b128 v[76:79], v239 offset:3072
    ds_read_b128 v[80:83], v239 offset:4096
    ds_read_b128 v[84:87], v239 offset:5120
    ds_read_b128 v[88:91], v239 offset:6144
    ds_read_b128 v[92:95], v239 offset:7168
    ds_read_b128 v[96:99], v239 offset:8192
    ds_read_b128 v[100:103], v239 offset:9216
    ds_read_b128 v[104:107], v239 offset:10240
    ds_read_b128 v[108:111], v239 offset:11264
    ds_read_b128 v[112:115], v239 offset:12288
    ds_read_b128 v[116:119], v239 offset:13312
    ds_read_b128 v[120:123], v239 offset:14336
    ds_read_b128 v[124:127], v239 offset:15360
    v_and_b32 v240, 1, v234
    v_lshlrev_b32 v240, 11, v240
    v_lshl_add_u32 v240, v235, 4, v240
    s_lshl_b32 s53, s48, 14
    v_pk_fma_f32 v[196:197], v[128:129], v[192:193], v[132:133] op_sel:[0,1,0] op_sel_hi:[1,1,1]
    v_pk_fma_f32 v[198:199], v[130:131], v[192:193], v[134:135] op_sel:[0,1,0] op_sel_hi:[1,1,1]
    s_waitcnt lgkmcnt(14)
    v_pk_add_f32 v[0:1], v[0:1], v[64:65]
    v_pk_add_f32 v[2:3], v[2:3], v[66:67]
    v_pk_fma_f32 v[0:1], v[0:1], v[192:193], v[196:197] op_sel:[0,0,0] op_sel_hi:[1,0,1]
    v_pk_fma_f32 v[2:3], v[2:3], v[192:193], v[198:199] op_sel:[0,0,0] op_sel_hi:[1,0,1]
    v_max_f32 v0, 0, v0
    v_max_f32 v1, 0, v1
    v_max_f32 v2, 0, v2
    v_max_f32 v3, 0, v3
    v_pk_mul_f32 v[0:1], v[0:1], v[0:1]
    v_pk_mul_f32 v[2:3], v[2:3], v[2:3]
    v_cvt_pk_bf16_f32 v64, v0, v1
    v_cvt_pk_bf16_f32 v65, v2, v3
    v_pk_fma_f32 v[196:197], v[136:137], v[192:193], v[140:141] op_sel:[0,1,0] op_sel_hi:[1,1,1]
    v_pk_fma_f32 v[198:199], v[138:139], v[192:193], v[142:143] op_sel:[0,1,0] op_sel_hi:[1,1,1]
    s_waitcnt lgkmcnt(14)
    v_pk_add_f32 v[4:5], v[4:5], v[68:69]
    v_pk_add_f32 v[6:7], v[6:7], v[70:71]
    v_pk_fma_f32 v[4:5], v[4:5], v[192:193], v[196:197] op_sel:[0,0,0] op_sel_hi:[1,0,1]
    v_pk_fma_f32 v[6:7], v[6:7], v[192:193], v[198:199] op_sel:[0,0,0] op_sel_hi:[1,0,1]
    v_max_f32 v4, 0, v4
    v_max_f32 v5, 0, v5
    v_max_f32 v6, 0, v6
    v_max_f32 v7, 0, v7
    v_pk_mul_f32 v[4:5], v[4:5], v[4:5]
    v_pk_mul_f32 v[6:7], v[6:7], v[6:7]
    v_cvt_pk_bf16_f32 v66, v4, v5
    v_cvt_pk_bf16_f32 v67, v6, v7
    buffer_store_dwordx4 v[64:67], v240, s[24:27], s53 offen offset:0 sc1
    s_add_u32 s53, s53, 4096
    v_pk_fma_f32 v[196:197], v[144:145], v[192:193], v[148:149] op_sel:[0,1,0] op_sel_hi:[1,1,1]
    v_pk_fma_f32 v[198:199], v[146:147], v[192:193], v[150:151] op_sel:[0,1,0] op_sel_hi:[1,1,1]
    s_waitcnt lgkmcnt(13)
    v_pk_add_f32 v[8:9], v[8:9], v[72:73]
    v_pk_add_f32 v[10:11], v[10:11], v[74:75]
    v_pk_fma_f32 v[8:9], v[8:9], v[192:193], v[196:197] op_sel:[0,0,0] op_sel_hi:[1,0,1]
    v_pk_fma_f32 v[10:11], v[10:11], v[192:193], v[198:199] op_sel:[0,0,0] op_sel_hi:[1,0,1]
    v_max_f32 v8, 0, v8
    v_max_f32 v9, 0, v9
    v_max_f32 v10, 0, v10
    v_max_f32 v11, 0, v11
    v_pk_mul_f32 v[8:9], v[8:9], v[8:9]
    v_pk_mul_f32 v[10:11], v[10:11], v[10:11]
    v_cvt_pk_bf16_f32 v72, v8, v9
    v_cvt_pk_bf16_f32 v73, v10, v11
    v_pk_fma_f32 v[196:197], v[152:153], v[192:193], v[156:157] op_sel:[0,1,0] op_sel_hi:[1,1,1]
    v_pk_fma_f32 v[198:199], v[154:155], v[192:193], v[158:159] op_sel:[0,1,0] op_sel_hi:[1,1,1]
    s_waitcnt lgkmcnt(12)
    v_pk_add_f32 v[12:13], v[12:13], v[76:77]
    v_pk_add_f32 v[14:15], v[14:15], v[78:79]
    v_pk_fma_f32 v[12:13], v[12:13], v[192:193], v[196:197] op_sel:[0,0,0] op_sel_hi:[1,0,1]
    v_pk_fma_f32 v[14:15], v[14:15], v[192:193], v[198:199] op_sel:[0,0,0] op_sel_hi:[1,0,1]
    v_max_f32 v12, 0, v12
    v_max_f32 v13, 0, v13
    v_max_f32 v14, 0, v14
    v_max_f32 v15, 0, v15
    v_pk_mul_f32 v[12:13], v[12:13], v[12:13]
    v_pk_mul_f32 v[14:15], v[14:15], v[14:15]
    v_cvt_pk_bf16_f32 v74, v12, v13
    v_cvt_pk_bf16_f32 v75, v14, v15
    buffer_store_dwordx4 v[72:75], v240, s[24:27], s53 offen offset:0 sc1
    s_add_u32 s53, s53, 4096
    v_pk_fma_f32 v[196:197], v[160:161], v[192:193], v[164:165] op_sel:[0,1,0] op_sel_hi:[1,1,1]
    v_pk_fma_f32 v[198:199], v[162:163], v[192:193], v[166:167] op_sel:[0,1,0] op_sel_hi:[1,1,1]
    s_waitcnt lgkmcnt(11)
    v_pk_add_f32 v[16:17], v[16:17], v[80:81]
    v_pk_add_f32 v[18:19], v[18:19], v[82:83]
    v_pk_fma_f32 v[16:17], v[16:17], v[192:193], v[196:197] op_sel:[0,0,0] op_sel_hi:[1,0,1]
    v_pk_fma_f32 v[18:19], v[18:19], v[192:193], v[198:199] op_sel:[0,0,0] op_sel_hi:[1,0,1]
    v_max_f32 v16, 0, v16
    v_max_f32 v17, 0, v17
    v_max_f32 v18, 0, v18
    v_max_f32 v19, 0, v19
    v_pk_mul_f32 v[16:17], v[16:17], v[16:17]
    v_pk_mul_f32 v[18:19], v[18:19], v[18:19]
    v_cvt_pk_bf16_f32 v80, v16, v17
    v_cvt_pk_bf16_f32 v81, v18, v19
    v_pk_fma_f32 v[196:197], v[168:169], v[192:193], v[172:173] op_sel:[0,1,0] op_sel_hi:[1,1,1]
    v_pk_fma_f32 v[198:199], v[170:171], v[192:193], v[174:175] op_sel:[0,1,0] op_sel_hi:[1,1,1]
    s_waitcnt lgkmcnt(10)
    v_pk_add_f32 v[20:21], v[20:21], v[84:85]
    v_pk_add_f32 v[22:23], v[22:23], v[86:87]
    v_pk_fma_f32 v[20:21], v[20:21], v[192:193], v[196:197] op_sel:[0,0,0] op_sel_hi:[1,0,1]
    v_pk_fma_f32 v[22:23], v[22:23], v[192:193], v[198:199] op_sel:[0,0,0] op_sel_hi:[1,0,1]
    v_max_f32 v20, 0, v20
    v_max_f32 v21, 0, v21
    v_max_f32 v22, 0, v22
    v_max_f32 v23, 0, v23
    v_pk_mul_f32 v[20:21], v[20:21], v[20:21]
    v_pk_mul_f32 v[22:23], v[22:23], v[22:23]
    v_cvt_pk_bf16_f32 v82, v20, v21
    v_cvt_pk_bf16_f32 v83, v22, v23
    buffer_store_dwordx4 v[80:83], v240, s[24:27], s53 offen offset:0 sc1
    s_add_u32 s53, s53, 4096
    v_pk_fma_f32 v[196:197], v[176:177], v[192:193], v[180:181] op_sel:[0,1,0] op_sel_hi:[1,1,1]
    v_pk_fma_f32 v[198:199], v[178:179], v[192:193], v[182:183] op_sel:[0,1,0] op_sel_hi:[1,1,1]
    s_waitcnt lgkmcnt(9)
    v_pk_add_f32 v[24:25], v[24:25], v[88:89]
    v_pk_add_f32 v[26:27], v[26:27], v[90:91]
    v_pk_fma_f32 v[24:25], v[24:25], v[192:193], v[196:197] op_sel:[0,0,0] op_sel_hi:[1,0,1]
    v_pk_fma_f32 v[26:27], v[26:27], v[192:193], v[198:199] op_sel:[0,0,0] op_sel_hi:[1,0,1]
    v_max_f32 v24, 0, v24
    v_max_f32 v25, 0, v25
    v_max_f32 v26, 0, v26
    v_max_f32 v27, 0, v27
    v_pk_mul_f32 v[24:25], v[24:25], v[24:25]
    v_pk_mul_f32 v[26:27], v[26:27], v[26:27]
    v_cvt_pk_bf16_f32 v88, v24, v25
    v_cvt_pk_bf16_f32 v89, v26, v27
    v_pk_fma_f32 v[196:197], v[184:185], v[192:193], v[188:189] op_sel:[0,1,0] op_sel_hi:[1,1,1]
    v_pk_fma_f32 v[198:199], v[186:187], v[192:193], v[190:191] op_sel:[0,1,0] op_sel_hi:[1,1,1]
    s_waitcnt lgkmcnt(8)
    v_pk_add_f32 v[28:29], v[28:29], v[92:93]
    v_pk_add_f32 v[30:31], v[30:31], v[94:95]
    v_pk_fma_f32 v[28:29], v[28:29], v[192:193], v[196:197] op_sel:[0,0,0] op_sel_hi:[1,0,1]
    v_pk_fma_f32 v[30:31], v[30:31], v[192:193], v[198:199] op_sel:[0,0,0] op_sel_hi:[1,0,1]
    v_max_f32 v28, 0, v28
    v_max_f32 v29, 0, v29
    v_max_f32 v30, 0, v30
    v_max_f32 v31, 0, v31
    v_pk_mul_f32 v[28:29], v[28:29], v[28:29]
    v_pk_mul_f32 v[30:31], v[30:31], v[30:31]
    v_cvt_pk_bf16_f32 v90, v28, v29
    v_cvt_pk_bf16_f32 v91, v30, v31
    buffer_store_dwordx4 v[88:91], v240, s[24:27], s53 offen offset:0 sc1
    s_add_u32 s53, s53, -12288
    v_pk_fma_f32 v[196:197], v[128:129], v[194:195], v[132:133] op_sel:[0,1,0] op_sel_hi:[1,1,1]
    v_pk_fma_f32 v[198:199], v[130:131], v[194:195], v[134:135] op_sel:[0,1,0] op_sel_hi:[1,1,1]
    s_waitcnt lgkmcnt(7)
    v_pk_add_f32 v[32:33], v[32:33], v[96:97]
    v_pk_add_f32 v[34:35], v[34:35], v[98:99]
    v_pk_fma_f32 v[32:33], v[32:33], v[194:195], v[196:197] op_sel:[0,0,0] op_sel_hi:[1,0,1]
    v_pk_fma_f32 v[34:35], v[34:35], v[194:195], v[198:199] op_sel:[0,0,0] op_sel_hi:[1,0,1]
    v_max_f32 v32, 0, v32
    v_max_f32 v33, 0, v33
    v_max_f32 v34, 0, v34
    v_max_f32 v35, 0, v35
    v_pk_mul_f32 v[32:33], v[32:33], v[32:33]
    v_pk_mul_f32 v[34:35], v[34:35], v[34:35]
    v_cvt_pk_bf16_f32 v96, v32, v33
    v_cvt_pk_bf16_f32 v97, v34, v35
    v_pk_fma_f32 v[196:197], v[136:137], v[194:195], v[140:141] op_sel:[0,1,0] op_sel_hi:[1,1,1]
    v_pk_fma_f32 v[198:199], v[138:139], v[194:195], v[142:143] op_sel:[0,1,0] op_sel_hi:[1,1,1]
    s_waitcnt lgkmcnt(6)
    v_pk_add_f32 v[36:37], v[36:37], v[100:101]
    v_pk_add_f32 v[38:39], v[38:39], v[102:103]
    v_pk_fma_f32 v[36:37], v[36:37], v[194:195], v[196:197] op_sel:[0,0,0] op_sel_hi:[1,0,1]
    v_pk_fma_f32 v[38:39], v[38:39], v[194:195], v[198:199] op_sel:[0,0,0] op_sel_hi:[1,0,1]
    v_max_f32 v36, 0, v36
    v_max_f32 v37, 0, v37
    v_max_f32 v38, 0, v38
    v_max_f32 v39, 0, v39
    v_pk_mul_f32 v[36:37], v[36:37], v[36:37]
    v_pk_mul_f32 v[38:39], v[38:39], v[38:39]
    v_cvt_pk_bf16_f32 v98, v36, v37
    v_cvt_pk_bf16_f32 v99, v38, v39
    buffer_store_dwordx4 v[96:99], v240, s[24:27], s53 offen offset:1024 sc1
    s_add_u32 s53, s53, 4096
    v_pk_fma_f32 v[196:197], v[144:145], v[194:195], v[148:149] op_sel:[0,1,0] op_sel_hi:[1,1,1]
    v_pk_fma_f32 v[198:199], v[146:147], v[194:195], v[150:151] op_sel:[0,1,0] op_sel_hi:[1,1,1]
    s_waitcnt lgkmcnt(5)
    v_pk_add_f32 v[40:41], v[40:41], v[104:105]
    v_pk_add_f32 v[42:43], v[42:43], v[106:107]
    v_pk_fma_f32 v[40:41], v[40:41], v[194:195], v[196:197] op_sel:[0,0,0] op_sel_hi:[1,0,1]
    v_pk_fma_f32 v[42:43], v[42:43], v[194:195], v[198:199] op_sel:[0,0,0] op_sel_hi:[1,0,1]
    v_max_f32 v40, 0, v40
    v_max_f32 v41, 0, v41
    v_max_f32 v42, 0, v42
    v_max_f32 v43, 0, v43
    v_pk_mul_f32 v[40:41], v[40:41], v[40:41]
    v_pk_mul_f32 v[42:43], v[42:43], v[42:43]
    v_cvt_pk_bf16_f32 v104, v40, v41
    v_cvt_pk_bf16_f32 v105, v42, v43
    v_pk_fma_f32 v[196:197], v[152:153], v[194:195], v[156:157] op_sel:[0,1,0] op_sel_hi:[1,1,1]
    v_pk_fma_f32 v[198:199], v[154:155], v[194:195], v[158:159] op_sel:[0,1,0] op_sel_hi:[1,1,1]
    s_waitcnt lgkmcnt(4)
    v_pk_add_f32 v[44:45], v[44:45], v[108:109]
    v_pk_add_f32 v[46:47], v[46:47], v[110:111]
    v_pk_fma_f32 v[44:45], v[44:45], v[194:195], v[196:197] op_sel:[0,0,0] op_sel_hi:[1,0,1]
    v_pk_fma_f32 v[46:47], v[46:47], v[194:195], v[198:199] op_sel:[0,0,0] op_sel_hi:[1,0,1]
    v_max_f32 v44, 0, v44
    v_max_f32 v45, 0, v45
    v_max_f32 v46, 0, v46
    v_max_f32 v47, 0, v47
    v_pk_mul_f32 v[44:45], v[44:45], v[44:45]
    v_pk_mul_f32 v[46:47], v[46:47], v[46:47]
    v_cvt_pk_bf16_f32 v106, v44, v45
    v_cvt_pk_bf16_f32 v107, v46, v47
    buffer_store_dwordx4 v[104:107], v240, s[24:27], s53 offen offset:1024 sc1
    s_add_u32 s53, s53, 4096
    v_pk_fma_f32 v[196:197], v[160:161], v[194:195], v[164:165] op_sel:[0,1,0] op_sel_hi:[1,1,1]
    v_pk_fma_f32 v[198:199], v[162:163], v[194:195], v[166:167] op_sel:[0,1,0] op_sel_hi:[1,1,1]
    s_waitcnt lgkmcnt(3)
    v_pk_add_f32 v[48:49], v[48:49], v[112:113]
    v_pk_add_f32 v[50:51], v[50:51], v[114:115]
    v_pk_fma_f32 v[48:49], v[48:49], v[194:195], v[196:197] op_sel:[0,0,0] op_sel_hi:[1,0,1]
    v_pk_fma_f32 v[50:51], v[50:51], v[194:195], v[198:199] op_sel:[0,0,0] op_sel_hi:[1,0,1]
    v_max_f32 v48, 0, v48
    v_max_f32 v49, 0, v49
    v_max_f32 v50, 0, v50
    v_max_f32 v51, 0, v51
    v_pk_mul_f32 v[48:49], v[48:49], v[48:49]
    v_pk_mul_f32 v[50:51], v[50:51], v[50:51]
    v_cvt_pk_bf16_f32 v112, v48, v49
    v_cvt_pk_bf16_f32 v113, v50, v51
    v_pk_fma_f32 v[196:197], v[168:169], v[194:195], v[172:173] op_sel:[0,1,0] op_sel_hi:[1,1,1]
    v_pk_fma_f32 v[198:199], v[170:171], v[194:195], v[174:175] op_sel:[0,1,0] op_sel_hi:[1,1,1]
    s_waitcnt lgkmcnt(2)
    v_pk_add_f32 v[52:53], v[52:53], v[116:117]
    v_pk_add_f32 v[54:55], v[54:55], v[118:119]
    v_pk_fma_f32 v[52:53], v[52:53], v[194:195], v[196:197] op_sel:[0,0,0] op_sel_hi:[1,0,1]
    v_pk_fma_f32 v[54:55], v[54:55], v[194:195], v[198:199] op_sel:[0,0,0] op_sel_hi:[1,0,1]
    v_max_f32 v52, 0, v52
    v_max_f32 v53, 0, v53
    v_max_f32 v54, 0, v54
    v_max_f32 v55, 0, v55
    v_pk_mul_f32 v[52:53], v[52:53], v[52:53]
    v_pk_mul_f32 v[54:55], v[54:55], v[54:55]
    v_cvt_pk_bf16_f32 v114, v52, v53
    v_cvt_pk_bf16_f32 v115, v54, v55
    buffer_store_dwordx4 v[112:115], v240, s[24:27], s53 offen offset:1024 sc1
    s_add_u32 s53, s53, 4096
    v_pk_fma_f32 v[196:197], v[176:177], v[194:195], v[180:181] op_sel:[0,1,0] op_sel_hi:[1,1,1]
    v_pk_fma_f32 v[198:199], v[178:179], v[194:195], v[182:183] op_sel:[0,1,0] op_sel_hi:[1,1,1]
    s_waitcnt lgkmcnt(1)
    v_pk_add_f32 v[56:57], v[56:57], v[120:121]
    v_pk_add_f32 v[58:59], v[58:59], v[122:123]
    v_pk_fma_f32 v[56:57], v[56:57], v[194:195], v[196:197] op_sel:[0,0,0] op_sel_hi:[1,0,1]
    v_pk_fma_f32 v[58:59], v[58:59], v[194:195], v[198:199] op_sel:[0,0,0] op_sel_hi:[1,0,1]
    v_max_f32 v56, 0, v56
    v_max_f32 v57, 0, v57
    v_max_f32 v58, 0, v58
    v_max_f32 v59, 0, v59
    v_pk_mul_f32 v[56:57], v[56:57], v[56:57]
    v_pk_mul_f32 v[58:59], v[58:59], v[58:59]
    v_cvt_pk_bf16_f32 v120, v56, v57
    v_cvt_pk_bf16_f32 v121, v58, v59
    v_pk_fma_f32 v[196:197], v[184:185], v[194:195], v[188:189] op_sel:[0,1,0] op_sel_hi:[1,1,1]
    v_pk_fma_f32 v[198:199], v[186:187], v[194:195], v[190:191] op_sel:[0,1,0] op_sel_hi:[1,1,1]
    s_waitcnt lgkmcnt(0)
    v_pk_add_f32 v[60:61], v[60:61], v[124:125]
    v_pk_add_f32 v[62:63], v[62:63], v[126:127]
    v_pk_fma_f32 v[60:61], v[60:61], v[194:195], v[196:197] op_sel:[0,0,0] op_sel_hi:[1,0,1]
    v_pk_fma_f32 v[62:63], v[62:63], v[194:195], v[198:199] op_sel:[0,0,0] op_sel_hi:[1,0,1]
    v_max_f32 v60, 0, v60
    v_max_f32 v61, 0, v61
    v_max_f32 v62, 0, v62
    v_max_f32 v63, 0, v63
    v_pk_mul_f32 v[60:61], v[60:61], v[60:61]
    v_pk_mul_f32 v[62:63], v[62:63], v[62:63]
    v_cvt_pk_bf16_f32 v122, v60, v61
    v_cvt_pk_bf16_f32 v123, v62, v63
    buffer_store_dwordx4 v[120:123], v240, s[24:27], s53 offen offset:1024 sc1
    s_add_u32 s53, s53, -12288
mlp1_kernel_end_1:
    s_endpgm
mlp1_kernel_ld_3:
    s_sub_u32 s44, s44, 4
    s_mul_i32 s51, s44, 4096
    v_lshrrev_b32 v238, 4, v235
    v_and_b32 v239, 15, v235
    v_lshl_add_u32 v240, v234, 4, v238
    v_mul_u32_u24 v240, 3456, v240
    v_lshlrev_b32 v238, 1, v238
    v_xor_b32 v239, v239, v238
    v_lshl_add_u32 v8, v239, 4, v240
    v_xor_b32 v239, 8, v239
    v_lshl_add_u32 v9, v239, 4, v240
    v_add_u32 v9, 12800, v9
    v_add_u32 v10, 25600, v8
    v_add_u32 v11, 25600, v9
    s_mul_i32 s53, s48, 256
    s_sub_u32 s54, 2211840, s53
    s_mov_b32 s49, 0
    s_waitcnt lgkmcnt(0)
    s_mov_b32 s16, s10
    s_mov_b32 s17, s11
    s_mov_b32 s18, 3456
    s_mov_b32 s19, 0x00020000
    s_add_u32 s8, s8, s53
    s_addc_u32 s9, s9, 0
    s_mov_b32 s10, s54
    s_mov_b32 s11, 0x00020000
    s_mov_b32 m0, s51
    s_nop 0
    buffer_load_dwordx4 v8, s[8:11], s49 offen offset:0 lds
    buffer_load_dwordx4 v9, s[8:11], s49 offen offset:1024 lds
    buffer_load_dwordx4 v10, s[8:11], s49 offen offset:2048 lds
    buffer_load_dwordx4 v11, s[8:11], s49 offen offset:3072 lds
    s_add_u32 s49, s49, 221184
    s_add_u32 m0, s51, 16384
    s_nop 0
    buffer_load_dwordx4 v8, s[8:11], s49 offen offset:0 lds
    buffer_load_dwordx4 v9, s[8:11], s49 offen offset:1024 lds
    buffer_load_dwordx4 v10, s[8:11], s49 offen offset:2048 lds
    buffer_load_dwordx4 v11, s[8:11], s49 offen offset:3072 lds
    s_add_u32 s49, s49, 221184
    s_add_u32 m0, s51, 32768
    s_nop 0
    buffer_load_dwordx4 v8, s[8:11], s49 offen offset:0 lds
    buffer_load_dwordx4 v9, s[8:11], s49 offen offset:1024 lds
    buffer_load_dwordx4 v10, s[8:11], s49 offen offset:2048 lds
    buffer_load_dwordx4 v11, s[8:11], s49 offen offset:3072 lds
    s_add_u32 s49, s49, 221184
    s_add_u32 m0, s51, 49152
    s_nop 0
    buffer_load_dwordx4 v8, s[8:11], s49 offen offset:0 lds
    buffer_load_dwordx4 v9, s[8:11], s49 offen offset:1024 lds
    buffer_load_dwordx4 v10, s[8:11], s49 offen offset:2048 lds
    buffer_load_dwordx4 v11, s[8:11], s49 offen offset:3072 lds
    s_add_u32 s49, s49, 221184
    s_add_u32 m0, s51, 65536
    s_nop 0
    buffer_load_dwordx4 v8, s[8:11], s49 offen offset:0 lds
    buffer_load_dwordx4 v9, s[8:11], s49 offen offset:1024 lds
    buffer_load_dwordx4 v10, s[8:11], s49 offen offset:2048 lds
    buffer_load_dwordx4 v11, s[8:11], s49 offen offset:3072 lds
    s_add_u32 s49, s49, 221184
    s_lshr_b32 s45, s44, 1
    s_lshl_b32 s53, s47, 10
    s_add_u32 s53, s53, 30408704
    s_lshl_b32 s54, s48, 10
    s_add_u32 s54, s54, 34603008
    s_cmp_eq_u32 s45, 0
    s_cselect_b32 s53, s53, s54
    s_cselect_b32 s38, 1, 2
    s_mov_b32 s55, 14336
    s_cselect_b32 s56, 16384, s55
    s_mul_i32 s38, s38, 115712
    s_add_u32 s36, s4, s53
    s_addc_u32 s37, s5, 0
    s_mov_b32 s39, 0x00020000
    v_and_b32 v240, 127, v241
    v_lshlrev_b32 v239, 3, v240
    v_lshlrev_b32 v238, 1, v240
    s_mov_b32 s55, 0
    s_lshl_b32 s60, s48, 8
    s_waitcnt vmcnt(16)
    s_barrier
    s_waitcnt vmcnt(12)
    s_barrier
    s_add_u32 m0, s51, 81920
    s_nop 0
    buffer_load_dwordx4 v8, s[8:11], s49 offen offset:0 lds
    buffer_load_dwordx4 v9, s[8:11], s49 offen offset:1024 lds
    buffer_load_dwordx4 v10, s[8:11], s49 offen offset:2048 lds
    buffer_load_dwordx4 v11, s[8:11], s49 offen offset:3072 lds
    s_add_u32 s49, s49, 221184
    s_waitcnt vmcnt(12)
    s_barrier
    s_mov_b32 m0, s51
    s_nop 0
    buffer_load_dwordx4 v8, s[8:11], s49 offen offset:0 lds
    buffer_load_dwordx4 v9, s[8:11], s49 offen offset:1024 lds
    buffer_load_dwordx4 v10, s[8:11], s49 offen offset:2048 lds
    buffer_load_dwordx4 v11, s[8:11], s49 offen offset:3072 lds
    s_add_u32 s49, s49, 221184
    s_waitcnt vmcnt(12)
    s_barrier
    s_add_u32 m0, s51, 16384
    s_nop 0
    buffer_load_dwordx4 v8, s[8:11], s49 offen offset:0 lds
    buffer_load_dwordx4 v9, s[8:11], s49 offen offset:1024 lds
    buffer_load_dwordx4 v10, s[8:11], s49 offen offset:2048 lds
    buffer_load_dwordx4 v11, s[8:11], s49 offen offset:3072 lds
    s_add_u32 s49, s49, 221184
    s_waitcnt vmcnt(12)
    s_barrier
    s_add_u32 m0, s51, 32768
    s_nop 0
    buffer_load_dwordx4 v8, s[8:11], s49 offen offset:0 lds
    buffer_load_dwordx4 v9, s[8:11], s49 offen offset:1024 lds
    buffer_load_dwordx4 v10, s[8:11], s49 offen offset:2048 lds
    buffer_load_dwordx4 v11, s[8:11], s49 offen offset:3072 lds
    s_add_u32 s49, s49, 221184
    s_waitcnt vmcnt(12)
    s_barrier
    s_add_u32 m0, s51, 49152
    s_nop 0
    buffer_load_dwordx4 v8, s[8:11], s49 offen offset:0 lds
    buffer_load_dwordx4 v9, s[8:11], s49 offen offset:1024 lds
    buffer_load_dwordx4 v10, s[8:11], s49 offen offset:2048 lds
    buffer_load_dwordx4 v11, s[8:11], s49 offen offset:3072 lds
    s_add_u32 s49, s49, 221184
    s_waitcnt vmcnt(12)
    s_barrier
    s_waitcnt vmcnt(8)
    s_barrier
    buffer_load_dwordx2 v[16:17], v239, s[36:39], s55 offen
    s_add_u32 s55, s55, s56
    buffer_load_dwordx2 v[18:19], v239, s[36:39], s55 offen
    s_add_u32 s55, s55, s56
    buffer_load_dwordx2 v[20:21], v239, s[36:39], s55 offen
    s_add_u32 s55, s55, s56
    buffer_load_dwordx2 v[22:23], v239, s[36:39], s55 offen
    s_add_u32 s55, s55, s56
    buffer_load_dwordx2 v[24:25], v239, s[36:39], s55 offen
    s_add_u32 s55, s55, s56
    buffer_load_dwordx2 v[26:27], v239, s[36:39], s55 offen
    s_add_u32 s55, s55, s56
    buffer_load_dwordx2 v[28:29], v239, s[36:39], s55 offen
    s_add_u32 s55, s55, s56
    buffer_load_dwordx2 v[30:31], v239, s[36:39], s55 offen
    s_add_u32 s55, s55, s56
    buffer_load_dwordx2 v[32:33], v239, s[36:39], s55 offen
    s_add_u32 s55, s55, s56
    buffer_load_dwordx2 v[34:35], v239, s[36:39], s55 offen
    s_add_u32 s55, s55, s56
    buffer_load_dwordx2 v[36:37], v239, s[36:39], s55 offen
    s_add_u32 s55, s55, s56
    buffer_load_dwordx2 v[38:39], v239, s[36:39], s55 offen
    s_add_u32 s55, s55, s56
    buffer_load_dwordx2 v[40:41], v239, s[36:39], s55 offen
    s_add_u32 s55, s55, s56
    buffer_load_dwordx2 v[42:43], v239, s[36:39], s55 offen
    s_add_u32 s55, s55, s56
    buffer_load_dwordx2 v[44:45], v239, s[36:39], s55 offen
    s_add_u32 s55, s55, s56
    buffer_load_dwordx2 v[46:47], v239, s[36:39], s55 offen
    buffer_load_ushort v48, v238, s[16:19], s60 offen
    s_waitcnt vmcnt(21)
    s_barrier
    s_waitcnt vmcnt(8)
    v_pk_add_f32 v[16:17], v[16:17], v[32:33]
    s_waitcnt vmcnt(7)
    v_pk_add_f32 v[18:19], v[18:19], v[34:35]
    s_waitcnt vmcnt(6)
    v_pk_add_f32 v[20:21], v[20:21], v[36:37]
    s_waitcnt vmcnt(5)
    v_pk_add_f32 v[22:23], v[22:23], v[38:39]
    s_waitcnt vmcnt(4)
    v_pk_add_f32 v[24:25], v[24:25], v[40:41]
    s_waitcnt vmcnt(3)
    v_pk_add_f32 v[26:27], v[26:27], v[42:43]
    s_waitcnt vmcnt(2)
    v_pk_add_f32 v[28:29], v[28:29], v[44:45]
    s_waitcnt vmcnt(1)
    v_pk_add_f32 v[30:31], v[30:31], v[46:47]
    v_pk_add_f32 v[16:17], v[16:17], v[24:25]
    v_pk_add_f32 v[18:19], v[18:19], v[26:27]
    v_pk_add_f32 v[20:21], v[20:21], v[28:29]
    v_pk_add_f32 v[22:23], v[22:23], v[30:31]
    v_pk_add_f32 v[16:17], v[16:17], v[20:21]
    v_pk_add_f32 v[18:19], v[18:19], v[22:23]
    v_pk_add_f32 v[16:17], v[16:17], v[18:19]
    s_waitcnt vmcnt(0)
    v_lshlrev_b32 v239, 16, v48
    s_cmp_lg_u32 s45, 0
    s_cbranch_scc1 mlp1_kernel_uv_4
    v_mul_f32 v16, 0x3acccccd, v16
    v_mul_f32 v17, 0x3acccccd, v17
    v_fma_f32 v17, -v16, v16, v17
    v_max_f32 v17, 0, v17
    v_add_f32 v17, 0x3727c5ac, v17
    v_rsq_f32 v18, v17
    s_nop 0
    v_mul_f32 v19, -v16, v18
    v_lshlrev_b32 v238, 3, v240
    v_add_u32 v238, 98304, v238
    ds_write_b64 v238, v[18:19]
    s_branch mlp1_kernel_jn_5
mlp1_kernel_uv_4:
    v_add_f32 v17, v17, v239
    v_lshlrev_b32 v238, 2, v240
    v_add_u32 v238, 98304, v238
    ds_write_b32 v238, v16 offset:1024
    ds_write_b32 v238, v17 offset:1536
mlp1_kernel_jn_5:
    s_waitcnt lgkmcnt(0)
    s_barrier
    s_waitcnt vmcnt(0)
    s_endpgm
.globl mlp2_kernel
.p2align 8
.type mlp2_kernel,@function
mlp2_kernel:
    s_cmp_ge_u32 s2, 256
    s_cbranch_scc1 mlp2_kernel_end_1
    s_load_dwordx2 s[4:5], s[0:1], 112
    s_load_dwordx2 s[36:37], s[0:1], 72
    s_load_dwordx2 s[24:25], s[0:1], 96
    v_lshrrev_b32 v120, 6, v0
    v_and_b32 v121, 63, v0
    v_readfirstlane_b32 s44, v120
    s_and_b32 s52, s2, 7
    s_lshr_b32 s53, s2, 3
    s_lshr_b32 s46, s52, 1
    s_lshl_b32 s46, s46, 3
    s_and_b32 s54, s53, 7
    s_add_u32 s46, s46, s54
    s_and_b32 s47, s52, 1
    s_lshl_b32 s47, s47, 2
    s_lshr_b32 s54, s53, 3
    s_add_u32 s47, s47, s54
    s_cmp_lt_u32 s44, 4
    s_cbranch_scc1 mlp2_kernel_comp_3
    s_sub_u32 s44, s44, 4
    s_mul_i32 s50, s44, 2560
    v_lshlrev_b32 v11, 4, v121
    v_add_u32 v8, s50, v11
    s_mul_i32 s52, s47, 276480
    s_add_u32 s52, s52, 52428800
    s_mov_b32 s48, 0
    s_waitcnt lgkmcnt(0)
    s_add_u32 s8, s4, s52
    s_addc_u32 s9, s5, 0
    s_mov_b32 s10, 276480
    s_mov_b32 s11, 0x00020000
    s_mov_b32 m0, s50
    s_nop 0
    buffer_load_dwordx4 v8, s[8:11], s48 offen offset:0 lds
    buffer_load_dwordx4 v8, s[8:11], s48 offen offset:1024 lds
    s_mov_b64 exec, 0xffffffff
    buffer_load_dwordx4 v8, s[8:11], s48 offen offset:2048 lds
    s_mov_b64 exec, -1
    s_add_u32 s48, s48, 20480
    s_add_u32 m0, s50, 20480
    s_nop 0
    buffer_load_dwordx4 v8, s[8:11], s48 offen offset:0 lds
    buffer_load_dwordx4 v8, s[8:11], s48 offen offset:1024 lds
    s_mov_b64 exec, 0xffffffff
    buffer_load_dwordx4 v8, s[8:11], s48 offen offset:2048 lds
    s_mov_b64 exec, -1
    s_add_u32 s48, s48, 20480
    s_add_u32 m0, s50, 40960
    s_nop 0
    buffer_load_dwordx4 v8, s[8:11], s48 offen offset:0 lds
    buffer_load_dwordx4 v8, s[8:11], s48 offen offset:1024 lds
    s_mov_b64 exec, 0xffffffff
    buffer_load_dwordx4 v8, s[8:11], s48 offen offset:2048 lds
    s_mov_b64 exec, -1
    s_add_u32 s48, s48, 20480
    s_add_u32 m0, s50, 61440
    s_nop 0
    buffer_load_dwordx4 v8, s[8:11], s48 offen offset:0 lds
    buffer_load_dwordx4 v8, s[8:11], s48 offen offset:1024 lds
    s_mov_b64 exec, 0xffffffff
    buffer_load_dwordx4 v8, s[8:11], s48 offen offset:2048 lds
    s_mov_b64 exec, -1
    s_add_u32 s48, s48, 20480
    v_subrev_u32 v164, 256, v0
    s_mov_b32 s20, s4
    s_mov_b32 s21, s5
    s_mov_b32 s22, 15360
    s_mov_b32 s23, 0x00020000
    s_mul_i32 s53, s47, 320
    s_add_u32 s53, s53, 12800
    s_lshl_b32 s55, s44, 10
    s_lshl_b32 s52, s46, 3
    s_add_u32 s52, s52, s47
    s_mul_i32 s52, s52, 10240
    s_add_u32 s52, s52, 27262976
    s_add_u32 s16, s4, s52
    s_addc_u32 s17, s5, 0
    s_mov_b32 s18, 10240
    s_mov_b32 s19, 0x00020000
    v_lshlrev_b32 v9, 4, v164
    v_add_u32 v10, 8192, v9
    s_mul_i32 s52, s47, 160
    s_add_u32 s36, s36, s52
    s_addc_u32 s37, s37, 0
    s_mov_b32 s38, 160
    s_mov_b32 s39, 0x00020000
    s_add_u32 m0, s55, 122880
    s_nop 0
    buffer_load_dwordx4 v9, s[16:19], 0 offen lds
    s_add_u32 m0, s55, 131072
    s_nop 0
    buffer_load_dwordx4 v10, s[16:19], 0 offen lds
    s_mov_b32 m0, 139264
    s_nop 0
    buffer_load_dwordx4 v11, s[20:23], s53 offen lds
    s_mov_b32 m0, 140288
    s_nop 0
    buffer_load_dwordx4 v11, s[36:39], 0 offen lds
    s_waitcnt vmcnt(13)
    s_barrier
    s_waitcnt vmcnt(10)
    s_barrier
    s_add_u32 m0, s50, 81920
    s_nop 0
    buffer_load_dwordx4 v8, s[8:11], s48 offen offset:0 lds
    buffer_load_dwordx4 v8, s[8:11], s48 offen offset:1024 lds
    s_mov_b64 exec, 0xffffffff
    buffer_load_dwordx4 v8, s[8:11], s48 offen offset:2048 lds
    s_mov_b64 exec, -1
    s_add_u32 s48, s48, 20480
    s_waitcnt vmcnt(10)
    s_barrier
    s_mov_b32 m0, s50
    s_nop 0
    buffer_load_dwordx4 v8, s[8:11], s48 offen offset:0 lds
    buffer_load_dwordx4 v8, s[8:11], s48 offen offset:1024 lds
    s_mov_b64 exec, 0xffffffff
    buffer_load_dwordx4 v8, s[8:11], s48 offen offset:2048 lds
    s_mov_b64 exec, -1
    s_add_u32 s48, s48, 20480
    s_waitcnt vmcnt(10)
    s_barrier
    s_add_u32 m0, s50, 20480
    s_nop 0
    buffer_load_dwordx4 v8, s[8:11], s48 offen offset:0 lds
    buffer_load_dwordx4 v8, s[8:11], s48 offen offset:1024 lds
    s_mov_b64 exec, 0xffffffff
    buffer_load_dwordx4 v8, s[8:11], s48 offen offset:2048 lds
    s_mov_b64 exec, -1
    s_add_u32 s48, s48, 20480
    s_waitcnt vmcnt(6)
    s_barrier
    s_add_u32 m0, s50, 40960
    s_nop 0
    buffer_load_dwordx4 v8, s[8:11], s48 offen offset:0 lds
    buffer_load_dwordx4 v8, s[8:11], s48 offen offset:1024 lds
    s_mov_b64 exec, 0xffffffff
    buffer_load_dwordx4 v8, s[8:11], s48 offen offset:2048 lds
    s_mov_b64 exec, -1
    s_add_u32 s48, s48, 20480
    s_waitcnt vmcnt(6)
    s_barrier
    s_add_u32 m0, s50, 61440
    s_nop 0
    buffer_load_dwordx4 v8, s[8:11], s48 offen offset:0 lds
    buffer_load_dwordx4 v8, s[8:11], s48 offen offset:1024 lds
    s_mov_b64 exec, 0xffffffff
    buffer_load_dwordx4 v8, s[8:11], s48 offen offset:2048 lds
    s_mov_b64 exec, -1
    s_add_u32 s48, s48, 20480
    s_waitcnt vmcnt(6)
    s_barrier
    s_add_u32 m0, s50, 81920
    s_nop 0
    buffer_load_dwordx4 v8, s[8:11], s48 offen offset:0 lds
    buffer_load_dwordx4 v8, s[8:11], s48 offen offset:1024 lds
    s_mov_b64 exec, 0xffffffff
    buffer_load_dwordx4 v8, s[8:11], s48 offen offset:2048 lds
    s_mov_b64 exec, -1
    s_add_u32 s48, s48, 20480
    s_waitcnt vmcnt(6)
    s_barrier
    s_mov_b32 m0, s50
    s_nop 0
    buffer_load_dwordx4 v8, s[8:11], s48 offen offset:0 lds
    buffer_load_dwordx4 v8, s[8:11], s48 offen offset:1024 lds
    s_mov_b64 exec, 0xffffffff
    buffer_load_dwordx4 v8, s[8:11], s48 offen offset:2048 lds
    s_mov_b64 exec, -1
    s_add_u32 s48, s48, 20480
    s_waitcnt vmcnt(6)
    s_barrier
    s_add_u32 m0, s50, 20480
    s_nop 0
    buffer_load_dwordx4 v8, s[8:11], s48 offen offset:0 lds
    buffer_load_dwordx4 v8, s[8:11], s48 offen offset:1024 lds
    s_mov_b64 exec, 0xffffffff
    buffer_load_dwordx4 v8, s[8:11], s48 offen offset:2048 lds
    s_mov_b64 exec, -1
    s_add_u32 s48, s48, 20480
    s_waitcnt vmcnt(6)
    s_barrier
    s_add_u32 m0, s50, 40960
    s_nop 0
    buffer_load_dwordx4 v8, s[8:11], s48 offen offset:0 lds
    buffer_load_dwordx4 v8, s[8:11], s48 offen offset:1024 lds
    s_mov_b64 exec, 0xffffffff
    buffer_load_dwordx4 v8, s[8:11], s48 offen offset:2048 lds
    s_mov_b64 exec, -1
    s_add_u32 s48, s48, 20480
    s_waitcnt vmcnt(6)
    s_barrier
    s_add_u32 m0, s50, 61440
    s_nop 0
    buffer_load_dwordx4 v8, s[8:11], s48 offen offset:0 lds
    buffer_load_dwordx4 v8, s[8:11], s48 offen offset:1024 lds
    s_mov_b64 exec, 0xffffffff
    buffer_load_dwordx4 v8, s[8:11], s48 offen offset:2048 lds
    s_mov_b64 exec, -1
    s_add_u32 s48, s48, 20480
    s_waitcnt vmcnt(6)
    s_barrier
    s_waitcnt vmcnt(3)
    s_barrier
    s_waitcnt vmcnt(0)
    s_barrier
    s_endpgm
mlp2_kernel_comp_3:
    v_mov_b32 v164, v0
    v_lshrrev_b32 v165, 1, v120
    v_and_b32 v166, 1, v120
    v_lshlrev_b32 v165, 11, v165
    v_lshl_add_u32 v165, v121, 4, v165
    v_mul_u32_u24 v167, 9216, v166
    v_add_u32 v160, v165, v167
    v_xor_b32 v161, 1024, v160
    s_mul_i32 s52, s46, 221184
    s_add_u32 s52, s52, 35651584
    s_mov_b32 s49, 0
    s_mov_b32 s45, 4096
    s_waitcnt lgkmcnt(0)
    s_add_u32 s12, s4, s52
    s_addc_u32 s13, s5, 0
    s_mov_b32 s14, 221184
    s_mov_b32 s15, 0x00020000
    buffer_load_dwordx4 v[40:43], v160, s[12:15], s49 offen
    buffer_load_dwordx4 v[44:47], v161, s[12:15], s49 offen
    s_add_u32 s49, s49, 16384
    buffer_load_dwordx4 v[48:51], v160, s[12:15], s45 offen
    buffer_load_dwordx4 v[52:55], v161, s[12:15], s45 offen
    s_add_u32 s45, s45, 16384
    buffer_load_dwordx4 v[56:59], v160, s[12:15], s49 offen
    buffer_load_dwordx4 v[60:63], v161, s[12:15], s49 offen
    s_add_u32 s49, s49, 16384
    buffer_load_dwordx4 v[64:67], v160, s[12:15], s45 offen
    buffer_load_dwordx4 v[68:71], v161, s[12:15], s45 offen
    s_add_u32 s45, s45, 16384
    buffer_load_dwordx4 v[72:75], v160, s[12:15], s49 offen
    buffer_load_dwordx4 v[76:79], v161, s[12:15], s49 offen
    s_add_u32 s49, s49, 16384
    buffer_load_dwordx4 v[80:83], v160, s[12:15], s45 offen
    buffer_load_dwordx4 v[84:87], v161, s[12:15], s45 offen
    s_add_u32 s45, s45, 16384
    buffer_load_dwordx4 v[88:91], v160, s[12:15], s49 offen
    buffer_load_dwordx4 v[92:95], v161, s[12:15], s49 offen
    s_add_u32 s49, s49, 16384
    buffer_load_dwordx4 v[96:99], v160, s[12:15], s45 offen
    buffer_load_dwordx4 v[100:103], v161, s[12:15], s45 offen
    s_add_u32 s45, s45, 16384
    v_lshrrev_b32 v122, 4, v121
    v_bfe_u32 v123, v121, 2, 2
    v_and_b32 v124, 3, v121
    v_lshlrev_b32 v165, 2, v122
    v_add_u32 v165, v165, v123
    v_lshl_add_u32 v166, v166, 6, v165
    v_mul_u32_u24 v166, 160, v166
    v_lshl_add_u32 v162, v124, 3, v166
    v_add_u32 v163, 61440, v162
    s_mul_i32 s54, s46, 81920
    s_mul_i32 s55, s47, 160
    s_add_u32 s54, s54, s55
    s_add_u32 s24, s24, s54
    s_addc_u32 s25, s25, 0
    s_mov_b32 s26, 81920
    s_mov_b32 s27, 0x00020000
    s_barrier
    ds_read_b64_tr_b16 v[120:121], v162 offset:0
    ds_read_b64_tr_b16 v[122:123], v162 offset:2560
    ds_read_b64_tr_b16 v[124:125], v162 offset:32
    ds_read_b64_tr_b16 v[126:127], v162 offset:2592
    ds_read_b64_tr_b16 v[128:129], v162 offset:64
    ds_read_b64_tr_b16 v[130:131], v162 offset:2624
    ds_read_b64_tr_b16 v[132:133], v162 offset:96
    ds_read_b64_tr_b16 v[134:135], v162 offset:2656
    ds_read_b64_tr_b16 v[136:137], v162 offset:128
    ds_read_b64_tr_b16 v[138:139], v162 offset:2688
    ds_read_b64_tr_b16 v[140:141], v162 offset:5120
    ds_read_b64_tr_b16 v[142:143], v162 offset:7680
    ds_read_b64_tr_b16 v[144:145], v162 offset:5152
    ds_read_b64_tr_b16 v[146:147], v162 offset:7712
    ds_read_b64_tr_b16 v[148:149], v162 offset:5184
    ds_read_b64_tr_b16 v[150:151], v162 offset:7744
    ds_read_b64_tr_b16 v[152:153], v162 offset:5216
    ds_read_b64_tr_b16 v[154:155], v162 offset:7776
    ds_read_b64_tr_b16 v[156:157], v162 offset:5248
    ds_read_b64_tr_b16 v[158:159], v162 offset:7808
    s_barrier
    s_waitcnt vmcnt(15) lgkmcnt(14)
    v_mfma_f32_16x16x32_bf16 v[0:3], v[120:123], v[40:43], 0
    buffer_load_dwordx4 v[104:107], v160, s[12:15], s49 offen
    s_waitcnt vmcnt(15)
    v_mfma_f32_16x16x32_bf16 v[20:23], v[120:123], v[44:47], 0
    ds_read_b64_tr_b16 v[120:121], v162 offset:20480
    ds_read_b64_tr_b16 v[122:123], v162 offset:23040
    s_waitcnt lgkmcnt(14)
    v_mfma_f32_16x16x32_bf16 v[4:7], v[124:127], v[40:43], 0
    buffer_load_dwordx4 v[108:111], v161, s[12:15], s49 offen
    v_mfma_f32_16x16x32_bf16 v[24:27], v[124:127], v[44:47], 0
    ds_read_b64_tr_b16 v[124:125], v162 offset:20512
    ds_read_b64_tr_b16 v[126:127], v162 offset:23072
    s_waitcnt lgkmcnt(14)
    v_mfma_f32_16x16x32_bf16 v[8:11], v[128:131], v[40:43], 0
    v_mfma_f32_16x16x32_bf16 v[28:31], v[128:131], v[44:47], 0
    ds_read_b64_tr_b16 v[128:129], v162 offset:20544
    ds_read_b64_tr_b16 v[130:131], v162 offset:23104
    s_waitcnt lgkmcnt(14)
    v_mfma_f32_16x16x32_bf16 v[12:15], v[132:135], v[40:43], 0
    s_add_u32 s49, s49, 16384
    v_mfma_f32_16x16x32_bf16 v[32:35], v[132:135], v[44:47], 0
    ds_read_b64_tr_b16 v[132:133], v162 offset:20576
    ds_read_b64_tr_b16 v[134:135], v162 offset:23136
    s_waitcnt lgkmcnt(14)
    v_mfma_f32_16x16x32_bf16 v[16:19], v[136:139], v[40:43], 0
    v_mfma_f32_16x16x32_bf16 v[36:39], v[136:139], v[44:47], 0
    ds_read_b64_tr_b16 v[136:137], v162 offset:20608
    ds_read_b64_tr_b16 v[138:139], v162 offset:23168
    s_waitcnt vmcnt(15) lgkmcnt(14)
    v_mfma_f32_16x16x32_bf16 v[0:3], v[140:143], v[48:51], v[0:3]
    buffer_load_dwordx4 v[112:115], v160, s[12:15], s45 offen
    s_waitcnt vmcnt(15)
    v_mfma_f32_16x16x32_bf16 v[20:23], v[140:143], v[52:55], v[20:23]
    ds_read_b64_tr_b16 v[140:141], v162 offset:25600
    ds_read_b64_tr_b16 v[142:143], v162 offset:28160
    s_waitcnt lgkmcnt(14)
    v_mfma_f32_16x16x32_bf16 v[4:7], v[144:147], v[48:51], v[4:7]
    buffer_load_dwordx4 v[116:119], v161, s[12:15], s45 offen
    v_mfma_f32_16x16x32_bf16 v[24:27], v[144:147], v[52:55], v[24:27]
    ds_read_b64_tr_b16 v[144:145], v162 offset:25632
    ds_read_b64_tr_b16 v[146:147], v162 offset:28192
    s_waitcnt lgkmcnt(14)
    v_mfma_f32_16x16x32_bf16 v[8:11], v[148:151], v[48:51], v[8:11]
    v_mfma_f32_16x16x32_bf16 v[28:31], v[148:151], v[52:55], v[28:31]
    ds_read_b64_tr_b16 v[148:149], v162 offset:25664
    ds_read_b64_tr_b16 v[150:151], v162 offset:28224
    s_waitcnt lgkmcnt(14)
    v_mfma_f32_16x16x32_bf16 v[12:15], v[152:155], v[48:51], v[12:15]
    s_add_u32 s45, s45, 16384
    v_mfma_f32_16x16x32_bf16 v[32:35], v[152:155], v[52:55], v[32:35]
    ds_read_b64_tr_b16 v[152:153], v162 offset:25696
    ds_read_b64_tr_b16 v[154:155], v162 offset:28256
    s_waitcnt lgkmcnt(14)
    v_mfma_f32_16x16x32_bf16 v[16:19], v[156:159], v[48:51], v[16:19]
    v_mfma_f32_16x16x32_bf16 v[36:39], v[156:159], v[52:55], v[36:39]
    ds_read_b64_tr_b16 v[156:157], v162 offset:25728
    ds_read_b64_tr_b16 v[158:159], v162 offset:28288
    s_barrier
    s_waitcnt vmcnt(15) lgkmcnt(14)
    v_mfma_f32_16x16x32_bf16 v[0:3], v[120:123], v[56:59], v[0:3]
    buffer_load_dwordx4 v[40:43], v160, s[12:15], s49 offen
    s_waitcnt vmcnt(15)
    v_mfma_f32_16x16x32_bf16 v[20:23], v[120:123], v[60:63], v[20:23]
    ds_read_b64_tr_b16 v[120:121], v162 offset:40960
    ds_read_b64_tr_b16 v[122:123], v162 offset:43520
    s_waitcnt lgkmcnt(14)
    v_mfma_f32_16x16x32_bf16 v[4:7], v[124:127], v[56:59], v[4:7]
    buffer_load_dwordx4 v[44:47], v161, s[12:15], s49 offen
    v_mfma_f32_16x16x32_bf16 v[24:27], v[124:127], v[60:63], v[24:27]
    ds_read_b64_tr_b16 v[124:125], v162 offset:40992
    ds_read_b64_tr_b16 v[126:127], v162 offset:43552
    s_waitcnt lgkmcnt(14)
    v_mfma_f32_16x16x32_bf16 v[8:11], v[128:131], v[56:59], v[8:11]
    v_mfma_f32_16x16x32_bf16 v[28:31], v[128:131], v[60:63], v[28:31]
    ds_read_b64_tr_b16 v[128:129], v162 offset:41024
    ds_read_b64_tr_b16 v[130:131], v162 offset:43584
    s_waitcnt lgkmcnt(14)
    v_mfma_f32_16x16x32_bf16 v[12:15], v[132:135], v[56:59], v[12:15]
    s_add_u32 s49, s49, 16384
    v_mfma_f32_16x16x32_bf16 v[32:35], v[132:135], v[60:63], v[32:35]
    ds_read_b64_tr_b16 v[132:133], v162 offset:41056
    ds_read_b64_tr_b16 v[134:135], v162 offset:43616
    s_waitcnt lgkmcnt(14)
    v_mfma_f32_16x16x32_bf16 v[16:19], v[136:139], v[56:59], v[16:19]
    v_mfma_f32_16x16x32_bf16 v[36:39], v[136:139], v[60:63], v[36:39]
    ds_read_b64_tr_b16 v[136:137], v162 offset:41088
    ds_read_b64_tr_b16 v[138:139], v162 offset:43648
    s_waitcnt vmcnt(15) lgkmcnt(14)
    v_mfma_f32_16x16x32_bf16 v[0:3], v[140:143], v[64:67], v[0:3]
    buffer_load_dwordx4 v[48:51], v160, s[12:15], s45 offen
    s_waitcnt vmcnt(15)
    v_mfma_f32_16x16x32_bf16 v[20:23], v[140:143], v[68:71], v[20:23]
    ds_read_b64_tr_b16 v[140:141], v162 offset:46080
    ds_read_b64_tr_b16 v[142:143], v162 offset:48640
    s_waitcnt lgkmcnt(14)
    v_mfma_f32_16x16x32_bf16 v[4:7], v[144:147], v[64:67], v[4:7]
    buffer_load_dwordx4 v[52:55], v161, s[12:15], s45 offen
    v_mfma_f32_16x16x32_bf16 v[24:27], v[144:147], v[68:71], v[24:27]
    ds_read_b64_tr_b16 v[144:145], v162 offset:46112
    ds_read_b64_tr_b16 v[146:147], v162 offset:48672
    s_waitcnt lgkmcnt(14)
    v_mfma_f32_16x16x32_bf16 v[8:11], v[148:151], v[64:67], v[8:11]
    v_mfma_f32_16x16x32_bf16 v[28:31], v[148:151], v[68:71], v[28:31]
    ds_read_b64_tr_b16 v[148:149], v162 offset:46144
    ds_read_b64_tr_b16 v[150:151], v162 offset:48704
    s_waitcnt lgkmcnt(14)
    v_mfma_f32_16x16x32_bf16 v[12:15], v[152:155], v[64:67], v[12:15]
    s_add_u32 s45, s45, 16384
    v_mfma_f32_16x16x32_bf16 v[32:35], v[152:155], v[68:71], v[32:35]
    ds_read_b64_tr_b16 v[152:153], v162 offset:46176
    ds_read_b64_tr_b16 v[154:155], v162 offset:48736
    s_waitcnt lgkmcnt(14)
    v_mfma_f32_16x16x32_bf16 v[16:19], v[156:159], v[64:67], v[16:19]
    v_mfma_f32_16x16x32_bf16 v[36:39], v[156:159], v[68:71], v[36:39]
    ds_read_b64_tr_b16 v[156:157], v162 offset:46208
    ds_read_b64_tr_b16 v[158:159], v162 offset:48768
    s_barrier
    s_waitcnt vmcnt(15) lgkmcnt(14)
    v_mfma_f32_16x16x32_bf16 v[0:3], v[120:123], v[72:75], v[0:3]
    buffer_load_dwordx4 v[56:59], v160, s[12:15], s49 offen
    s_waitcnt vmcnt(15)
    v_mfma_f32_16x16x32_bf16 v[20:23], v[120:123], v[76:79], v[20:23]
    ds_read_b64_tr_b16 v[120:121], v163 offset:0
    ds_read_b64_tr_b16 v[122:123], v163 offset:2560
    s_waitcnt lgkmcnt(14)
    v_mfma_f32_16x16x32_bf16 v[4:7], v[124:127], v[72:75], v[4:7]
    buffer_load_dwordx4 v[60:63], v161, s[12:15], s49 offen
    v_mfma_f32_16x16x32_bf16 v[24:27], v[124:127], v[76:79], v[24:27]
    ds_read_b64_tr_b16 v[124:125], v163 offset:32
    ds_read_b64_tr_b16 v[126:127], v163 offset:2592
    s_waitcnt lgkmcnt(14)
    v_mfma_f32_16x16x32_bf16 v[8:11], v[128:131], v[72:75], v[8:11]
    v_mfma_f32_16x16x32_bf16 v[28:31], v[128:131], v[76:79], v[28:31]
    ds_read_b64_tr_b16 v[128:129], v163 offset:64
    ds_read_b64_tr_b16 v[130:131], v163 offset:2624
    s_waitcnt lgkmcnt(14)
    v_mfma_f32_16x16x32_bf16 v[12:15], v[132:135], v[72:75], v[12:15]
    s_add_u32 s49, s49, 16384
    v_mfma_f32_16x16x32_bf16 v[32:35], v[132:135], v[76:79], v[32:35]
    ds_read_b64_tr_b16 v[132:133], v163 offset:96
    ds_read_b64_tr_b16 v[134:135], v163 offset:2656
    s_waitcnt lgkmcnt(14)
    v_mfma_f32_16x16x32_bf16 v[16:19], v[136:139], v[72:75], v[16:19]
    v_mfma_f32_16x16x32_bf16 v[36:39], v[136:139], v[76:79], v[36:39]
    ds_read_b64_tr_b16 v[136:137], v163 offset:128
    ds_read_b64_tr_b16 v[138:139], v163 offset:2688
    s_waitcnt vmcnt(15) lgkmcnt(14)
    v_mfma_f32_16x16x32_bf16 v[0:3], v[140:143], v[80:83], v[0:3]
    buffer_load_dwordx4 v[64:67], v160, s[12:15], s45 offen
    s_waitcnt vmcnt(15)
    v_mfma_f32_16x16x32_bf16 v[20:23], v[140:143], v[84:87], v[20:23]
    ds_read_b64_tr_b16 v[140:141], v163 offset:5120
    ds_read_b64_tr_b16 v[142:143], v163 offset:7680
    s_waitcnt lgkmcnt(14)
    v_mfma_f32_16x16x32_bf16 v[4:7], v[144:147], v[80:83], v[4:7]
    buffer_load_dwordx4 v[68:71], v161, s[12:15], s45 offen
    v_mfma_f32_16x16x32_bf16 v[24:27], v[144:147], v[84:87], v[24:27]
    ds_read_b64_tr_b16 v[144:145], v163 offset:5152
    ds_read_b64_tr_b16 v[146:147], v163 offset:7712
    s_waitcnt lgkmcnt(14)
    v_mfma_f32_16x16x32_bf16 v[8:11], v[148:151], v[80:83], v[8:11]
    v_mfma_f32_16x16x32_bf16 v[28:31], v[148:151], v[84:87], v[28:31]
    ds_read_b64_tr_b16 v[148:149], v163 offset:5184
    ds_read_b64_tr_b16 v[150:151], v163 offset:7744
    s_waitcnt lgkmcnt(14)
    v_mfma_f32_16x16x32_bf16 v[12:15], v[152:155], v[80:83], v[12:15]
    s_add_u32 s45, s45, 16384
    v_mfma_f32_16x16x32_bf16 v[32:35], v[152:155], v[84:87], v[32:35]
    ds_read_b64_tr_b16 v[152:153], v163 offset:5216
    ds_read_b64_tr_b16 v[154:155], v163 offset:7776
    s_waitcnt lgkmcnt(14)
    v_mfma_f32_16x16x32_bf16 v[16:19], v[156:159], v[80:83], v[16:19]
    v_mfma_f32_16x16x32_bf16 v[36:39], v[156:159], v[84:87], v[36:39]
    ds_read_b64_tr_b16 v[156:157], v163 offset:5248
    ds_read_b64_tr_b16 v[158:159], v163 offset:7808
    s_barrier
    s_waitcnt vmcnt(15) lgkmcnt(14)
    v_mfma_f32_16x16x32_bf16 v[0:3], v[120:123], v[88:91], v[0:3]
    buffer_load_dwordx4 v[72:75], v160, s[12:15], s49 offen
    s_waitcnt vmcnt(15)
    v_mfma_f32_16x16x32_bf16 v[20:23], v[120:123], v[92:95], v[20:23]
    ds_read_b64_tr_b16 v[120:121], v163 offset:20480
    ds_read_b64_tr_b16 v[122:123], v163 offset:23040
    s_waitcnt lgkmcnt(14)
    v_mfma_f32_16x16x32_bf16 v[4:7], v[124:127], v[88:91], v[4:7]
    buffer_load_dwordx4 v[76:79], v161, s[12:15], s49 offen
    v_mfma_f32_16x16x32_bf16 v[24:27], v[124:127], v[92:95], v[24:27]
    ds_read_b64_tr_b16 v[124:125], v163 offset:20512
    ds_read_b64_tr_b16 v[126:127], v163 offset:23072
    s_waitcnt lgkmcnt(14)
    v_mfma_f32_16x16x32_bf16 v[8:11], v[128:131], v[88:91], v[8:11]
    v_mfma_f32_16x16x32_bf16 v[28:31], v[128:131], v[92:95], v[28:31]
    ds_read_b64_tr_b16 v[128:129], v163 offset:20544
    ds_read_b64_tr_b16 v[130:131], v163 offset:23104
    s_waitcnt lgkmcnt(14)
    v_mfma_f32_16x16x32_bf16 v[12:15], v[132:135], v[88:91], v[12:15]
    s_add_u32 s49, s49, 16384
    v_mfma_f32_16x16x32_bf16 v[32:35], v[132:135], v[92:95], v[32:35]
    ds_read_b64_tr_b16 v[132:133], v163 offset:20576
    ds_read_b64_tr_b16 v[134:135], v163 offset:23136
    s_waitcnt lgkmcnt(14)
    v_mfma_f32_16x16x32_bf16 v[16:19], v[136:139], v[88:91], v[16:19]
    v_mfma_f32_16x16x32_bf16 v[36:39], v[136:139], v[92:95], v[36:39]
    ds_read_b64_tr_b16 v[136:137], v163 offset:20608
    ds_read_b64_tr_b16 v[138:139], v163 offset:23168
    s_waitcnt vmcnt(15) lgkmcnt(14)
    v_mfma_f32_16x16x32_bf16 v[0:3], v[140:143], v[96:99], v[0:3]
    buffer_load_dwordx4 v[80:83], v160, s[12:15], s45 offen
    s_waitcnt vmcnt(15)
    v_mfma_f32_16x16x32_bf16 v[20:23], v[140:143], v[100:103], v[20:23]
    ds_read_b64_tr_b16 v[140:141], v163 offset:25600
    ds_read_b64_tr_b16 v[142:143], v163 offset:28160
    s_waitcnt lgkmcnt(14)
    v_mfma_f32_16x16x32_bf16 v[4:7], v[144:147], v[96:99], v[4:7]
    buffer_load_dwordx4 v[84:87], v161, s[12:15], s45 offen
    v_mfma_f32_16x16x32_bf16 v[24:27], v[144:147], v[100:103], v[24:27]
    ds_read_b64_tr_b16 v[144:145], v163 offset:25632
    ds_read_b64_tr_b16 v[146:147], v163 offset:28192
    s_waitcnt lgkmcnt(14)
    v_mfma_f32_16x16x32_bf16 v[8:11], v[148:151], v[96:99], v[8:11]
    v_mfma_f32_16x16x32_bf16 v[28:31], v[148:151], v[100:103], v[28:31]
    ds_read_b64_tr_b16 v[148:149], v163 offset:25664
    ds_read_b64_tr_b16 v[150:151], v163 offset:28224
    s_waitcnt lgkmcnt(14)
    v_mfma_f32_16x16x32_bf16 v[12:15], v[152:155], v[96:99], v[12:15]
    s_add_u32 s45, s45, 16384
    v_mfma_f32_16x16x32_bf16 v[32:35], v[152:155], v[100:103], v[32:35]
    ds_read_b64_tr_b16 v[152:153], v163 offset:25696
    ds_read_b64_tr_b16 v[154:155], v163 offset:28256
    s_waitcnt lgkmcnt(14)
    v_mfma_f32_16x16x32_bf16 v[16:19], v[156:159], v[96:99], v[16:19]
    v_mfma_f32_16x16x32_bf16 v[36:39], v[156:159], v[100:103], v[36:39]
    ds_read_b64_tr_b16 v[156:157], v163 offset:25728
    ds_read_b64_tr_b16 v[158:159], v163 offset:28288
    s_barrier
    s_waitcnt vmcnt(15) lgkmcnt(14)
    v_mfma_f32_16x16x32_bf16 v[0:3], v[120:123], v[104:107], v[0:3]
    buffer_load_dwordx4 v[88:91], v160, s[12:15], s49 offen
    s_waitcnt vmcnt(15)
    v_mfma_f32_16x16x32_bf16 v[20:23], v[120:123], v[108:111], v[20:23]
    ds_read_b64_tr_b16 v[120:121], v162 offset:0
    ds_read_b64_tr_b16 v[122:123], v162 offset:2560
    s_waitcnt lgkmcnt(14)
    v_mfma_f32_16x16x32_bf16 v[4:7], v[124:127], v[104:107], v[4:7]
    buffer_load_dwordx4 v[92:95], v161, s[12:15], s49 offen
    v_mfma_f32_16x16x32_bf16 v[24:27], v[124:127], v[108:111], v[24:27]
    ds_read_b64_tr_b16 v[124:125], v162 offset:32
    ds_read_b64_tr_b16 v[126:127], v162 offset:2592
    s_waitcnt lgkmcnt(14)
    v_mfma_f32_16x16x32_bf16 v[8:11], v[128:131], v[104:107], v[8:11]
    v_mfma_f32_16x16x32_bf16 v[28:31], v[128:131], v[108:111], v[28:31]
    ds_read_b64_tr_b16 v[128:129], v162 offset:64
    ds_read_b64_tr_b16 v[130:131], v162 offset:2624
    s_waitcnt lgkmcnt(14)
    v_mfma_f32_16x16x32_bf16 v[12:15], v[132:135], v[104:107], v[12:15]
    s_add_u32 s49, s49, 16384
    v_mfma_f32_16x16x32_bf16 v[32:35], v[132:135], v[108:111], v[32:35]
    ds_read_b64_tr_b16 v[132:133], v162 offset:96
    ds_read_b64_tr_b16 v[134:135], v162 offset:2656
    s_waitcnt lgkmcnt(14)
    v_mfma_f32_16x16x32_bf16 v[16:19], v[136:139], v[104:107], v[16:19]
    v_mfma_f32_16x16x32_bf16 v[36:39], v[136:139], v[108:111], v[36:39]
    ds_read_b64_tr_b16 v[136:137], v162 offset:128
    ds_read_b64_tr_b16 v[138:139], v162 offset:2688
    s_waitcnt vmcnt(15) lgkmcnt(14)
    v_mfma_f32_16x16x32_bf16 v[0:3], v[140:143], v[112:115], v[0:3]
    buffer_load_dwordx4 v[96:99], v160, s[12:15], s45 offen
    s_waitcnt vmcnt(15)
    v_mfma_f32_16x16x32_bf16 v[20:23], v[140:143], v[116:119], v[20:23]
    ds_read_b64_tr_b16 v[140:141], v162 offset:5120
    ds_read_b64_tr_b16 v[142:143], v162 offset:7680
    s_waitcnt lgkmcnt(14)
    v_mfma_f32_16x16x32_bf16 v[4:7], v[144:147], v[112:115], v[4:7]
    buffer_load_dwordx4 v[100:103], v161, s[12:15], s45 offen
    v_mfma_f32_16x16x32_bf16 v[24:27], v[144:147], v[116:119], v[24:27]
    ds_read_b64_tr_b16 v[144:145], v162 offset:5152
    ds_read_b64_tr_b16 v[146:147], v162 offset:7712
    s_waitcnt lgkmcnt(14)
    v_mfma_f32_16x16x32_bf16 v[8:11], v[148:151], v[112:115], v[8:11]
    v_mfma_f32_16x16x32_bf16 v[28:31], v[148:151], v[116:119], v[28:31]
    ds_read_b64_tr_b16 v[148:149], v162 offset:5184
    ds_read_b64_tr_b16 v[150:151], v162 offset:7744
    s_waitcnt lgkmcnt(14)
    v_mfma_f32_16x16x32_bf16 v[12:15], v[152:155], v[112:115], v[12:15]
    s_add_u32 s45, s45, 16384
    v_mfma_f32_16x16x32_bf16 v[32:35], v[152:155], v[116:119], v[32:35]
    ds_read_b64_tr_b16 v[152:153], v162 offset:5216
    ds_read_b64_tr_b16 v[154:155], v162 offset:7776
    s_waitcnt lgkmcnt(14)
    v_mfma_f32_16x16x32_bf16 v[16:19], v[156:159], v[112:115], v[16:19]
    v_mfma_f32_16x16x32_bf16 v[36:39], v[156:159], v[116:119], v[36:39]
    ds_read_b64_tr_b16 v[156:157], v162 offset:5248
    ds_read_b64_tr_b16 v[158:159], v162 offset:7808
    s_barrier
    s_waitcnt vmcnt(15) lgkmcnt(14)
    v_mfma_f32_16x16x32_bf16 v[0:3], v[120:123], v[40:43], v[0:3]
    buffer_load_dwordx4 v[104:107], v160, s[12:15], s49 offen
    s_waitcnt vmcnt(15)
    v_mfma_f32_16x16x32_bf16 v[20:23], v[120:123], v[44:47], v[20:23]
    ds_read_b64_tr_b16 v[120:121], v162 offset:20480
    ds_read_b64_tr_b16 v[122:123], v162 offset:23040
    s_waitcnt lgkmcnt(14)
    v_mfma_f32_16x16x32_bf16 v[4:7], v[124:127], v[40:43], v[4:7]
    buffer_load_dwordx4 v[108:111], v161, s[12:15], s49 offen
    v_mfma_f32_16x16x32_bf16 v[24:27], v[124:127], v[44:47], v[24:27]
    ds_read_b64_tr_b16 v[124:125], v162 offset:20512
    ds_read_b64_tr_b16 v[126:127], v162 offset:23072
    s_waitcnt lgkmcnt(14)
    v_mfma_f32_16x16x32_bf16 v[8:11], v[128:131], v[40:43], v[8:11]
    v_mfma_f32_16x16x32_bf16 v[28:31], v[128:131], v[44:47], v[28:31]
    ds_read_b64_tr_b16 v[128:129], v162 offset:20544
    ds_read_b64_tr_b16 v[130:131], v162 offset:23104
    s_waitcnt lgkmcnt(14)
    v_mfma_f32_16x16x32_bf16 v[12:15], v[132:135], v[40:43], v[12:15]
    s_add_u32 s49, s49, 16384
    v_mfma_f32_16x16x32_bf16 v[32:35], v[132:135], v[44:47], v[32:35]
    ds_read_b64_tr_b16 v[132:133], v162 offset:20576
    ds_read_b64_tr_b16 v[134:135], v162 offset:23136
    s_waitcnt lgkmcnt(14)
    v_mfma_f32_16x16x32_bf16 v[16:19], v[136:139], v[40:43], v[16:19]
    v_mfma_f32_16x16x32_bf16 v[36:39], v[136:139], v[44:47], v[36:39]
    ds_read_b64_tr_b16 v[136:137], v162 offset:20608
    ds_read_b64_tr_b16 v[138:139], v162 offset:23168
    s_waitcnt vmcnt(15) lgkmcnt(14)
    v_mfma_f32_16x16x32_bf16 v[0:3], v[140:143], v[48:51], v[0:3]
    buffer_load_dwordx4 v[112:115], v160, s[12:15], s45 offen
    s_waitcnt vmcnt(15)
    v_mfma_f32_16x16x32_bf16 v[20:23], v[140:143], v[52:55], v[20:23]
    ds_read_b64_tr_b16 v[140:141], v162 offset:25600
    ds_read_b64_tr_b16 v[142:143], v162 offset:28160
    s_waitcnt lgkmcnt(14)
    v_mfma_f32_16x16x32_bf16 v[4:7], v[144:147], v[48:51], v[4:7]
    buffer_load_dwordx4 v[116:119], v161, s[12:15], s45 offen
    v_mfma_f32_16x16x32_bf16 v[24:27], v[144:147], v[52:55], v[24:27]
    ds_read_b64_tr_b16 v[144:145], v162 offset:25632
    ds_read_b64_tr_b16 v[146:147], v162 offset:28192
    s_waitcnt lgkmcnt(14)
    v_mfma_f32_16x16x32_bf16 v[8:11], v[148:151], v[48:51], v[8:11]
    v_mfma_f32_16x16x32_bf16 v[28:31], v[148:151], v[52:55], v[28:31]
    ds_read_b64_tr_b16 v[148:149], v162 offset:25664
    ds_read_b64_tr_b16 v[150:151], v162 offset:28224
    s_waitcnt lgkmcnt(14)
    v_mfma_f32_16x16x32_bf16 v[12:15], v[152:155], v[48:51], v[12:15]
    s_add_u32 s45, s45, 16384
    v_mfma_f32_16x16x32_bf16 v[32:35], v[152:155], v[52:55], v[32:35]
    ds_read_b64_tr_b16 v[152:153], v162 offset:25696
    ds_read_b64_tr_b16 v[154:155], v162 offset:28256
    s_waitcnt lgkmcnt(14)
    v_mfma_f32_16x16x32_bf16 v[16:19], v[156:159], v[48:51], v[16:19]
    v_mfma_f32_16x16x32_bf16 v[36:39], v[156:159], v[52:55], v[36:39]
    ds_read_b64_tr_b16 v[156:157], v162 offset:25728
    ds_read_b64_tr_b16 v[158:159], v162 offset:28288
    s_barrier
    s_waitcnt vmcnt(15) lgkmcnt(14)
    v_mfma_f32_16x16x32_bf16 v[0:3], v[120:123], v[56:59], v[0:3]
    buffer_load_dwordx4 v[40:43], v160, s[12:15], s49 offen
    s_waitcnt vmcnt(15)
    v_mfma_f32_16x16x32_bf16 v[20:23], v[120:123], v[60:63], v[20:23]
    ds_read_b64_tr_b16 v[120:121], v162 offset:40960
    ds_read_b64_tr_b16 v[122:123], v162 offset:43520
    s_waitcnt lgkmcnt(14)
    v_mfma_f32_16x16x32_bf16 v[4:7], v[124:127], v[56:59], v[4:7]
    buffer_load_dwordx4 v[44:47], v161, s[12:15], s49 offen
    v_mfma_f32_16x16x32_bf16 v[24:27], v[124:127], v[60:63], v[24:27]
    ds_read_b64_tr_b16 v[124:125], v162 offset:40992
    ds_read_b64_tr_b16 v[126:127], v162 offset:43552
    s_waitcnt lgkmcnt(14)
    v_mfma_f32_16x16x32_bf16 v[8:11], v[128:131], v[56:59], v[8:11]
    v_mfma_f32_16x16x32_bf16 v[28:31], v[128:131], v[60:63], v[28:31]
    ds_read_b64_tr_b16 v[128:129], v162 offset:41024
    ds_read_b64_tr_b16 v[130:131], v162 offset:43584
    s_waitcnt lgkmcnt(14)
    v_mfma_f32_16x16x32_bf16 v[12:15], v[132:135], v[56:59], v[12:15]
    s_add_u32 s49, s49, 16384
    v_mfma_f32_16x16x32_bf16 v[32:35], v[132:135], v[60:63], v[32:35]
    ds_read_b64_tr_b16 v[132:133], v162 offset:41056
    ds_read_b64_tr_b16 v[134:135], v162 offset:43616
    s_waitcnt lgkmcnt(14)
    v_mfma_f32_16x16x32_bf16 v[16:19], v[136:139], v[56:59], v[16:19]
    v_mfma_f32_16x16x32_bf16 v[36:39], v[136:139], v[60:63], v[36:39]
    ds_read_b64_tr_b16 v[136:137], v162 offset:41088
    ds_read_b64_tr_b16 v[138:139], v162 offset:43648
    s_waitcnt vmcnt(15) lgkmcnt(14)
    v_mfma_f32_16x16x32_bf16 v[0:3], v[140:143], v[64:67], v[0:3]
    buffer_load_dwordx4 v[48:51], v160, s[12:15], s45 offen
    s_waitcnt vmcnt(15)
    v_mfma_f32_16x16x32_bf16 v[20:23], v[140:143], v[68:71], v[20:23]
    ds_read_b64_tr_b16 v[140:141], v162 offset:46080
    ds_read_b64_tr_b16 v[142:143], v162 offset:48640
    s_waitcnt lgkmcnt(14)
    v_mfma_f32_16x16x32_bf16 v[4:7], v[144:147], v[64:67], v[4:7]
    buffer_load_dwordx4 v[52:55], v161, s[12:15], s45 offen
    v_mfma_f32_16x16x32_bf16 v[24:27], v[144:147], v[68:71], v[24:27]
    ds_read_b64_tr_b16 v[144:145], v162 offset:46112
    ds_read_b64_tr_b16 v[146:147], v162 offset:48672
    s_waitcnt lgkmcnt(14)
    v_mfma_f32_16x16x32_bf16 v[8:11], v[148:151], v[64:67], v[8:11]
    v_mfma_f32_16x16x32_bf16 v[28:31], v[148:151], v[68:71], v[28:31]
    ds_read_b64_tr_b16 v[148:149], v162 offset:46144
    ds_read_b64_tr_b16 v[150:151], v162 offset:48704
    s_waitcnt lgkmcnt(14)
    v_mfma_f32_16x16x32_bf16 v[12:15], v[152:155], v[64:67], v[12:15]
    s_add_u32 s45, s45, 16384
    v_mfma_f32_16x16x32_bf16 v[32:35], v[152:155], v[68:71], v[32:35]
    ds_read_b64_tr_b16 v[152:153], v162 offset:46176
    ds_read_b64_tr_b16 v[154:155], v162 offset:48736
    s_waitcnt lgkmcnt(14)
    v_mfma_f32_16x16x32_bf16 v[16:19], v[156:159], v[64:67], v[16:19]
    v_mfma_f32_16x16x32_bf16 v[36:39], v[156:159], v[68:71], v[36:39]
    ds_read_b64_tr_b16 v[156:157], v162 offset:46208
    ds_read_b64_tr_b16 v[158:159], v162 offset:48768
    s_barrier
    s_waitcnt vmcnt(15) lgkmcnt(14)
    v_mfma_f32_16x16x32_bf16 v[0:3], v[120:123], v[72:75], v[0:3]
    buffer_load_dwordx4 v[56:59], v160, s[12:15], s49 offen
    s_waitcnt vmcnt(15)
    v_mfma_f32_16x16x32_bf16 v[20:23], v[120:123], v[76:79], v[20:23]
    ds_read_b64_tr_b16 v[120:121], v163 offset:0
    ds_read_b64_tr_b16 v[122:123], v163 offset:2560
    s_waitcnt lgkmcnt(14)
    v_mfma_f32_16x16x32_bf16 v[4:7], v[124:127], v[72:75], v[4:7]
    buffer_load_dwordx4 v[60:63], v161, s[12:15], s49 offen
    v_mfma_f32_16x16x32_bf16 v[24:27], v[124:127], v[76:79], v[24:27]
    ds_read_b64_tr_b16 v[124:125], v163 offset:32
    ds_read_b64_tr_b16 v[126:127], v163 offset:2592
    s_waitcnt lgkmcnt(14)
    v_mfma_f32_16x16x32_bf16 v[8:11], v[128:131], v[72:75], v[8:11]
    v_mfma_f32_16x16x32_bf16 v[28:31], v[128:131], v[76:79], v[28:31]
    ds_read_b64_tr_b16 v[128:129], v163 offset:64
    ds_read_b64_tr_b16 v[130:131], v163 offset:2624
    s_waitcnt lgkmcnt(14)
    v_mfma_f32_16x16x32_bf16 v[12:15], v[132:135], v[72:75], v[12:15]
    s_add_u32 s49, s49, 16384
    v_mfma_f32_16x16x32_bf16 v[32:35], v[132:135], v[76:79], v[32:35]
    ds_read_b64_tr_b16 v[132:133], v163 offset:96
    ds_read_b64_tr_b16 v[134:135], v163 offset:2656
    s_waitcnt lgkmcnt(14)
    v_mfma_f32_16x16x32_bf16 v[16:19], v[136:139], v[72:75], v[16:19]
    v_mfma_f32_16x16x32_bf16 v[36:39], v[136:139], v[76:79], v[36:39]
    ds_read_b64_tr_b16 v[136:137], v163 offset:128
    ds_read_b64_tr_b16 v[138:139], v163 offset:2688
    s_waitcnt vmcnt(15) lgkmcnt(14)
    v_mfma_f32_16x16x32_bf16 v[0:3], v[140:143], v[80:83], v[0:3]
    buffer_load_dwordx4 v[64:67], v160, s[12:15], s45 offen
    s_waitcnt vmcnt(15)
    v_mfma_f32_16x16x32_bf16 v[20:23], v[140:143], v[84:87], v[20:23]
    ds_read_b64_tr_b16 v[140:141], v163 offset:5120
    ds_read_b64_tr_b16 v[142:143], v163 offset:7680
    s_waitcnt lgkmcnt(14)
    v_mfma_f32_16x16x32_bf16 v[4:7], v[144:147], v[80:83], v[4:7]
    buffer_load_dwordx4 v[68:71], v161, s[12:15], s45 offen
    v_mfma_f32_16x16x32_bf16 v[24:27], v[144:147], v[84:87], v[24:27]
    ds_read_b64_tr_b16 v[144:145], v163 offset:5152
    ds_read_b64_tr_b16 v[146:147], v163 offset:7712
    s_waitcnt lgkmcnt(14)
    v_mfma_f32_16x16x32_bf16 v[8:11], v[148:151], v[80:83], v[8:11]
    v_mfma_f32_16x16x32_bf16 v[28:31], v[148:151], v[84:87], v[28:31]
    ds_read_b64_tr_b16 v[148:149], v163 offset:5184
    ds_read_b64_tr_b16 v[150:151], v163 offset:7744
    s_waitcnt lgkmcnt(14)
    v_mfma_f32_16x16x32_bf16 v[12:15], v[152:155], v[80:83], v[12:15]
    s_add_u32 s45, s45, 16384
    v_mfma_f32_16x16x32_bf16 v[32:35], v[152:155], v[84:87], v[32:35]
    ds_read_b64_tr_b16 v[152:153], v163 offset:5216
    ds_read_b64_tr_b16 v[154:155], v163 offset:7776
    s_waitcnt lgkmcnt(14)
    v_mfma_f32_16x16x32_bf16 v[16:19], v[156:159], v[80:83], v[16:19]
    v_mfma_f32_16x16x32_bf16 v[36:39], v[156:159], v[84:87], v[36:39]
    ds_read_b64_tr_b16 v[156:157], v163 offset:5248
    ds_read_b64_tr_b16 v[158:159], v163 offset:7808
    s_barrier
    s_waitcnt vmcnt(15) lgkmcnt(14)
    v_mfma_f32_16x16x32_bf16 v[0:3], v[120:123], v[88:91], v[0:3]
    buffer_load_dwordx4 v[72:75], v160, s[12:15], s49 offen
    s_waitcnt vmcnt(15)
    v_mfma_f32_16x16x32_bf16 v[20:23], v[120:123], v[92:95], v[20:23]
    ds_read_b64_tr_b16 v[120:121], v163 offset:20480
    ds_read_b64_tr_b16 v[122:123], v163 offset:23040
    s_waitcnt lgkmcnt(14)
    v_mfma_f32_16x16x32_bf16 v[4:7], v[124:127], v[88:91], v[4:7]
    buffer_load_dwordx4 v[76:79], v161, s[12:15], s49 offen
    v_mfma_f32_16x16x32_bf16 v[24:27], v[124:127], v[92:95], v[24:27]
    ds_read_b64_tr_b16 v[124:125], v163 offset:20512
    ds_read_b64_tr_b16 v[126:127], v163 offset:23072
    s_waitcnt lgkmcnt(14)
    v_mfma_f32_16x16x32_bf16 v[8:11], v[128:131], v[88:91], v[8:11]
    v_mfma_f32_16x16x32_bf16 v[28:31], v[128:131], v[92:95], v[28:31]
    ds_read_b64_tr_b16 v[128:129], v163 offset:20544
    ds_read_b64_tr_b16 v[130:131], v163 offset:23104
    s_waitcnt lgkmcnt(14)
    v_mfma_f32_16x16x32_bf16 v[12:15], v[132:135], v[88:91], v[12:15]
    s_add_u32 s49, s49, 16384
    v_mfma_f32_16x16x32_bf16 v[32:35], v[132:135], v[92:95], v[32:35]
    ds_read_b64_tr_b16 v[132:133], v163 offset:20576
    ds_read_b64_tr_b16 v[134:135], v163 offset:23136
    s_waitcnt lgkmcnt(14)
    v_mfma_f32_16x16x32_bf16 v[16:19], v[136:139], v[88:91], v[16:19]
    v_mfma_f32_16x16x32_bf16 v[36:39], v[136:139], v[92:95], v[36:39]
    ds_read_b64_tr_b16 v[136:137], v163 offset:20608
    ds_read_b64_tr_b16 v[138:139], v163 offset:23168
    s_waitcnt vmcnt(15) lgkmcnt(14)
    v_mfma_f32_16x16x32_bf16 v[0:3], v[140:143], v[96:99], v[0:3]
    buffer_load_dwordx4 v[80:83], v160, s[12:15], s45 offen
    s_waitcnt vmcnt(15)
    v_mfma_f32_16x16x32_bf16 v[20:23], v[140:143], v[100:103], v[20:23]
    ds_read_b64_tr_b16 v[140:141], v163 offset:25600
    ds_read_b64_tr_b16 v[142:143], v163 offset:28160
    s_waitcnt lgkmcnt(14)
    v_mfma_f32_16x16x32_bf16 v[4:7], v[144:147], v[96:99], v[4:7]
    buffer_load_dwordx4 v[84:87], v161, s[12:15], s45 offen
    v_mfma_f32_16x16x32_bf16 v[24:27], v[144:147], v[100:103], v[24:27]
    ds_read_b64_tr_b16 v[144:145], v163 offset:25632
    ds_read_b64_tr_b16 v[146:147], v163 offset:28192
    s_waitcnt lgkmcnt(14)
    v_mfma_f32_16x16x32_bf16 v[8:11], v[148:151], v[96:99], v[8:11]
    v_mfma_f32_16x16x32_bf16 v[28:31], v[148:151], v[100:103], v[28:31]
    ds_read_b64_tr_b16 v[148:149], v163 offset:25664
    ds_read_b64_tr_b16 v[150:151], v163 offset:28224
    s_waitcnt lgkmcnt(14)
    v_mfma_f32_16x16x32_bf16 v[12:15], v[152:155], v[96:99], v[12:15]
    s_add_u32 s45, s45, 16384
    v_mfma_f32_16x16x32_bf16 v[32:35], v[152:155], v[100:103], v[32:35]
    ds_read_b64_tr_b16 v[152:153], v163 offset:25696
    ds_read_b64_tr_b16 v[154:155], v163 offset:28256
    s_waitcnt lgkmcnt(14)
    v_mfma_f32_16x16x32_bf16 v[16:19], v[156:159], v[96:99], v[16:19]
    v_mfma_f32_16x16x32_bf16 v[36:39], v[156:159], v[100:103], v[36:39]
    ds_read_b64_tr_b16 v[156:157], v163 offset:25728
    ds_read_b64_tr_b16 v[158:159], v163 offset:28288
    s_barrier
    s_waitcnt vmcnt(15) lgkmcnt(14)
    v_mfma_f32_16x16x32_bf16 v[0:3], v[120:123], v[104:107], v[0:3]
    buffer_load_dwordx4 v[88:91], v160, s[12:15], s49 offen
    s_waitcnt vmcnt(15)
    v_mfma_f32_16x16x32_bf16 v[20:23], v[120:123], v[108:111], v[20:23]
    ds_read_b64_tr_b16 v[120:121], v162 offset:0
    ds_read_b64_tr_b16 v[122:123], v162 offset:2560
    s_waitcnt lgkmcnt(14)
    v_mfma_f32_16x16x32_bf16 v[4:7], v[124:127], v[104:107], v[4:7]
    buffer_load_dwordx4 v[92:95], v161, s[12:15], s49 offen
    v_mfma_f32_16x16x32_bf16 v[24:27], v[124:127], v[108:111], v[24:27]
    ds_read_b64_tr_b16 v[124:125], v162 offset:32
    ds_read_b64_tr_b16 v[126:127], v162 offset:2592
    s_waitcnt lgkmcnt(14)
    v_mfma_f32_16x16x32_bf16 v[8:11], v[128:131], v[104:107], v[8:11]
    v_mfma_f32_16x16x32_bf16 v[28:31], v[128:131], v[108:111], v[28:31]
    ds_read_b64_tr_b16 v[128:129], v162 offset:64
    ds_read_b64_tr_b16 v[130:131], v162 offset:2624
    s_waitcnt lgkmcnt(14)
    v_mfma_f32_16x16x32_bf16 v[12:15], v[132:135], v[104:107], v[12:15]
    s_add_u32 s49, s49, 16384
    v_mfma_f32_16x16x32_bf16 v[32:35], v[132:135], v[108:111], v[32:35]
    ds_read_b64_tr_b16 v[132:133], v162 offset:96
    ds_read_b64_tr_b16 v[134:135], v162 offset:2656
    s_waitcnt lgkmcnt(14)
    v_mfma_f32_16x16x32_bf16 v[16:19], v[136:139], v[104:107], v[16:19]
    v_mfma_f32_16x16x32_bf16 v[36:39], v[136:139], v[108:111], v[36:39]
    ds_read_b64_tr_b16 v[136:137], v162 offset:128
    ds_read_b64_tr_b16 v[138:139], v162 offset:2688
    s_waitcnt vmcnt(15) lgkmcnt(14)
    v_mfma_f32_16x16x32_bf16 v[0:3], v[140:143], v[112:115], v[0:3]
    buffer_load_dwordx4 v[96:99], v160, s[12:15], s45 offen
    s_waitcnt vmcnt(15)
    v_mfma_f32_16x16x32_bf16 v[20:23], v[140:143], v[116:119], v[20:23]
    ds_read_b64_tr_b16 v[140:141], v162 offset:5120
    ds_read_b64_tr_b16 v[142:143], v162 offset:7680
    s_waitcnt lgkmcnt(14)
    v_mfma_f32_16x16x32_bf16 v[4:7], v[144:147], v[112:115], v[4:7]
    buffer_load_dwordx4 v[100:103], v161, s[12:15], s45 offen
    v_mfma_f32_16x16x32_bf16 v[24:27], v[144:147], v[116:119], v[24:27]
    ds_read_b64_tr_b16 v[144:145], v162 offset:5152
    ds_read_b64_tr_b16 v[146:147], v162 offset:7712
    s_waitcnt lgkmcnt(14)
    v_mfma_f32_16x16x32_bf16 v[8:11], v[148:151], v[112:115], v[8:11]
    v_mfma_f32_16x16x32_bf16 v[28:31], v[148:151], v[116:119], v[28:31]
    ds_read_b64_tr_b16 v[148:149], v162 offset:5184
    ds_read_b64_tr_b16 v[150:151], v162 offset:7744
    s_waitcnt lgkmcnt(14)
    v_mfma_f32_16x16x32_bf16 v[12:15], v[152:155], v[112:115], v[12:15]
    s_add_u32 s45, s45, 16384
    v_mfma_f32_16x16x32_bf16 v[32:35], v[152:155], v[116:119], v[32:35]
    ds_read_b64_tr_b16 v[152:153], v162 offset:5216
    ds_read_b64_tr_b16 v[154:155], v162 offset:7776
    s_waitcnt lgkmcnt(14)
    v_mfma_f32_16x16x32_bf16 v[16:19], v[156:159], v[112:115], v[16:19]
    v_mfma_f32_16x16x32_bf16 v[36:39], v[156:159], v[116:119], v[36:39]
    ds_read_b64_tr_b16 v[156:157], v162 offset:5248
    ds_read_b64_tr_b16 v[158:159], v162 offset:7808
    s_barrier
    s_waitcnt vmcnt(15) lgkmcnt(14)
    v_mfma_f32_16x16x32_bf16 v[0:3], v[120:123], v[40:43], v[0:3]
    s_waitcnt vmcnt(14)
    v_mfma_f32_16x16x32_bf16 v[20:23], v[120:123], v[44:47], v[20:23]
    ds_read_b64_tr_b16 v[120:121], v162 offset:20480
    ds_read_b64_tr_b16 v[122:123], v162 offset:23040
    s_waitcnt lgkmcnt(14)
    v_mfma_f32_16x16x32_bf16 v[4:7], v[124:127], v[40:43], v[4:7]
    v_mfma_f32_16x16x32_bf16 v[24:27], v[124:127], v[44:47], v[24:27]
    ds_read_b64_tr_b16 v[124:125], v162 offset:20512
    ds_read_b64_tr_b16 v[126:127], v162 offset:23072
    s_waitcnt lgkmcnt(14)
    v_mfma_f32_16x16x32_bf16 v[8:11], v[128:131], v[40:43], v[8:11]
    v_mfma_f32_16x16x32_bf16 v[28:31], v[128:131], v[44:47], v[28:31]
    ds_read_b64_tr_b16 v[128:129], v162 offset:20544
    ds_read_b64_tr_b16 v[130:131], v162 offset:23104
    s_waitcnt lgkmcnt(14)
    v_mfma_f32_16x16x32_bf16 v[12:15], v[132:135], v[40:43], v[12:15]
    v_mfma_f32_16x16x32_bf16 v[32:35], v[132:135], v[44:47], v[32:35]
    ds_read_b64_tr_b16 v[132:133], v162 offset:20576
    ds_read_b64_tr_b16 v[134:135], v162 offset:23136
    s_waitcnt lgkmcnt(14)
    v_mfma_f32_16x16x32_bf16 v[16:19], v[136:139], v[40:43], v[16:19]
    v_mfma_f32_16x16x32_bf16 v[36:39], v[136:139], v[44:47], v[36:39]
    ds_read_b64_tr_b16 v[136:137], v162 offset:20608
    ds_read_b64_tr_b16 v[138:139], v162 offset:23168
    s_waitcnt vmcnt(13) lgkmcnt(14)
    v_mfma_f32_16x16x32_bf16 v[0:3], v[140:143], v[48:51], v[0:3]
    s_waitcnt vmcnt(12)
    v_mfma_f32_16x16x32_bf16 v[20:23], v[140:143], v[52:55], v[20:23]
    ds_read_b64_tr_b16 v[140:141], v162 offset:25600
    ds_read_b64_tr_b16 v[142:143], v162 offset:28160
    s_waitcnt lgkmcnt(14)
    v_mfma_f32_16x16x32_bf16 v[4:7], v[144:147], v[48:51], v[4:7]
    v_mfma_f32_16x16x32_bf16 v[24:27], v[144:147], v[52:55], v[24:27]
    ds_read_b64_tr_b16 v[144:145], v162 offset:25632
    ds_read_b64_tr_b16 v[146:147], v162 offset:28192
    s_waitcnt lgkmcnt(14)
    v_mfma_f32_16x16x32_bf16 v[8:11], v[148:151], v[48:51], v[8:11]
    v_mfma_f32_16x16x32_bf16 v[28:31], v[148:151], v[52:55], v[28:31]
    ds_read_b64_tr_b16 v[148:149], v162 offset:25664
    ds_read_b64_tr_b16 v[150:151], v162 offset:28224
    s_waitcnt lgkmcnt(14)
    v_mfma_f32_16x16x32_bf16 v[12:15], v[152:155], v[48:51], v[12:15]
    v_mfma_f32_16x16x32_bf16 v[32:35], v[152:155], v[52:55], v[32:35]
    ds_read_b64_tr_b16 v[152:153], v162 offset:25696
    ds_read_b64_tr_b16 v[154:155], v162 offset:28256
    s_waitcnt lgkmcnt(14)
    v_mfma_f32_16x16x32_bf16 v[16:19], v[156:159], v[48:51], v[16:19]
    v_mfma_f32_16x16x32_bf16 v[36:39], v[156:159], v[52:55], v[36:39]
    ds_read_b64_tr_b16 v[156:157], v162 offset:25728
    ds_read_b64_tr_b16 v[158:159], v162 offset:28288
    s_barrier
    s_waitcnt vmcnt(11) lgkmcnt(14)
    v_mfma_f32_16x16x32_bf16 v[0:3], v[120:123], v[56:59], v[0:3]
    s_waitcnt vmcnt(10)
    v_mfma_f32_16x16x32_bf16 v[20:23], v[120:123], v[60:63], v[20:23]
    ds_read_b64_tr_b16 v[120:121], v162 offset:40960
    ds_read_b64_tr_b16 v[122:123], v162 offset:43520
    s_waitcnt lgkmcnt(14)
    v_mfma_f32_16x16x32_bf16 v[4:7], v[124:127], v[56:59], v[4:7]
    v_mfma_f32_16x16x32_bf16 v[24:27], v[124:127], v[60:63], v[24:27]
    ds_read_b64_tr_b16 v[124:125], v162 offset:40992
    ds_read_b64_tr_b16 v[126:127], v162 offset:43552
    s_waitcnt lgkmcnt(14)
    v_mfma_f32_16x16x32_bf16 v[8:11], v[128:131], v[56:59], v[8:11]
    v_mfma_f32_16x16x32_bf16 v[28:31], v[128:131], v[60:63], v[28:31]
    ds_read_b64_tr_b16 v[128:129], v162 offset:41024
    ds_read_b64_tr_b16 v[130:131], v162 offset:43584
    s_waitcnt lgkmcnt(14)
    v_mfma_f32_16x16x32_bf16 v[12:15], v[132:135], v[56:59], v[12:15]
    v_mfma_f32_16x16x32_bf16 v[32:35], v[132:135], v[60:63], v[32:35]
    ds_read_b64_tr_b16 v[132:133], v162 offset:41056
    ds_read_b64_tr_b16 v[134:135], v162 offset:43616
    s_waitcnt lgkmcnt(14)
    v_mfma_f32_16x16x32_bf16 v[16:19], v[136:139], v[56:59], v[16:19]
    v_mfma_f32_16x16x32_bf16 v[36:39], v[136:139], v[60:63], v[36:39]
    ds_read_b64_tr_b16 v[136:137], v162 offset:41088
    ds_read_b64_tr_b16 v[138:139], v162 offset:43648
    s_waitcnt vmcnt(9) lgkmcnt(14)
    v_mfma_f32_16x16x32_bf16 v[0:3], v[140:143], v[64:67], v[0:3]
    s_waitcnt vmcnt(8)
    v_mfma_f32_16x16x32_bf16 v[20:23], v[140:143], v[68:71], v[20:23]
    ds_read_b64_tr_b16 v[140:141], v162 offset:46080
    ds_read_b64_tr_b16 v[142:143], v162 offset:48640
    s_waitcnt lgkmcnt(14)
    v_mfma_f32_16x16x32_bf16 v[4:7], v[144:147], v[64:67], v[4:7]
    v_mfma_f32_16x16x32_bf16 v[24:27], v[144:147], v[68:71], v[24:27]
    ds_read_b64_tr_b16 v[144:145], v162 offset:46112
    ds_read_b64_tr_b16 v[146:147], v162 offset:48672
    s_waitcnt lgkmcnt(14)
    v_mfma_f32_16x16x32_bf16 v[8:11], v[148:151], v[64:67], v[8:11]
    v_mfma_f32_16x16x32_bf16 v[28:31], v[148:151], v[68:71], v[28:31]
    ds_read_b64_tr_b16 v[148:149], v162 offset:46144
    ds_read_b64_tr_b16 v[150:151], v162 offset:48704
    s_waitcnt lgkmcnt(14)
    v_mfma_f32_16x16x32_bf16 v[12:15], v[152:155], v[64:67], v[12:15]
    v_mfma_f32_16x16x32_bf16 v[32:35], v[152:155], v[68:71], v[32:35]
    ds_read_b64_tr_b16 v[152:153], v162 offset:46176
    ds_read_b64_tr_b16 v[154:155], v162 offset:48736
    s_waitcnt lgkmcnt(14)
    v_mfma_f32_16x16x32_bf16 v[16:19], v[156:159], v[64:67], v[16:19]
    v_mfma_f32_16x16x32_bf16 v[36:39], v[156:159], v[68:71], v[36:39]
    ds_read_b64_tr_b16 v[156:157], v162 offset:46208
    ds_read_b64_tr_b16 v[158:159], v162 offset:48768
    s_barrier
    s_waitcnt vmcnt(7) lgkmcnt(14)
    v_mfma_f32_16x16x32_bf16 v[0:3], v[120:123], v[72:75], v[0:3]
    s_waitcnt vmcnt(6)
    v_mfma_f32_16x16x32_bf16 v[20:23], v[120:123], v[76:79], v[20:23]
    ds_read_b64_tr_b16 v[120:121], v163 offset:0
    ds_read_b64_tr_b16 v[122:123], v163 offset:2560
    s_waitcnt lgkmcnt(14)
    v_mfma_f32_16x16x32_bf16 v[4:7], v[124:127], v[72:75], v[4:7]
    v_mfma_f32_16x16x32_bf16 v[24:27], v[124:127], v[76:79], v[24:27]
    ds_read_b64_tr_b16 v[124:125], v163 offset:32
    ds_read_b64_tr_b16 v[126:127], v163 offset:2592
    s_waitcnt lgkmcnt(14)
    v_mfma_f32_16x16x32_bf16 v[8:11], v[128:131], v[72:75], v[8:11]
    v_mfma_f32_16x16x32_bf16 v[28:31], v[128:131], v[76:79], v[28:31]
    ds_read_b64_tr_b16 v[128:129], v163 offset:64
    ds_read_b64_tr_b16 v[130:131], v163 offset:2624
    s_waitcnt lgkmcnt(14)
    v_mfma_f32_16x16x32_bf16 v[12:15], v[132:135], v[72:75], v[12:15]
    v_mfma_f32_16x16x32_bf16 v[32:35], v[132:135], v[76:79], v[32:35]
    ds_read_b64_tr_b16 v[132:133], v163 offset:96
    ds_read_b64_tr_b16 v[134:135], v163 offset:2656
    s_waitcnt lgkmcnt(14)
    v_mfma_f32_16x16x32_bf16 v[16:19], v[136:139], v[72:75], v[16:19]
    v_mfma_f32_16x16x32_bf16 v[36:39], v[136:139], v[76:79], v[36:39]
    ds_read_b64_tr_b16 v[136:137], v163 offset:128
    ds_read_b64_tr_b16 v[138:139], v163 offset:2688
    s_waitcnt vmcnt(5) lgkmcnt(14)
    v_mfma_f32_16x16x32_bf16 v[0:3], v[140:143], v[80:83], v[0:3]
    s_waitcnt vmcnt(4)
    v_mfma_f32_16x16x32_bf16 v[20:23], v[140:143], v[84:87], v[20:23]
    ds_read_b64_tr_b16 v[140:141], v163 offset:5120
    ds_read_b64_tr_b16 v[142:143], v163 offset:7680
    s_waitcnt lgkmcnt(14)
    v_mfma_f32_16x16x32_bf16 v[4:7], v[144:147], v[80:83], v[4:7]
    v_mfma_f32_16x16x32_bf16 v[24:27], v[144:147], v[84:87], v[24:27]
    ds_read_b64_tr_b16 v[144:145], v163 offset:5152
    ds_read_b64_tr_b16 v[146:147], v163 offset:7712
    s_waitcnt lgkmcnt(14)
    v_mfma_f32_16x16x32_bf16 v[8:11], v[148:151], v[80:83], v[8:11]
    v_mfma_f32_16x16x32_bf16 v[28:31], v[148:151], v[84:87], v[28:31]
    ds_read_b64_tr_b16 v[148:149], v163 offset:5184
    ds_read_b64_tr_b16 v[150:151], v163 offset:7744
    s_waitcnt lgkmcnt(14)
    v_mfma_f32_16x16x32_bf16 v[12:15], v[152:155], v[80:83], v[12:15]
    v_mfma_f32_16x16x32_bf16 v[32:35], v[152:155], v[84:87], v[32:35]
    ds_read_b64_tr_b16 v[152:153], v163 offset:5216
    ds_read_b64_tr_b16 v[154:155], v163 offset:7776
    s_waitcnt lgkmcnt(14)
    v_mfma_f32_16x16x32_bf16 v[16:19], v[156:159], v[80:83], v[16:19]
    v_mfma_f32_16x16x32_bf16 v[36:39], v[156:159], v[84:87], v[36:39]
    ds_read_b64_tr_b16 v[156:157], v163 offset:5248
    ds_read_b64_tr_b16 v[158:159], v163 offset:7808
    s_waitcnt vmcnt(3) lgkmcnt(14)
    v_mfma_f32_16x16x32_bf16 v[0:3], v[120:123], v[88:91], v[0:3]
    v_lshrrev_b32 v80, 6, v164
    v_and_b32 v81, 63, v164
    s_waitcnt vmcnt(2)
    v_mfma_f32_16x16x32_bf16 v[20:23], v[120:123], v[92:95], v[20:23]
    v_bfe_u32 v82, v164, 4, 2
    v_and_b32 v83, 15, v164
    s_waitcnt lgkmcnt(14)
    v_mfma_f32_16x16x32_bf16 v[4:7], v[124:127], v[88:91], v[4:7]
    v_lshlrev_b32 v165, 4, v82
    v_add_u32 v165, 139264, v165
    v_mfma_f32_16x16x32_bf16 v[24:27], v[124:127], v[92:95], v[24:27]
    ds_read_b128 v[40:43], v165 offset:0
    s_waitcnt lgkmcnt(14)
    v_mfma_f32_16x16x32_bf16 v[8:11], v[128:131], v[88:91], v[8:11]
    ds_read_b128 v[44:47], v165 offset:64
    ds_read_b128 v[48:51], v165 offset:128
    v_mfma_f32_16x16x32_bf16 v[28:31], v[128:131], v[92:95], v[28:31]
    ds_read_b128 v[52:55], v165 offset:192
    ds_read_b128 v[56:59], v165 offset:256
    s_waitcnt lgkmcnt(14)
    v_mfma_f32_16x16x32_bf16 v[12:15], v[132:135], v[88:91], v[12:15]
    v_lshl_add_u32 v167, v80, 4, v83
    v_lshlrev_b32 v166, 3, v82
    v_mfma_f32_16x16x32_bf16 v[32:35], v[132:135], v[92:95], v[32:35]
    v_add_u32 v166, 140288, v166
    s_waitcnt lgkmcnt(14)
    v_mfma_f32_16x16x32_bf16 v[16:19], v[136:139], v[88:91], v[16:19]
    ds_read_b64 v[60:61], v166 offset:0
    ds_read_b64 v[62:63], v166 offset:32
    v_mfma_f32_16x16x32_bf16 v[36:39], v[136:139], v[92:95], v[36:39]
    ds_read_b64 v[64:65], v166 offset:64
    ds_read_b64 v[66:67], v166 offset:96
    s_waitcnt vmcnt(1) lgkmcnt(14)
    v_mfma_f32_16x16x32_bf16 v[0:3], v[140:143], v[96:99], v[0:3]
    ds_read_b64 v[68:69], v166 offset:128
    v_mul_u32_u24 v166, 2560, v80
    s_waitcnt vmcnt(0)
    v_mfma_f32_16x16x32_bf16 v[20:23], v[140:143], v[100:103], v[20:23]
    v_add_u32 v166, 122880, v166
    s_waitcnt lgkmcnt(14)
    v_mfma_f32_16x16x32_bf16 v[4:7], v[144:147], v[96:99], v[4:7]
    v_lshl_add_u32 v114, v81, 4, v166
    v_lshl_add_u32 v115, v81, 3, v166
    v_mfma_f32_16x16x32_bf16 v[24:27], v[144:147], v[100:103], v[24:27]
    ds_read_b128 v[104:107], v114
    ds_read_b128 v[108:111], v114 offset:1024
    s_waitcnt lgkmcnt(14)
    v_mfma_f32_16x16x32_bf16 v[8:11], v[148:151], v[96:99], v[8:11]
    ds_read_b64 v[112:113], v115 offset:2048
    v_mul_u32_u24 v167, 1280, v167
    v_mfma_f32_16x16x32_bf16 v[28:31], v[148:151], v[100:103], v[28:31]
    v_lshl_add_u32 v86, v82, 3, v167
    s_waitcnt lgkmcnt(14)
    v_mfma_f32_16x16x32_bf16 v[12:15], v[152:155], v[96:99], v[12:15]
    v_mul_u32_u24 v166, 5120, v80
    v_lshl_add_u32 v166, v81, 4, v166
    v_mfma_f32_16x16x32_bf16 v[32:35], v[152:155], v[100:103], v[32:35]
    v_add_u32 v84, 102400, v166
    v_xor_b32 v166, 1, v80
    s_waitcnt lgkmcnt(13)
    v_mfma_f32_16x16x32_bf16 v[16:19], v[156:159], v[96:99], v[16:19]
    v_mul_u32_u24 v166, 5120, v166
    v_lshl_add_u32 v166, v81, 4, v166
    v_mfma_f32_16x16x32_bf16 v[36:39], v[156:159], v[100:103], v[36:39]
    v_add_u32 v85, 102400, v166
    ds_write_b128 v84, v[20:23] offset:0
    ds_write_b128 v84, v[24:27] offset:1024
    ds_write_b128 v84, v[28:31] offset:2048
    ds_write_b128 v84, v[32:35] offset:3072
    s_nop 2
    ds_write_b128 v84, v[36:39] offset:4096
    s_waitcnt lgkmcnt(7)
    v_lshlrev_b32 v120, 16, v104
    v_and_b32 v121, 0xffff0000, v104
    v_lshlrev_b32 v122, 16, v105
    v_and_b32 v123, 0xffff0000, v105
    v_lshlrev_b32 v124, 16, v106
    v_and_b32 v125, 0xffff0000, v106
    v_lshlrev_b32 v126, 16, v107
    v_and_b32 v127, 0xffff0000, v107
    s_waitcnt lgkmcnt(6)
    v_lshlrev_b32 v128, 16, v108
    v_and_b32 v129, 0xffff0000, v108
    v_lshlrev_b32 v130, 16, v109
    v_and_b32 v131, 0xffff0000, v109
    v_lshlrev_b32 v132, 16, v110
    v_and_b32 v133, 0xffff0000, v110
    v_lshlrev_b32 v134, 16, v111
    v_and_b32 v135, 0xffff0000, v111
    s_waitcnt lgkmcnt(5)
    v_lshlrev_b32 v136, 16, v112
    v_and_b32 v137, 0xffff0000, v112
    v_lshlrev_b32 v138, 16, v113
    v_and_b32 v139, 0xffff0000, v113
    v_lshlrev_b32 v140, 16, v60
    v_and_b32 v141, 0xffff0000, v60
    v_lshlrev_b32 v142, 16, v61
    v_and_b32 v143, 0xffff0000, v61
    v_lshlrev_b32 v144, 16, v62
    v_and_b32 v145, 0xffff0000, v62
    v_lshlrev_b32 v146, 16, v63
    v_and_b32 v147, 0xffff0000, v63
    v_lshlrev_b32 v148, 16, v64
    v_and_b32 v149, 0xffff0000, v64
    v_lshlrev_b32 v150, 16, v65
    v_and_b32 v151, 0xffff0000, v65
    v_lshlrev_b32 v152, 16, v66
    v_and_b32 v153, 0xffff0000, v66
    v_lshlrev_b32 v154, 16, v67
    v_and_b32 v155, 0xffff0000, v67
    v_lshlrev_b32 v156, 16, v68
    v_and_b32 v157, 0xffff0000, v68
    v_lshlrev_b32 v158, 16, v69
    v_and_b32 v159, 0xffff0000, v69
    v_pk_fma_f32 v[120:121], v[140:141], v[40:41], v[120:121]
    v_pk_fma_f32 v[122:123], v[142:143], v[42:43], v[122:123]
    v_pk_fma_f32 v[124:125], v[144:145], v[44:45], v[124:125]
    v_pk_fma_f32 v[126:127], v[146:147], v[46:47], v[126:127]
    v_pk_fma_f32 v[128:129], v[148:149], v[48:49], v[128:129]
    v_pk_fma_f32 v[130:131], v[150:151], v[50:51], v[130:131]
    v_pk_fma_f32 v[132:133], v[152:153], v[52:53], v[132:133]
    v_pk_fma_f32 v[134:135], v[154:155], v[54:55], v[134:135]
    v_pk_fma_f32 v[136:137], v[156:157], v[56:57], v[136:137]
    v_pk_fma_f32 v[138:139], v[158:159], v[58:59], v[138:139]
    v_pk_fma_f32 v[120:121], v[0:1], v[40:41], v[120:121]
    v_pk_fma_f32 v[122:123], v[2:3], v[42:43], v[122:123]
    v_pk_fma_f32 v[124:125], v[4:5], v[44:45], v[124:125]
    v_pk_fma_f32 v[126:127], v[6:7], v[46:47], v[126:127]
    v_pk_fma_f32 v[128:129], v[8:9], v[48:49], v[128:129]
    v_pk_fma_f32 v[130:131], v[10:11], v[50:51], v[130:131]
    v_pk_fma_f32 v[132:133], v[12:13], v[52:53], v[132:133]
    v_pk_fma_f32 v[134:135], v[14:15], v[54:55], v[134:135]
    v_pk_fma_f32 v[136:137], v[16:17], v[56:57], v[136:137]
    v_pk_fma_f32 v[138:139], v[18:19], v[58:59], v[138:139]
    s_waitcnt lgkmcnt(0)
    s_barrier
    ds_read_b128 v[20:23], v85 offset:0
    ds_read_b128 v[24:27], v85 offset:1024
    ds_read_b128 v[28:31], v85 offset:2048
    ds_read_b128 v[32:35], v85 offset:3072
    ds_read_b128 v[36:39], v85 offset:4096
    s_waitcnt lgkmcnt(4)
    v_pk_fma_f32 v[0:1], v[20:21], v[40:41], v[120:121]
    v_pk_fma_f32 v[2:3], v[22:23], v[42:43], v[122:123]
    v_cvt_pk_bf16_f32 v0, v0, v1
    v_cvt_pk_bf16_f32 v1, v2, v3
    buffer_store_dwordx2 v[0:1], v86, s[24:27], 0 offen offset:0
    s_waitcnt lgkmcnt(3)
    v_pk_fma_f32 v[4:5], v[24:25], v[44:45], v[124:125]
    v_pk_fma_f32 v[6:7], v[26:27], v[46:47], v[126:127]
    v_cvt_pk_bf16_f32 v4, v4, v5
    v_cvt_pk_bf16_f32 v5, v6, v7
    buffer_store_dwordx2 v[4:5], v86, s[24:27], 0 offen offset:32
    s_waitcnt lgkmcnt(2)
    v_pk_fma_f32 v[8:9], v[28:29], v[48:49], v[128:129]
    v_pk_fma_f32 v[10:11], v[30:31], v[50:51], v[130:131]
    v_cvt_pk_bf16_f32 v8, v8, v9
    v_cvt_pk_bf16_f32 v9, v10, v11
    buffer_store_dwordx2 v[8:9], v86, s[24:27], 0 offen offset:64
    s_waitcnt lgkmcnt(1)
    v_pk_fma_f32 v[12:13], v[32:33], v[52:53], v[132:133]
    v_pk_fma_f32 v[14:15], v[34:35], v[54:55], v[134:135]
    v_cvt_pk_bf16_f32 v12, v12, v13
    v_cvt_pk_bf16_f32 v13, v14, v15
    buffer_store_dwordx2 v[12:13], v86, s[24:27], 0 offen offset:96
    s_waitcnt lgkmcnt(0)
    v_pk_fma_f32 v[16:17], v[36:37], v[56:57], v[136:137]
    v_pk_fma_f32 v[18:19], v[38:39], v[58:59], v[138:139]
    v_cvt_pk_bf16_f32 v16, v16, v17
    v_cvt_pk_bf16_f32 v17, v18, v19
    buffer_store_dwordx2 v[16:17], v86, s[24:27], 0 offen offset:128
mlp2_kernel_end_1:
    s_endpgm
.section .rodata,"a"
.p2align 6
.amdhsa_kernel attn_kernel
  .amdhsa_next_free_vgpr 456
  .amdhsa_next_free_sgpr 102
  .amdhsa_accum_offset 256
  .amdhsa_group_segment_fixed_size 0
  .amdhsa_kernarg_size 120
  .amdhsa_user_sgpr_count 2
  .amdhsa_user_sgpr_kernarg_segment_ptr 1
  .amdhsa_system_sgpr_workgroup_id_x 1
.end_amdhsa_kernel
.p2align 6
.amdhsa_kernel oproj_kernel
  .amdhsa_next_free_vgpr 168
  .amdhsa_next_free_sgpr 102
  .amdhsa_accum_offset 168
  .amdhsa_group_segment_fixed_size 0
  .amdhsa_kernarg_size 120
  .amdhsa_user_sgpr_count 2
  .amdhsa_user_sgpr_kernarg_segment_ptr 1
  .amdhsa_system_sgpr_workgroup_id_x 1
.end_amdhsa_kernel
.p2align 6
.amdhsa_kernel mlp1_kernel
  .amdhsa_next_free_vgpr 256
  .amdhsa_next_free_sgpr 102
  .amdhsa_accum_offset 256
  .amdhsa_group_segment_fixed_size 0
  .amdhsa_kernarg_size 120
  .amdhsa_user_sgpr_count 2
  .amdhsa_user_sgpr_kernarg_segment_ptr 1
  .amdhsa_system_sgpr_workgroup_id_x 1
.end_amdhsa_kernel
.p2align 6
.amdhsa_kernel mlp2_kernel
  .amdhsa_next_free_vgpr 168
  .amdhsa_next_free_sgpr 102
  .amdhsa_accum_offset 168
  .amdhsa_group_segment_fixed_size 0
  .amdhsa_kernarg_size 120
  .amdhsa_user_sgpr_count 2
  .amdhsa_user_sgpr_kernarg_segment_ptr 1
  .amdhsa_system_sgpr_workgroup_id_x 1
.end_amdhsa_kernel
```
